```python
import torch

def _softmax(x, axis=-1):
    return torch.softmax(x, dim=axis)
def _gelu(x):
    return torch.nn.functional.gelu(x, approximate="tanh")
def _silu(x):
    return torch.nn.functional.silu(x)
def _sigmoid(x):
    return torch.sigmoid(x)
def _layernorm(x, axis=-1, eps=1e-5):
    m = x.mean(dim=axis, keepdim=True)
    v = x.var(dim=axis, keepdim=True, unbiased=False)
    return (x - m) / torch.sqrt(v + eps)
def _scatter_add(tgt, idx, src, axis=0):
    return tgt.clone().index_add_(axis, idx, src)
def _segment_sum(src, seg, n):
    out = torch.zeros((n,) + src.shape[1:], dtype=src.dtype)
    return out.index_add_(0, seg, src)
def _pad(x, pw):
    flat = tuple(v for pair in reversed(pw) for v in pair)
    return torch.nn.functional.pad(x, flat)

kernel_name = 'recurrent_scan__sliding_block__mixer_s_mlp__prompt'

def setup_inputs():

    _w = (lambda a: (lambda t: t.to(torch.bfloat16) if t.is_floating_point() else t)(torch.as_tensor(a)))
    def _A_setup():
        B, S, D = 1, 2048, 512
        return {
            "x": _w((lambda *s: torch.randn(*s, dtype=torch.bfloat16) * 0.05)(B, S, D)),
            "wqkv": _w((lambda *s: torch.randn(*s, dtype=torch.bfloat16) * 0.05)(D, 3 * D)),
            "wo": _w((lambda *s: torch.randn(*s, dtype=torch.bfloat16) * 0.05)(D, D)),
        }
    _A_in = _A_setup()

    def _B_setup():
        B, S, D, F = 1, 2048, 512, 1792
        return {
            "x":  _w((lambda *s: torch.randn(*s, dtype=torch.bfloat16) * 0.05)(B, S, D)),
            "w1": _w((lambda *s: torch.randn(*s, dtype=torch.bfloat16) * 3.2)(D, D) * (D ** -0.5)),
            "w2": _w((lambda *s: torch.randn(*s, dtype=torch.bfloat16) * 3.2)(D, D) * (D ** -0.5)),
            "w3": _w((lambda *s: torch.randn(*s, dtype=torch.bfloat16) * 3.2)(D, F) * (D ** -0.5)),
            "w4": _w((lambda *s: torch.randn(*s, dtype=torch.bfloat16) * 1.6)(F, D) * (F ** -0.5)),
        }
    _B_in = _B_setup()

    return {
        "A_x": _A_in["x"],
        "A_wqkv": _A_in["wqkv"],
        "A_wo": _A_in["wo"],
        "B_x": _B_in["x"],
        "B_w1": _B_in["w1"],
        "B_w2": _B_in["w2"],
        "B_w3": _B_in["w3"],
        "B_w4": _B_in["w4"],
    }

def reference(A_x, A_wqkv, A_wo, B_x, B_w1, B_w2, B_w3, B_w4):
    def _A_ref(x, wqkv, wo):
        B, S, D = x.shape
        H = 32; Dh = D // H; W = 256
        qkv = (lambda x, *d: x.permute(*d))((x @ wqkv).reshape(B, S, 3, H, Dh), 2, 0, 3, 1, 4)
        q, k, v = qkv[0], qkv[1], qkv[2]
        scores = torch.einsum("bhqd,bhkd->bhqk", q, k) * (Dh ** -0.5)
        idx = torch.arange(S)
        mask = (idx[:, None] - idx[None, :] >= 0) & (idx[:, None] - idx[None, :] < W)
        scores = torch.where(mask[None, None], scores, -1e9)
        p = _softmax(scores, axis=-1)
        o = torch.einsum("bhqk,bhkd->bhqd", p, v)
        return (lambda x, *d: x.permute(*d))(o, 0, 2, 1, 3).reshape(B, S, D) @ wo

    def _B_ref(x, w1, w2, w3, w4):
        B, S, D = x.shape
        h = _gelu(_layernorm(x, axis=-1) @ w1)
        c = D // 4
        g0 = _pad(h[:, :, 0*c:1*c], ((0, 0), (1, 0), (0, 0)))[:, :S, :]
        g1 = _pad(h[:, :, 1*c:2*c], ((0, 0), (0, 1), (0, 0)))[:, 1:, :]
        g2 = _pad(h[:, :, 2*c:3*c], ((0, 0), (2, 0), (0, 0)))[:, :S, :]
        g3 = _pad(h[:, :, 3*c:   ], ((0, 0), (0, 2), (0, 0)))[:, 2:, :]
        hs = torch.concatenate([g0, g1, g2, g3], axis=-1) @ w2
        x1 = x + hs
        h2 = _gelu(_layernorm(x1, axis=-1) @ w3) @ w4
        return x1 + h2

    x = A_x
    xn = _layernorm(x, axis=-1)
    s = _A_ref(xn, A_wqkv, A_wo)
    g = _silu(_B_ref(xn, B_w1, B_w2, B_w3, B_w4))
    return x + s * g
```

```asm
; @launch grid=(256,1,1) block=(512,1,1) lds=163840
.amdgcn_target "amdgcn-amd-amdhsa--gfx950"
.text
.globl recurrent_scan__sliding_block__mixer_s_mlp__prompt_kernel
.p2align 8
.type recurrent_scan__sliding_block__mixer_s_mlp__prompt_kernel,@function
recurrent_scan__sliding_block__mixer_s_mlp__prompt_kernel:
  s_cmp_ge_u32 s2, 256
  s_cbranch_scc1 L_END
  s_load_dwordx16 s[64:79], s[0:1], 0
  s_load_dwordx4 s[80:83], s[0:1], 64
  s_load_dwordx2 s[84:85], s[0:1], 80
  v_lshrrev_b32 v2, 6, v0
  v_and_b32 v1, 63, v0
  v_readfirstlane_b32 s44, v2
  s_and_b32 s45, s2, 7
  s_lshr_b32 s46, s2, 3
  s_lshr_b32 s60, s46, 3
  s_lshl_b32 s61, s45, 2
  s_add_u32 s47, s61, s60
  s_mov_b32 s51, s47
  s_and_b32 s48, s46, 7
  s_mov_b32 s52, s48
  s_lshr_b32 s60, s46, 4
  s_lshl_b32 s61, s45, 1
  s_add_u32 s49, s61, s60
  s_and_b32 s50, s46, 15
  s_cmp_ge_u32 s46, 14
  s_cselect_b32 s60, 1, 0
  s_add_u32 s53, s61, s60
  s_mul_i32 s60, s60, 14
  s_sub_u32 s54, s46, s60
  s_cmp_ge_u32 s46, 28
  s_cselect_b32 s57, 1, 0
  s_lshr_b32 s60, s48, 1
  s_lshr_b32 s61, s60, 1
  s_add_u32 s61, s61, 1
  s_sub_u32 s62, 0, s61
  s_bitcmp1_b32 s60, 0
  s_cselect_b32 s55, s62, s61
  s_and_b32 s58, s44, 1
  s_waitcnt lgkmcnt(0)
  s_mov_b32 s4, s64
  s_and_b32 s5, s65, 0xffff
  s_mov_b32 s6, 2097152
  s_mov_b32 s7, 0x20000
  s_mov_b32 s8, s66
  s_and_b32 s9, s67, 0xffff
  s_mov_b32 s10, 1572864
  s_mov_b32 s11, 0x20000
  s_mov_b32 s12, s68
  s_and_b32 s13, s69, 0xffff
  s_mov_b32 s14, 524288
  s_mov_b32 s15, 0x20000
  s_mov_b32 s16, s72
  s_and_b32 s17, s73, 0xffff
  s_mov_b32 s18, 524288
  s_mov_b32 s19, 0x20000
  s_mov_b32 s20, s74
  s_and_b32 s21, s75, 0xffff
  s_mov_b32 s22, 524288
  s_mov_b32 s23, 0x20000
  s_mov_b32 s24, s76
  s_and_b32 s25, s77, 0xffff
  s_mov_b32 s26, 1835008
  s_mov_b32 s27, 0x20000
  s_mov_b32 s28, s78
  s_and_b32 s29, s79, 0xffff
  s_mov_b32 s30, 1835008
  s_mov_b32 s31, 0x20000
  s_mov_b32 s32, s80
  s_and_b32 s33, s81, 0xffff
  s_mov_b32 s34, 2097152
  s_mov_b32 s35, 0x20000
  s_mov_b32 s36, s84
  s_and_b32 s37, s85, 0xffff
  s_mov_b32 s38, 33554432
  s_mov_b32 s39, 0x20000
  s_mov_b32 s40, s82
  s_and_b32 s41, s83, 0xffff
  s_mov_b32 s42, 256
  s_mov_b32 s43, 0x20000
  s_cmp_lt_u32 s44, 4
  s_cbranch_scc1 L_COMPUTE
  s_cmp_lt_u32 s44, 6
  s_cbranch_scc1 L_LOADA
  s_branch L_LOADB
L_COMPUTE:
  s_mov_b32 s59, 0
  s_or_b32 s60, s2, s44
  s_cmp_lg_u32 s60, 0
  s_cbranch_scc1 L_ep_1
  s_mov_b32 s60, 21037056
  buffer_load_dword v52, off, s[36:39], s60 sc1
  s_waitcnt vmcnt(0)
  v_xor_b32 v52, 0x9e3779b9, v52
  s_mov_b32 s61, 0x85ebca6b
  v_mul_lo_u32 v52, v52, s61
  v_add_u32 v52, 0x01234567, v52
  v_max_u32 v52, 1, v52
  s_mov_b64 exec, 1
  buffer_store_dword v52, off, s[36:39], s60 sc1
  buffer_store_dword v52, off, s[40:43], 0 sc1
  s_mov_b64 exec, -1
L_ep_1:
  v_and_b32 v48, 31, v1
  v_lshrrev_b32 v49, 5, v1
  v_and_b32 v50, 15, v1
  v_lshrrev_b32 v51, 4, v1
  s_lshr_b32 s68, s44, 1
  s_and_b32 s69, s44, 1
  v_lshlrev_b32 v12, 4, v1
  s_lshl_b32 s60, s68, 5
  s_add_u32 s60, s60, 2
  s_sub_u32 s61, s60, s55
  v_add_u32 v52, s61, v48
  v_and_b32 v53, 15, v52
  v_xor_b32 v53, v53, v49
  v_lshlrev_b32 v53, 4, v53
  v_lshl_add_u32 v2, v52, 8, v53
  v_add_u32 v52, s60, v48
  s_and_b32 s61, s48, 1
  s_lshl_b32 s61, s61, 3
  s_lshl_b32 s62, s69, 2
  s_add_u32 s61, s61, s62
  v_and_b32 v53, 15, v52
  v_xor_b32 v53, s61, v53
  v_lshlrev_b32 v53, 4, v53
  v_lshl_add_u32 v11, v52, 8, v53
  v_lshl_add_u32 v11, v49, 3, v11
  v_lshrrev_b32 v52, 2, v50
  v_mul_u32_u24 v53, 8, v49
  v_add_u32 v53, v53, v52
  v_mul_u32_u24 v3, 128, v53
  v_lshrrev_b32 v53, 3, v50
  v_xor_b32 v53, s69, v53
  v_lshl_add_u32 v3, v53, 6, v3
  v_and_b32 v53, 1, v51
  v_lshl_add_u32 v3, v53, 5, v3
  v_and_b32 v53, 3, v50
  v_lshl_add_u32 v3, v53, 3, v3
  v_lshrrev_b32 v52, 2, v50
  v_mul_u32_u24 v53, 4, v49
  v_add_u32 v53, v53, v52
  v_mul_u32_u24 v4, 128, v53
  v_lshrrev_b32 v53, 3, v50
  v_xor_b32 v53, s69, v53
  v_lshl_add_u32 v4, v53, 6, v4
  v_and_b32 v53, 1, v51
  v_lshl_add_u32 v4, v53, 5, v4
  v_and_b32 v53, 3, v50
  v_lshl_add_u32 v4, v53, 3, v4
  s_lshl_b32 s60, s68, 13
  v_add_u32 v5, s60, v12
  v_add_u32 v8, s60, v12
  s_lshl_b32 s60, s44, 5
  v_add_u32 v52, s60, v48
  v_lshrrev_b32 v53, 1, v52
  v_and_b32 v53, 7, v53
  v_xor_b32 v53, v53, v49
  v_lshlrev_b32 v53, 4, v53
  v_lshl_add_u32 v6, v52, 7, v53
  v_lshrrev_b32 v52, 2, v50
  v_mul_u32_u24 v53, 8, v49
  v_add_u32 v53, v53, v52
  v_mul_u32_u24 v7, 192, v53
  v_and_b32 v53, 1, v51
  v_lshl_add_u32 v7, v53, 5, v7
  v_and_b32 v53, 3, v50
  v_lshl_add_u32 v7, v53, 3, v7
  s_lshl_b32 s61, s69, 1
  v_lshrrev_b32 v52, 2, v50
  v_mul_u32_u24 v53, 4, v49
  v_add_u32 v53, v53, v52
  v_mul_u32_u24 v9, 256, v53
  v_xor_b32 v53, s61, v52
  v_lshl_add_u32 v9, v53, 6, v9
  v_and_b32 v53, 1, v51
  v_lshl_add_u32 v9, v53, 5, v9
  v_and_b32 v53, 3, v50
  v_lshl_add_u32 v9, v53, 3, v9
  v_xor_b32 v10, 64, v9
  s_mov_b32 s96, 0xbdd2d3e8
  s_mov_b32 s97, 0xbdd2d3e8
  s_mov_b32 s98, 0xbfb8aa3b
  s_mov_b32 s99, 0xbfb8aa3b
  s_barrier
  s_lshr_b32 s60, s48, 1
  s_cmp_lg_u32 s60, 0
  s_cbranch_scc1 L_xcap_2
  v_add_u32 v176, 0, v11
  v_xor_b32 v177, 0, v176
  ds_read_b64 v[16:17], v177
  v_xor_b32 v177, 16, v176
  ds_read_b64 v[18:19], v177
  v_xor_b32 v177, 32, v176
  ds_read_b64 v[20:21], v177
  v_xor_b32 v177, 48, v176
  ds_read_b64 v[22:23], v177
  s_waitcnt lgkmcnt(0)
L_xcap_2:
  v_add_u32 v176, 0, v2
  v_xor_b32 v178, 0, v176
  v_xor_b32 v179, 32, v176
  v_xor_b32 v180, 64, v176
  v_xor_b32 v181, 96, v176
  v_xor_b32 v182, 128, v176
  v_xor_b32 v183, 160, v176
  v_xor_b32 v184, 192, v176
  v_xor_b32 v185, 224, v176
  v_add_u32 v177, 69632, v3
  ds_read_b128 v[112:115], v178
  ds_read_b64_tr_b16 v[116:117], v177 offset:0
  ds_read_b64_tr_b16 v[118:119], v177 offset:512
  ds_read_b128 v[120:123], v179
  ds_read_b64_tr_b16 v[124:125], v177 offset:2048
  ds_read_b64_tr_b16 v[126:127], v177 offset:2560
  ds_read_b128 v[128:131], v180
  ds_read_b64_tr_b16 v[132:133], v177 offset:4096
  ds_read_b64_tr_b16 v[134:135], v177 offset:4608
  ds_read_b128 v[136:139], v181
  ds_read_b64_tr_b16 v[140:141], v177 offset:6144
  ds_read_b64_tr_b16 v[142:143], v177 offset:6656
  s_waitcnt lgkmcnt(9)
  v_mfma_f32_32x32x16_bf16 v[48:63], v[116:119], v[112:115], 0
  ds_read_b128 v[112:115], v182
  ds_read_b64_tr_b16 v[116:117], v177 offset:8192
  ds_read_b64_tr_b16 v[118:119], v177 offset:8704
  s_waitcnt lgkmcnt(9)
  v_mfma_f32_32x32x16_bf16 v[48:63], v[124:127], v[120:123], v[48:63]
  ds_read_b128 v[120:123], v183
  ds_read_b64_tr_b16 v[124:125], v177 offset:10240
  ds_read_b64_tr_b16 v[126:127], v177 offset:10752
  s_waitcnt lgkmcnt(9)
  v_mfma_f32_32x32x16_bf16 v[48:63], v[132:135], v[128:131], v[48:63]
  ds_read_b128 v[128:131], v184
  ds_read_b64_tr_b16 v[132:133], v177 offset:12288
  ds_read_b64_tr_b16 v[134:135], v177 offset:12800
  s_waitcnt lgkmcnt(9)
  v_mfma_f32_32x32x16_bf16 v[48:63], v[140:143], v[136:139], v[48:63]
  ds_read_b128 v[136:139], v185
  ds_read_b64_tr_b16 v[140:141], v177 offset:14336
  ds_read_b64_tr_b16 v[142:143], v177 offset:14848
  s_waitcnt lgkmcnt(9)
  v_mfma_f32_32x32x16_bf16 v[48:63], v[116:119], v[112:115], v[48:63]
  s_waitcnt lgkmcnt(6)
  v_mfma_f32_32x32x16_bf16 v[48:63], v[124:127], v[120:123], v[48:63]
  s_waitcnt lgkmcnt(3)
  v_mfma_f32_32x32x16_bf16 v[48:63], v[132:135], v[128:131], v[48:63]
  s_waitcnt lgkmcnt(0)
  v_mfma_f32_32x32x16_bf16 v[48:63], v[140:143], v[136:139], v[48:63]
  s_barrier
  s_lshr_b32 s60, s48, 1
  s_cmp_lg_u32 s60, 1
  s_cbranch_scc1 L_xcap_3
  v_add_u32 v176, 17408, v11
  v_xor_b32 v177, 0, v176
  ds_read_b64 v[16:17], v177
  v_xor_b32 v177, 16, v176
  ds_read_b64 v[18:19], v177
  v_xor_b32 v177, 32, v176
  ds_read_b64 v[20:21], v177
  v_xor_b32 v177, 48, v176
  ds_read_b64 v[22:23], v177
  s_waitcnt lgkmcnt(0)
L_xcap_3:
  v_add_u32 v176, 17408, v2
  v_xor_b32 v178, 0, v176
  v_xor_b32 v179, 32, v176
  v_xor_b32 v180, 64, v176
  v_xor_b32 v181, 96, v176
  v_xor_b32 v182, 128, v176
  v_xor_b32 v183, 160, v176
  v_xor_b32 v184, 192, v176
  v_xor_b32 v185, 224, v176
  v_add_u32 v177, 86016, v3
  ds_read_b128 v[112:115], v178
  ds_read_b64_tr_b16 v[116:117], v177 offset:0
  ds_read_b64_tr_b16 v[118:119], v177 offset:512
  ds_read_b128 v[120:123], v179
  ds_read_b64_tr_b16 v[124:125], v177 offset:2048
  ds_read_b64_tr_b16 v[126:127], v177 offset:2560
  ds_read_b128 v[128:131], v180
  ds_read_b64_tr_b16 v[132:133], v177 offset:4096
  ds_read_b64_tr_b16 v[134:135], v177 offset:4608
  ds_read_b128 v[136:139], v181
  ds_read_b64_tr_b16 v[140:141], v177 offset:6144
  ds_read_b64_tr_b16 v[142:143], v177 offset:6656
  s_waitcnt lgkmcnt(9)
  v_mfma_f32_32x32x16_bf16 v[48:63], v[116:119], v[112:115], v[48:63]
  ds_read_b128 v[112:115], v182
  ds_read_b64_tr_b16 v[116:117], v177 offset:8192
  ds_read_b64_tr_b16 v[118:119], v177 offset:8704
  s_waitcnt lgkmcnt(9)
  v_mfma_f32_32x32x16_bf16 v[48:63], v[124:127], v[120:123], v[48:63]
  ds_read_b128 v[120:123], v183
  ds_read_b64_tr_b16 v[124:125], v177 offset:10240
  ds_read_b64_tr_b16 v[126:127], v177 offset:10752
  s_waitcnt lgkmcnt(9)
  v_mfma_f32_32x32x16_bf16 v[48:63], v[132:135], v[128:131], v[48:63]
  ds_read_b128 v[128:131], v184
  ds_read_b64_tr_b16 v[132:133], v177 offset:12288
  ds_read_b64_tr_b16 v[134:135], v177 offset:12800
  s_waitcnt lgkmcnt(9)
  v_mfma_f32_32x32x16_bf16 v[48:63], v[140:143], v[136:139], v[48:63]
  ds_read_b128 v[136:139], v185
  ds_read_b64_tr_b16 v[140:141], v177 offset:14336
  ds_read_b64_tr_b16 v[142:143], v177 offset:14848
  s_waitcnt lgkmcnt(9)
  v_mfma_f32_32x32x16_bf16 v[48:63], v[116:119], v[112:115], v[48:63]
  s_waitcnt lgkmcnt(6)
  v_mfma_f32_32x32x16_bf16 v[48:63], v[124:127], v[120:123], v[48:63]
  s_waitcnt lgkmcnt(3)
  v_mfma_f32_32x32x16_bf16 v[48:63], v[132:135], v[128:131], v[48:63]
  s_waitcnt lgkmcnt(0)
  v_mfma_f32_32x32x16_bf16 v[48:63], v[140:143], v[136:139], v[48:63]
  s_barrier
  s_lshr_b32 s60, s48, 1
  s_cmp_lg_u32 s60, 2
  s_cbranch_scc1 L_xcap_4
  v_add_u32 v176, 34816, v11
  v_xor_b32 v177, 0, v176
  ds_read_b64 v[16:17], v177
  v_xor_b32 v177, 16, v176
  ds_read_b64 v[18:19], v177
  v_xor_b32 v177, 32, v176
  ds_read_b64 v[20:21], v177
  v_xor_b32 v177, 48, v176
  ds_read_b64 v[22:23], v177
  s_waitcnt lgkmcnt(0)
L_xcap_4:
  v_add_u32 v176, 34816, v2
  v_xor_b32 v178, 0, v176
  v_xor_b32 v179, 32, v176
  v_xor_b32 v180, 64, v176
  v_xor_b32 v181, 96, v176
  v_xor_b32 v182, 128, v176
  v_xor_b32 v183, 160, v176
  v_xor_b32 v184, 192, v176
  v_xor_b32 v185, 224, v176
  v_add_u32 v177, 102400, v3
  ds_read_b128 v[112:115], v178
  ds_read_b64_tr_b16 v[116:117], v177 offset:0
  ds_read_b64_tr_b16 v[118:119], v177 offset:512
  ds_read_b128 v[120:123], v179
  ds_read_b64_tr_b16 v[124:125], v177 offset:2048
  ds_read_b64_tr_b16 v[126:127], v177 offset:2560
  ds_read_b128 v[128:131], v180
  ds_read_b64_tr_b16 v[132:133], v177 offset:4096
  ds_read_b64_tr_b16 v[134:135], v177 offset:4608
  ds_read_b128 v[136:139], v181
  ds_read_b64_tr_b16 v[140:141], v177 offset:6144
  ds_read_b64_tr_b16 v[142:143], v177 offset:6656
  s_waitcnt lgkmcnt(9)
  v_mfma_f32_32x32x16_bf16 v[48:63], v[116:119], v[112:115], v[48:63]
  ds_read_b128 v[112:115], v182
  ds_read_b64_tr_b16 v[116:117], v177 offset:8192
  ds_read_b64_tr_b16 v[118:119], v177 offset:8704
  s_waitcnt lgkmcnt(9)
  v_mfma_f32_32x32x16_bf16 v[48:63], v[124:127], v[120:123], v[48:63]
  ds_read_b128 v[120:123], v183
  ds_read_b64_tr_b16 v[124:125], v177 offset:10240
  ds_read_b64_tr_b16 v[126:127], v177 offset:10752
  s_waitcnt lgkmcnt(9)
  v_mfma_f32_32x32x16_bf16 v[48:63], v[132:135], v[128:131], v[48:63]
  ds_read_b128 v[128:131], v184
  ds_read_b64_tr_b16 v[132:133], v177 offset:12288
  ds_read_b64_tr_b16 v[134:135], v177 offset:12800
  s_waitcnt lgkmcnt(9)
  v_mfma_f32_32x32x16_bf16 v[48:63], v[140:143], v[136:139], v[48:63]
  ds_read_b128 v[136:139], v185
  ds_read_b64_tr_b16 v[140:141], v177 offset:14336
  ds_read_b64_tr_b16 v[142:143], v177 offset:14848
  s_waitcnt lgkmcnt(9)
  v_mfma_f32_32x32x16_bf16 v[48:63], v[116:119], v[112:115], v[48:63]
  s_waitcnt lgkmcnt(6)
  v_mfma_f32_32x32x16_bf16 v[48:63], v[124:127], v[120:123], v[48:63]
  s_waitcnt lgkmcnt(3)
  v_mfma_f32_32x32x16_bf16 v[48:63], v[132:135], v[128:131], v[48:63]
  s_waitcnt lgkmcnt(0)
  v_mfma_f32_32x32x16_bf16 v[48:63], v[140:143], v[136:139], v[48:63]
  s_barrier
  s_lshr_b32 s60, s48, 1
  s_cmp_lg_u32 s60, 3
  s_cbranch_scc1 L_xcap_5
  v_add_u32 v176, 52224, v11
  v_xor_b32 v177, 0, v176
  ds_read_b64 v[16:17], v177
  v_xor_b32 v177, 16, v176
  ds_read_b64 v[18:19], v177
  v_xor_b32 v177, 32, v176
  ds_read_b64 v[20:21], v177
  v_xor_b32 v177, 48, v176
  ds_read_b64 v[22:23], v177
  s_waitcnt lgkmcnt(0)
L_xcap_5:
  v_add_u32 v176, 52224, v2
  v_xor_b32 v178, 0, v176
  v_xor_b32 v179, 32, v176
  v_xor_b32 v180, 64, v176
  v_xor_b32 v181, 96, v176
  v_xor_b32 v182, 128, v176
  v_xor_b32 v183, 160, v176
  v_xor_b32 v184, 192, v176
  v_xor_b32 v185, 224, v176
  v_add_u32 v177, 118784, v3
  ds_read_b128 v[112:115], v178
  ds_read_b64_tr_b16 v[116:117], v177 offset:0
  ds_read_b64_tr_b16 v[118:119], v177 offset:512
  ds_read_b128 v[120:123], v179
  ds_read_b64_tr_b16 v[124:125], v177 offset:2048
  ds_read_b64_tr_b16 v[126:127], v177 offset:2560
  ds_read_b128 v[128:131], v180
  ds_read_b64_tr_b16 v[132:133], v177 offset:4096
  ds_read_b64_tr_b16 v[134:135], v177 offset:4608
  ds_read_b128 v[136:139], v181
  ds_read_b64_tr_b16 v[140:141], v177 offset:6144
  ds_read_b64_tr_b16 v[142:143], v177 offset:6656
  s_waitcnt lgkmcnt(9)
  v_mfma_f32_32x32x16_bf16 v[48:63], v[116:119], v[112:115], v[48:63]
  ds_read_b128 v[112:115], v182
  ds_read_b64_tr_b16 v[116:117], v177 offset:8192
  ds_read_b64_tr_b16 v[118:119], v177 offset:8704
  s_waitcnt lgkmcnt(9)
  v_mfma_f32_32x32x16_bf16 v[48:63], v[124:127], v[120:123], v[48:63]
  ds_read_b128 v[120:123], v183
  ds_read_b64_tr_b16 v[124:125], v177 offset:10240
  ds_read_b64_tr_b16 v[126:127], v177 offset:10752
  s_waitcnt lgkmcnt(9)
  v_mfma_f32_32x32x16_bf16 v[48:63], v[132:135], v[128:131], v[48:63]
  ds_read_b128 v[128:131], v184
  ds_read_b64_tr_b16 v[132:133], v177 offset:12288
  ds_read_b64_tr_b16 v[134:135], v177 offset:12800
  s_waitcnt lgkmcnt(9)
  v_mfma_f32_32x32x16_bf16 v[48:63], v[140:143], v[136:139], v[48:63]
  ds_read_b128 v[136:139], v185
  ds_read_b64_tr_b16 v[140:141], v177 offset:14336
  ds_read_b64_tr_b16 v[142:143], v177 offset:14848
  s_waitcnt lgkmcnt(9)
  v_mfma_f32_32x32x16_bf16 v[48:63], v[116:119], v[112:115], v[48:63]
  s_waitcnt lgkmcnt(6)
  v_mfma_f32_32x32x16_bf16 v[48:63], v[124:127], v[120:123], v[48:63]
  s_waitcnt lgkmcnt(3)
  v_mfma_f32_32x32x16_bf16 v[48:63], v[132:135], v[128:131], v[48:63]
  s_waitcnt lgkmcnt(0)
  v_mfma_f32_32x32x16_bf16 v[48:63], v[140:143], v[136:139], v[48:63]
  s_barrier
  v_and_b32 v216, 31, v1
  v_lshrrev_b32 v217, 5, v1
  s_lshl_b32 s60, s68, 5
  s_add_u32 s60, s60, 2
  v_add_u32 v194, s60, v216
  v_lshlrev_b32 v194, 2, v194
  v_add_u32 v194, 159744, v194
  s_lshl_b32 s61, s55, 2
  v_subrev_u32 v195, s61, v194
  ds_read_b32 v14, v194 offset:0
  ds_read_b32 v15, v194 offset:512
  ds_read_b32 v192, v195 offset:1024
  ds_read_b32 v193, v195 offset:1536
  s_lshl_b32 s61, s69, 7
  v_lshlrev_b32 v194, 4, v217
  v_add_u32 v194, s61, v194
  v_add_u32 v194, 161792, v194
  ds_read_b128 v[176:179], v194 offset:0
  ds_read_b128 v[180:183], v194 offset:32
  ds_read_b128 v[184:187], v194 offset:64
  ds_read_b128 v[188:191], v194 offset:96
  s_mov_b32 s65, 0x10000
L_epoll_6:
  buffer_load_dword v13, off, s[40:43], 0 sc1
  s_waitcnt vmcnt(0)
  v_readfirstlane_b32 s56, v13
  s_nop 1
  s_cmp_lg_u32 s56, 0
  s_cbranch_scc1 L_epolld_7
  s_sub_u32 s65, s65, 1
  s_cmp_eq_u32 s65, 0
  s_cbranch_scc0 L_epoll_6
L_epolld_7:
  v_mov_b32 v198, 162304
  ds_write_b32 v198, v13
  v_mov_b32 v196, 0xc0135761
  v_mov_b32 v197, 0xc0135761
  s_waitcnt lgkmcnt(0)
  v_pk_mul_f32 v[176:177], v[176:177], v[192:193] op_sel:[0,1] op_sel_hi:[1,1]
  v_pk_mul_f32 v[178:179], v[178:179], v[192:193] op_sel:[0,1] op_sel_hi:[1,1]
  v_pk_mul_f32 v[180:181], v[180:181], v[192:193] op_sel:[0,1] op_sel_hi:[1,1]
  v_pk_mul_f32 v[182:183], v[182:183], v[192:193] op_sel:[0,1] op_sel_hi:[1,1]
  v_pk_mul_f32 v[184:185], v[184:185], v[192:193] op_sel:[0,1] op_sel_hi:[1,1]
  v_pk_mul_f32 v[186:187], v[186:187], v[192:193] op_sel:[0,1] op_sel_hi:[1,1]
  v_pk_mul_f32 v[188:189], v[188:189], v[192:193] op_sel:[0,1] op_sel_hi:[1,1]
  v_pk_mul_f32 v[190:191], v[190:191], v[192:193] op_sel:[0,1] op_sel_hi:[1,1]
  v_pk_fma_f32 v[48:49], v[48:49], v[192:193], v[176:177] op_sel_hi:[1,0,1] neg_lo:[0,0,1] neg_hi:[0,0,1]
  v_pk_fma_f32 v[50:51], v[50:51], v[192:193], v[178:179] op_sel_hi:[1,0,1] neg_lo:[0,0,1] neg_hi:[0,0,1]
  v_pk_fma_f32 v[52:53], v[52:53], v[192:193], v[180:181] op_sel_hi:[1,0,1] neg_lo:[0,0,1] neg_hi:[0,0,1]
  v_pk_fma_f32 v[54:55], v[54:55], v[192:193], v[182:183] op_sel_hi:[1,0,1] neg_lo:[0,0,1] neg_hi:[0,0,1]
  v_pk_fma_f32 v[56:57], v[56:57], v[192:193], v[184:185] op_sel_hi:[1,0,1] neg_lo:[0,0,1] neg_hi:[0,0,1]
  v_pk_fma_f32 v[58:59], v[58:59], v[192:193], v[186:187] op_sel_hi:[1,0,1] neg_lo:[0,0,1] neg_hi:[0,0,1]
  v_pk_fma_f32 v[60:61], v[60:61], v[192:193], v[188:189] op_sel_hi:[1,0,1] neg_lo:[0,0,1] neg_hi:[0,0,1]
  v_pk_fma_f32 v[62:63], v[62:63], v[192:193], v[190:191] op_sel_hi:[1,0,1] neg_lo:[0,0,1] neg_hi:[0,0,1]
  v_pk_mul_f32 v[200:201], v[48:49], v[48:49]
  v_pk_mul_f32 v[202:203], v[50:51], v[50:51]
  v_pk_mul_f32 v[204:205], v[52:53], v[52:53]
  v_pk_mul_f32 v[206:207], v[54:55], v[54:55]
  v_pk_mul_f32 v[208:209], v[56:57], v[56:57]
  v_pk_mul_f32 v[210:211], v[58:59], v[58:59]
  v_pk_mul_f32 v[212:213], v[60:61], v[60:61]
  v_pk_mul_f32 v[214:215], v[62:63], v[62:63]
  v_pk_fma_f32 v[200:201], v[200:201], s[96:97], v[196:197]
  v_pk_fma_f32 v[202:203], v[202:203], s[96:97], v[196:197]
  v_pk_fma_f32 v[204:205], v[204:205], s[96:97], v[196:197]
  v_pk_fma_f32 v[206:207], v[206:207], s[96:97], v[196:197]
  v_pk_fma_f32 v[208:209], v[208:209], s[96:97], v[196:197]
  v_pk_fma_f32 v[210:211], v[210:211], s[96:97], v[196:197]
  v_pk_fma_f32 v[212:213], v[212:213], s[96:97], v[196:197]
  v_pk_fma_f32 v[214:215], v[214:215], s[96:97], v[196:197]
  v_pk_mul_f32 v[200:201], v[200:201], v[48:49]
  v_pk_mul_f32 v[202:203], v[202:203], v[50:51]
  v_pk_mul_f32 v[204:205], v[204:205], v[52:53]
  v_pk_mul_f32 v[206:207], v[206:207], v[54:55]
  v_pk_mul_f32 v[208:209], v[208:209], v[56:57]
  v_pk_mul_f32 v[210:211], v[210:211], v[58:59]
  v_pk_mul_f32 v[212:213], v[212:213], v[60:61]
  v_pk_mul_f32 v[214:215], v[214:215], v[62:63]
  v_exp_f32 v200, v200
  v_exp_f32 v201, v201
  v_exp_f32 v202, v202
  v_exp_f32 v203, v203
  v_exp_f32 v204, v204
  v_exp_f32 v205, v205
  v_exp_f32 v206, v206
  v_exp_f32 v207, v207
  v_exp_f32 v208, v208
  v_exp_f32 v209, v209
  v_exp_f32 v210, v210
  v_exp_f32 v211, v211
  v_exp_f32 v212, v212
  v_exp_f32 v213, v213
  v_exp_f32 v214, v214
  v_exp_f32 v215, v215
  v_pk_add_f32 v[200:201], v[200:201], 1.0 op_sel_hi:[1,0]
  v_pk_add_f32 v[202:203], v[202:203], 1.0 op_sel_hi:[1,0]
  v_pk_add_f32 v[204:205], v[204:205], 1.0 op_sel_hi:[1,0]
  v_pk_add_f32 v[206:207], v[206:207], 1.0 op_sel_hi:[1,0]
  v_pk_add_f32 v[208:209], v[208:209], 1.0 op_sel_hi:[1,0]
  v_pk_add_f32 v[210:211], v[210:211], 1.0 op_sel_hi:[1,0]
  v_pk_add_f32 v[212:213], v[212:213], 1.0 op_sel_hi:[1,0]
  v_pk_add_f32 v[214:215], v[214:215], 1.0 op_sel_hi:[1,0]
  v_rcp_f32 v200, v200
  v_rcp_f32 v201, v201
  v_rcp_f32 v202, v202
  v_rcp_f32 v203, v203
  v_rcp_f32 v204, v204
  v_rcp_f32 v205, v205
  v_rcp_f32 v206, v206
  v_rcp_f32 v207, v207
  v_rcp_f32 v208, v208
  v_rcp_f32 v209, v209
  v_rcp_f32 v210, v210
  v_rcp_f32 v211, v211
  v_rcp_f32 v212, v212
  v_rcp_f32 v213, v213
  v_rcp_f32 v214, v214
  v_rcp_f32 v215, v215
  v_pk_mul_f32 v[48:49], v[48:49], v[200:201]
  v_pk_mul_f32 v[50:51], v[50:51], v[202:203]
  v_pk_mul_f32 v[52:53], v[52:53], v[204:205]
  v_pk_mul_f32 v[54:55], v[54:55], v[206:207]
  v_pk_mul_f32 v[56:57], v[56:57], v[208:209]
  v_pk_mul_f32 v[58:59], v[58:59], v[210:211]
  v_pk_mul_f32 v[60:61], v[60:61], v[212:213]
  v_pk_mul_f32 v[62:63], v[62:63], v[214:215]
  v_cvt_pk_bf16_f32 v200, v48, v49
  v_cvt_pk_bf16_f32 v201, v50, v51
  v_cvt_pk_bf16_f32 v202, v52, v53
  v_cvt_pk_bf16_f32 v203, v54, v55
  v_cvt_pk_bf16_f32 v204, v56, v57
  v_cvt_pk_bf16_f32 v205, v58, v59
  v_cvt_pk_bf16_f32 v206, v60, v61
  v_cvt_pk_bf16_f32 v207, v62, v63
  s_lshl_b32 s60, s47, 6
  s_lshl_b32 s61, s68, 5
  s_add_u32 s60, s60, s61
  s_sub_u32 s60, s60, s55
  v_add_u32 v216, s60, v216
  v_cmp_gt_u32 vcc, 2048, v216
  s_nop 1
  v_cndmask_b32 v200, 0, v200, vcc
  v_cndmask_b32 v201, 0, v201, vcc
  v_cndmask_b32 v202, 0, v202, vcc
  v_cndmask_b32 v203, 0, v203, vcc
  v_cndmask_b32 v204, 0, v204, vcc
  v_cndmask_b32 v205, 0, v205, vcc
  v_cndmask_b32 v206, 0, v206, vcc
  v_cndmask_b32 v207, 0, v207, vcc
  s_lshl_b32 s60, s47, 1
  s_add_u32 s60, s60, s68
  s_lshl_b32 s60, s60, 5
  s_lshl_b32 s61, s48, 2
  s_add_u32 s60, s60, s61
  s_lshl_b32 s61, s69, 1
  s_add_u32 s60, s60, s61
  s_lshl_b32 s60, s60, 10
  s_add_u32 s61, s60, 0
  buffer_store_dwordx4 v[200:203], v12, s[36:39], s61 offen offset:0 sc1
  buffer_store_dwordx4 v[204:207], v12, s[36:39], s61 offen offset:1024 sc1
  v_add_u32 v176, 0, v6
  v_xor_b32 v180, 0, v176
  v_xor_b32 v181, 32, v176
  v_xor_b32 v182, 64, v176
  v_xor_b32 v183, 96, v176
  v_add_u32 v177, 135168, v7
  ds_read_b128 v[112:115], v180
  ds_read_b64_tr_b16 v[116:117], v177 offset:0
  ds_read_b64_tr_b16 v[118:119], v177 offset:768
  ds_read_b64_tr_b16 v[120:121], v177 offset:64
  ds_read_b64_tr_b16 v[122:123], v177 offset:832
  ds_read_b64_tr_b16 v[124:125], v177 offset:128
  ds_read_b64_tr_b16 v[126:127], v177 offset:896
  ds_read_b128 v[128:131], v181
  ds_read_b64_tr_b16 v[132:133], v177 offset:3072
  ds_read_b64_tr_b16 v[134:135], v177 offset:3840
  ds_read_b64_tr_b16 v[136:137], v177 offset:3136
  ds_read_b64_tr_b16 v[138:139], v177 offset:3904
  ds_read_b64_tr_b16 v[140:141], v177 offset:3200
  ds_read_b64_tr_b16 v[142:143], v177 offset:3968
  s_waitcnt lgkmcnt(7)
  v_mfma_f32_32x32x16_bf16 v[48:63], v[116:119], v[112:115], 0
  v_mfma_f32_32x32x16_bf16 v[64:79], v[120:123], v[112:115], 0
  v_mfma_f32_32x32x16_bf16 v[80:95], v[112:115], v[124:127], 0
  ds_read_b128 v[112:115], v182
  ds_read_b64_tr_b16 v[116:117], v177 offset:6144
  ds_read_b64_tr_b16 v[118:119], v177 offset:6912
  ds_read_b64_tr_b16 v[120:121], v177 offset:6208
  ds_read_b64_tr_b16 v[122:123], v177 offset:6976
  ds_read_b64_tr_b16 v[124:125], v177 offset:6272
  ds_read_b64_tr_b16 v[126:127], v177 offset:7040
  s_waitcnt lgkmcnt(7)
  v_mfma_f32_32x32x16_bf16 v[48:63], v[132:135], v[128:131], v[48:63]
  v_mfma_f32_32x32x16_bf16 v[64:79], v[136:139], v[128:131], v[64:79]
  v_mfma_f32_32x32x16_bf16 v[80:95], v[128:131], v[140:143], v[80:95]
  ds_read_b128 v[128:131], v183
  ds_read_b64_tr_b16 v[132:133], v177 offset:9216
  ds_read_b64_tr_b16 v[134:135], v177 offset:9984
  ds_read_b64_tr_b16 v[136:137], v177 offset:9280
  ds_read_b64_tr_b16 v[138:139], v177 offset:10048
  ds_read_b64_tr_b16 v[140:141], v177 offset:9344
  ds_read_b64_tr_b16 v[142:143], v177 offset:10112
  s_waitcnt lgkmcnt(7)
  v_mfma_f32_32x32x16_bf16 v[48:63], v[116:119], v[112:115], v[48:63]
  v_mfma_f32_32x32x16_bf16 v[64:79], v[120:123], v[112:115], v[64:79]
  v_mfma_f32_32x32x16_bf16 v[80:95], v[112:115], v[124:127], v[80:95]
  s_waitcnt lgkmcnt(0)
  s_barrier
  s_waitcnt vmcnt(0)
  s_lshl_b32 s64, s47, 3
  s_add_u32 s64, s64, s48
  s_lshl_b32 s64, s64, 2
  s_add_u32 s64, s64, s44
  s_lshl_b32 s64, s64, 2
  s_add_u32 s64, s64, 20971520
  s_mov_b64 exec, 1
  buffer_store_dword v13, off, s[36:39], s64 sc1
  s_mov_b64 exec, -1
  v_add_u32 v176, 17408, v6
  v_xor_b32 v180, 0, v176
  v_xor_b32 v181, 32, v176
  v_xor_b32 v182, 64, v176
  v_xor_b32 v183, 96, v176
  v_add_u32 v177, 69632, v7
  ds_read_b128 v[112:115], v180
  ds_read_b64_tr_b16 v[116:117], v177 offset:0
  ds_read_b64_tr_b16 v[118:119], v177 offset:768
  ds_read_b64_tr_b16 v[120:121], v177 offset:64
  ds_read_b64_tr_b16 v[122:123], v177 offset:832
  ds_read_b64_tr_b16 v[124:125], v177 offset:128
  ds_read_b64_tr_b16 v[126:127], v177 offset:896
  v_mfma_f32_32x32x16_bf16 v[48:63], v[132:135], v[128:131], v[48:63]
  v_mfma_f32_32x32x16_bf16 v[64:79], v[136:139], v[128:131], v[64:79]
  v_mfma_f32_32x32x16_bf16 v[80:95], v[128:131], v[140:143], v[80:95]
  ds_read_b128 v[128:131], v181
  ds_read_b64_tr_b16 v[132:133], v177 offset:3072
  ds_read_b64_tr_b16 v[134:135], v177 offset:3840
  ds_read_b64_tr_b16 v[136:137], v177 offset:3136
  ds_read_b64_tr_b16 v[138:139], v177 offset:3904
  ds_read_b64_tr_b16 v[140:141], v177 offset:3200
  ds_read_b64_tr_b16 v[142:143], v177 offset:3968
  s_waitcnt lgkmcnt(7)
  v_mfma_f32_32x32x16_bf16 v[48:63], v[116:119], v[112:115], v[48:63]
  v_mfma_f32_32x32x16_bf16 v[64:79], v[120:123], v[112:115], v[64:79]
  v_mfma_f32_32x32x16_bf16 v[80:95], v[112:115], v[124:127], v[80:95]
  ds_read_b128 v[112:115], v182
  ds_read_b64_tr_b16 v[116:117], v177 offset:6144
  ds_read_b64_tr_b16 v[118:119], v177 offset:6912
  ds_read_b64_tr_b16 v[120:121], v177 offset:6208
  ds_read_b64_tr_b16 v[122:123], v177 offset:6976
  ds_read_b64_tr_b16 v[124:125], v177 offset:6272
  ds_read_b64_tr_b16 v[126:127], v177 offset:7040
  s_waitcnt lgkmcnt(7)
  v_mfma_f32_32x32x16_bf16 v[48:63], v[132:135], v[128:131], v[48:63]
  v_mfma_f32_32x32x16_bf16 v[64:79], v[136:139], v[128:131], v[64:79]
  v_mfma_f32_32x32x16_bf16 v[80:95], v[128:131], v[140:143], v[80:95]
  ds_read_b128 v[128:131], v183
  ds_read_b64_tr_b16 v[132:133], v177 offset:9216
  ds_read_b64_tr_b16 v[134:135], v177 offset:9984
  ds_read_b64_tr_b16 v[136:137], v177 offset:9280
  ds_read_b64_tr_b16 v[138:139], v177 offset:10048
  ds_read_b64_tr_b16 v[140:141], v177 offset:9344
  ds_read_b64_tr_b16 v[142:143], v177 offset:10112
  s_waitcnt lgkmcnt(7)
  v_mfma_f32_32x32x16_bf16 v[48:63], v[116:119], v[112:115], v[48:63]
  v_mfma_f32_32x32x16_bf16 v[64:79], v[120:123], v[112:115], v[64:79]
  v_mfma_f32_32x32x16_bf16 v[80:95], v[112:115], v[124:127], v[80:95]
  s_waitcnt lgkmcnt(0)
  s_barrier
  v_add_u32 v176, 34816, v6
  v_xor_b32 v180, 0, v176
  v_xor_b32 v181, 32, v176
  v_xor_b32 v182, 64, v176
  v_xor_b32 v183, 96, v176
  v_add_u32 v177, 86016, v7
  ds_read_b128 v[112:115], v180
  ds_read_b64_tr_b16 v[116:117], v177 offset:0
  ds_read_b64_tr_b16 v[118:119], v177 offset:768
  ds_read_b64_tr_b16 v[120:121], v177 offset:64
  ds_read_b64_tr_b16 v[122:123], v177 offset:832
  ds_read_b64_tr_b16 v[124:125], v177 offset:128
  ds_read_b64_tr_b16 v[126:127], v177 offset:896
  v_mfma_f32_32x32x16_bf16 v[48:63], v[132:135], v[128:131], v[48:63]
  v_mfma_f32_32x32x16_bf16 v[64:79], v[136:139], v[128:131], v[64:79]
  v_mfma_f32_32x32x16_bf16 v[80:95], v[128:131], v[140:143], v[80:95]
  ds_read_b128 v[128:131], v181
  ds_read_b64_tr_b16 v[132:133], v177 offset:3072
  ds_read_b64_tr_b16 v[134:135], v177 offset:3840
  ds_read_b64_tr_b16 v[136:137], v177 offset:3136
  ds_read_b64_tr_b16 v[138:139], v177 offset:3904
  ds_read_b64_tr_b16 v[140:141], v177 offset:3200
  ds_read_b64_tr_b16 v[142:143], v177 offset:3968
  s_waitcnt lgkmcnt(7)
  v_mfma_f32_32x32x16_bf16 v[48:63], v[116:119], v[112:115], v[48:63]
  v_mfma_f32_32x32x16_bf16 v[64:79], v[120:123], v[112:115], v[64:79]
  v_mfma_f32_32x32x16_bf16 v[80:95], v[112:115], v[124:127], v[80:95]
  ds_read_b128 v[112:115], v182
  ds_read_b64_tr_b16 v[116:117], v177 offset:6144
  ds_read_b64_tr_b16 v[118:119], v177 offset:6912
  ds_read_b64_tr_b16 v[120:121], v177 offset:6208
  ds_read_b64_tr_b16 v[122:123], v177 offset:6976
  ds_read_b64_tr_b16 v[124:125], v177 offset:6272
  ds_read_b64_tr_b16 v[126:127], v177 offset:7040
  s_waitcnt lgkmcnt(7)
  v_mfma_f32_32x32x16_bf16 v[48:63], v[132:135], v[128:131], v[48:63]
  v_mfma_f32_32x32x16_bf16 v[64:79], v[136:139], v[128:131], v[64:79]
  v_mfma_f32_32x32x16_bf16 v[80:95], v[128:131], v[140:143], v[80:95]
  ds_read_b128 v[128:131], v183
  ds_read_b64_tr_b16 v[132:133], v177 offset:9216
  ds_read_b64_tr_b16 v[134:135], v177 offset:9984
  ds_read_b64_tr_b16 v[136:137], v177 offset:9280
  ds_read_b64_tr_b16 v[138:139], v177 offset:10048
  ds_read_b64_tr_b16 v[140:141], v177 offset:9344
  ds_read_b64_tr_b16 v[142:143], v177 offset:10112
  s_waitcnt lgkmcnt(7)
  v_mfma_f32_32x32x16_bf16 v[48:63], v[116:119], v[112:115], v[48:63]
  v_mfma_f32_32x32x16_bf16 v[64:79], v[120:123], v[112:115], v[64:79]
  v_mfma_f32_32x32x16_bf16 v[80:95], v[112:115], v[124:127], v[80:95]
  s_waitcnt lgkmcnt(0)
  s_barrier
  v_add_u32 v176, 52224, v6
  v_xor_b32 v180, 0, v176
  v_xor_b32 v181, 32, v176
  v_xor_b32 v182, 64, v176
  v_xor_b32 v183, 96, v176
  v_add_u32 v177, 102400, v7
  ds_read_b128 v[112:115], v180
  ds_read_b64_tr_b16 v[116:117], v177 offset:0
  ds_read_b64_tr_b16 v[118:119], v177 offset:768
  ds_read_b64_tr_b16 v[120:121], v177 offset:64
  ds_read_b64_tr_b16 v[122:123], v177 offset:832
  ds_read_b64_tr_b16 v[124:125], v177 offset:128
  ds_read_b64_tr_b16 v[126:127], v177 offset:896
  v_mfma_f32_32x32x16_bf16 v[48:63], v[132:135], v[128:131], v[48:63]
  v_mfma_f32_32x32x16_bf16 v[64:79], v[136:139], v[128:131], v[64:79]
  v_mfma_f32_32x32x16_bf16 v[80:95], v[128:131], v[140:143], v[80:95]
  ds_read_b128 v[128:131], v181
  ds_read_b64_tr_b16 v[132:133], v177 offset:3072
  ds_read_b64_tr_b16 v[134:135], v177 offset:3840
  ds_read_b64_tr_b16 v[136:137], v177 offset:3136
  ds_read_b64_tr_b16 v[138:139], v177 offset:3904
  ds_read_b64_tr_b16 v[140:141], v177 offset:3200
  ds_read_b64_tr_b16 v[142:143], v177 offset:3968
  s_waitcnt lgkmcnt(7)
  v_mfma_f32_32x32x16_bf16 v[48:63], v[116:119], v[112:115], v[48:63]
  v_mfma_f32_32x32x16_bf16 v[64:79], v[120:123], v[112:115], v[64:79]
  v_mfma_f32_32x32x16_bf16 v[80:95], v[112:115], v[124:127], v[80:95]
  ds_read_b128 v[112:115], v182
  ds_read_b64_tr_b16 v[116:117], v177 offset:6144
  ds_read_b64_tr_b16 v[118:119], v177 offset:6912
  ds_read_b64_tr_b16 v[120:121], v177 offset:6208
  ds_read_b64_tr_b16 v[122:123], v177 offset:6976
  ds_read_b64_tr_b16 v[124:125], v177 offset:6272
  ds_read_b64_tr_b16 v[126:127], v177 offset:7040
  s_waitcnt lgkmcnt(7)
  v_mfma_f32_32x32x16_bf16 v[48:63], v[132:135], v[128:131], v[48:63]
  v_mfma_f32_32x32x16_bf16 v[64:79], v[136:139], v[128:131], v[64:79]
  v_mfma_f32_32x32x16_bf16 v[80:95], v[128:131], v[140:143], v[80:95]
  ds_read_b128 v[128:131], v183
  ds_read_b64_tr_b16 v[132:133], v177 offset:9216
  ds_read_b64_tr_b16 v[134:135], v177 offset:9984
  ds_read_b64_tr_b16 v[136:137], v177 offset:9280
  ds_read_b64_tr_b16 v[138:139], v177 offset:10048
  ds_read_b64_tr_b16 v[140:141], v177 offset:9344
  ds_read_b64_tr_b16 v[142:143], v177 offset:10112
  s_waitcnt lgkmcnt(7)
  v_mfma_f32_32x32x16_bf16 v[48:63], v[116:119], v[112:115], v[48:63]
  v_mfma_f32_32x32x16_bf16 v[64:79], v[120:123], v[112:115], v[64:79]
  v_mfma_f32_32x32x16_bf16 v[80:95], v[112:115], v[124:127], v[80:95]
  s_waitcnt lgkmcnt(0)
  s_barrier
  v_add_u32 v176, 0, v6
  v_xor_b32 v180, 0, v176
  v_xor_b32 v181, 32, v176
  v_xor_b32 v182, 64, v176
  v_xor_b32 v183, 96, v176
  v_add_u32 v177, 118784, v7
  ds_read_b128 v[112:115], v180
  ds_read_b64_tr_b16 v[116:117], v177 offset:0
  ds_read_b64_tr_b16 v[118:119], v177 offset:768
  ds_read_b64_tr_b16 v[120:121], v177 offset:64
  ds_read_b64_tr_b16 v[122:123], v177 offset:832
  ds_read_b64_tr_b16 v[124:125], v177 offset:128
  ds_read_b64_tr_b16 v[126:127], v177 offset:896
  v_mfma_f32_32x32x16_bf16 v[48:63], v[132:135], v[128:131], v[48:63]
  v_mfma_f32_32x32x16_bf16 v[64:79], v[136:139], v[128:131], v[64:79]
  v_mfma_f32_32x32x16_bf16 v[80:95], v[128:131], v[140:143], v[80:95]
  ds_read_b128 v[128:131], v181
  ds_read_b64_tr_b16 v[132:133], v177 offset:3072
  ds_read_b64_tr_b16 v[134:135], v177 offset:3840
  ds_read_b64_tr_b16 v[136:137], v177 offset:3136
  ds_read_b64_tr_b16 v[138:139], v177 offset:3904
  ds_read_b64_tr_b16 v[140:141], v177 offset:3200
  ds_read_b64_tr_b16 v[142:143], v177 offset:3968
  s_waitcnt lgkmcnt(7)
  v_mfma_f32_32x32x16_bf16 v[48:63], v[116:119], v[112:115], v[48:63]
  v_mfma_f32_32x32x16_bf16 v[64:79], v[120:123], v[112:115], v[64:79]
  v_mfma_f32_32x32x16_bf16 v[80:95], v[112:115], v[124:127], v[80:95]
  ds_read_b128 v[112:115], v182
  ds_read_b64_tr_b16 v[116:117], v177 offset:6144
  ds_read_b64_tr_b16 v[118:119], v177 offset:6912
  ds_read_b64_tr_b16 v[120:121], v177 offset:6208
  ds_read_b64_tr_b16 v[122:123], v177 offset:6976
  ds_read_b64_tr_b16 v[124:125], v177 offset:6272
  ds_read_b64_tr_b16 v[126:127], v177 offset:7040
  s_waitcnt lgkmcnt(7)
  v_mfma_f32_32x32x16_bf16 v[48:63], v[132:135], v[128:131], v[48:63]
  v_mfma_f32_32x32x16_bf16 v[64:79], v[136:139], v[128:131], v[64:79]
  v_mfma_f32_32x32x16_bf16 v[80:95], v[128:131], v[140:143], v[80:95]
  ds_read_b128 v[128:131], v183
  ds_read_b64_tr_b16 v[132:133], v177 offset:9216
  ds_read_b64_tr_b16 v[134:135], v177 offset:9984
  ds_read_b64_tr_b16 v[136:137], v177 offset:9280
  ds_read_b64_tr_b16 v[138:139], v177 offset:10048
  ds_read_b64_tr_b16 v[140:141], v177 offset:9344
  ds_read_b64_tr_b16 v[142:143], v177 offset:10112
  s_waitcnt lgkmcnt(7)
  v_mfma_f32_32x32x16_bf16 v[48:63], v[116:119], v[112:115], v[48:63]
  v_mfma_f32_32x32x16_bf16 v[64:79], v[120:123], v[112:115], v[64:79]
  v_mfma_f32_32x32x16_bf16 v[80:95], v[112:115], v[124:127], v[80:95]
  s_waitcnt lgkmcnt(0)
  s_barrier
  v_add_u32 v176, 17408, v6
  v_xor_b32 v180, 0, v176
  v_xor_b32 v181, 32, v176
  v_xor_b32 v182, 64, v176
  v_xor_b32 v183, 96, v176
  v_add_u32 v177, 135168, v7
  ds_read_b128 v[112:115], v180
  ds_read_b64_tr_b16 v[116:117], v177 offset:0
  ds_read_b64_tr_b16 v[118:119], v177 offset:768
  ds_read_b64_tr_b16 v[120:121], v177 offset:64
  ds_read_b64_tr_b16 v[122:123], v177 offset:832
  ds_read_b64_tr_b16 v[124:125], v177 offset:128
  ds_read_b64_tr_b16 v[126:127], v177 offset:896
  v_mfma_f32_32x32x16_bf16 v[48:63], v[132:135], v[128:131], v[48:63]
  v_mfma_f32_32x32x16_bf16 v[64:79], v[136:139], v[128:131], v[64:79]
  v_mfma_f32_32x32x16_bf16 v[80:95], v[128:131], v[140:143], v[80:95]
  ds_read_b128 v[128:131], v181
  ds_read_b64_tr_b16 v[132:133], v177 offset:3072
  ds_read_b64_tr_b16 v[134:135], v177 offset:3840
  ds_read_b64_tr_b16 v[136:137], v177 offset:3136
  ds_read_b64_tr_b16 v[138:139], v177 offset:3904
  ds_read_b64_tr_b16 v[140:141], v177 offset:3200
  ds_read_b64_tr_b16 v[142:143], v177 offset:3968
  s_waitcnt lgkmcnt(7)
  v_mfma_f32_32x32x16_bf16 v[48:63], v[116:119], v[112:115], v[48:63]
  v_mfma_f32_32x32x16_bf16 v[64:79], v[120:123], v[112:115], v[64:79]
  v_mfma_f32_32x32x16_bf16 v[80:95], v[112:115], v[124:127], v[80:95]
  ds_read_b128 v[112:115], v182
  ds_read_b64_tr_b16 v[116:117], v177 offset:6144
  ds_read_b64_tr_b16 v[118:119], v177 offset:6912
  ds_read_b64_tr_b16 v[120:121], v177 offset:6208
  ds_read_b64_tr_b16 v[122:123], v177 offset:6976
  ds_read_b64_tr_b16 v[124:125], v177 offset:6272
  ds_read_b64_tr_b16 v[126:127], v177 offset:7040
  s_waitcnt lgkmcnt(7)
  v_mfma_f32_32x32x16_bf16 v[48:63], v[132:135], v[128:131], v[48:63]
  v_mfma_f32_32x32x16_bf16 v[64:79], v[136:139], v[128:131], v[64:79]
  v_mfma_f32_32x32x16_bf16 v[80:95], v[128:131], v[140:143], v[80:95]
  ds_read_b128 v[128:131], v183
  ds_read_b64_tr_b16 v[132:133], v177 offset:9216
  ds_read_b64_tr_b16 v[134:135], v177 offset:9984
  ds_read_b64_tr_b16 v[136:137], v177 offset:9280
  ds_read_b64_tr_b16 v[138:139], v177 offset:10048
  ds_read_b64_tr_b16 v[140:141], v177 offset:9344
  ds_read_b64_tr_b16 v[142:143], v177 offset:10112
  s_waitcnt lgkmcnt(7)
  v_mfma_f32_32x32x16_bf16 v[48:63], v[116:119], v[112:115], v[48:63]
  v_mfma_f32_32x32x16_bf16 v[64:79], v[120:123], v[112:115], v[64:79]
  v_mfma_f32_32x32x16_bf16 v[80:95], v[112:115], v[124:127], v[80:95]
  s_waitcnt lgkmcnt(0)
  s_barrier
  v_add_u32 v176, 34816, v6
  v_xor_b32 v180, 0, v176
  v_xor_b32 v181, 32, v176
  v_xor_b32 v182, 64, v176
  v_xor_b32 v183, 96, v176
  v_add_u32 v177, 69632, v7
  ds_read_b128 v[112:115], v180
  ds_read_b64_tr_b16 v[116:117], v177 offset:0
  ds_read_b64_tr_b16 v[118:119], v177 offset:768
  ds_read_b64_tr_b16 v[120:121], v177 offset:64
  ds_read_b64_tr_b16 v[122:123], v177 offset:832
  ds_read_b64_tr_b16 v[124:125], v177 offset:128
  ds_read_b64_tr_b16 v[126:127], v177 offset:896
  v_mfma_f32_32x32x16_bf16 v[48:63], v[132:135], v[128:131], v[48:63]
  v_mfma_f32_32x32x16_bf16 v[64:79], v[136:139], v[128:131], v[64:79]
  v_mfma_f32_32x32x16_bf16 v[80:95], v[128:131], v[140:143], v[80:95]
  ds_read_b128 v[128:131], v181
  ds_read_b64_tr_b16 v[132:133], v177 offset:3072
  ds_read_b64_tr_b16 v[134:135], v177 offset:3840
  ds_read_b64_tr_b16 v[136:137], v177 offset:3136
  ds_read_b64_tr_b16 v[138:139], v177 offset:3904
  ds_read_b64_tr_b16 v[140:141], v177 offset:3200
  ds_read_b64_tr_b16 v[142:143], v177 offset:3968
  s_waitcnt lgkmcnt(7)
  v_mfma_f32_32x32x16_bf16 v[48:63], v[116:119], v[112:115], v[48:63]
  v_mfma_f32_32x32x16_bf16 v[64:79], v[120:123], v[112:115], v[64:79]
  v_mfma_f32_32x32x16_bf16 v[80:95], v[112:115], v[124:127], v[80:95]
  ds_read_b128 v[112:115], v182
  ds_read_b64_tr_b16 v[116:117], v177 offset:6144
  ds_read_b64_tr_b16 v[118:119], v177 offset:6912
  ds_read_b64_tr_b16 v[120:121], v177 offset:6208
  ds_read_b64_tr_b16 v[122:123], v177 offset:6976
  ds_read_b64_tr_b16 v[124:125], v177 offset:6272
  ds_read_b64_tr_b16 v[126:127], v177 offset:7040
  s_waitcnt lgkmcnt(7)
  v_mfma_f32_32x32x16_bf16 v[48:63], v[132:135], v[128:131], v[48:63]
  v_mfma_f32_32x32x16_bf16 v[64:79], v[136:139], v[128:131], v[64:79]
  v_mfma_f32_32x32x16_bf16 v[80:95], v[128:131], v[140:143], v[80:95]
  ds_read_b128 v[128:131], v183
  ds_read_b64_tr_b16 v[132:133], v177 offset:9216
  ds_read_b64_tr_b16 v[134:135], v177 offset:9984
  ds_read_b64_tr_b16 v[136:137], v177 offset:9280
  ds_read_b64_tr_b16 v[138:139], v177 offset:10048
  ds_read_b64_tr_b16 v[140:141], v177 offset:9344
  ds_read_b64_tr_b16 v[142:143], v177 offset:10112
  s_waitcnt lgkmcnt(7)
  v_mfma_f32_32x32x16_bf16 v[48:63], v[116:119], v[112:115], v[48:63]
  v_mfma_f32_32x32x16_bf16 v[64:79], v[120:123], v[112:115], v[64:79]
  v_mfma_f32_32x32x16_bf16 v[80:95], v[112:115], v[124:127], v[80:95]
  s_waitcnt lgkmcnt(0)
  s_barrier
  v_add_u32 v176, 52224, v6
  v_xor_b32 v180, 0, v176
  v_xor_b32 v181, 32, v176
  v_xor_b32 v182, 64, v176
  v_xor_b32 v183, 96, v176
  v_add_u32 v177, 86016, v7
  ds_read_b128 v[112:115], v180
  ds_read_b64_tr_b16 v[116:117], v177 offset:0
  ds_read_b64_tr_b16 v[118:119], v177 offset:768
  ds_read_b64_tr_b16 v[120:121], v177 offset:64
  ds_read_b64_tr_b16 v[122:123], v177 offset:832
  ds_read_b64_tr_b16 v[124:125], v177 offset:128
  ds_read_b64_tr_b16 v[126:127], v177 offset:896
  v_mfma_f32_32x32x16_bf16 v[48:63], v[132:135], v[128:131], v[48:63]
  v_mfma_f32_32x32x16_bf16 v[64:79], v[136:139], v[128:131], v[64:79]
  v_mfma_f32_32x32x16_bf16 v[80:95], v[128:131], v[140:143], v[80:95]
  ds_read_b128 v[128:131], v181
  ds_read_b64_tr_b16 v[132:133], v177 offset:3072
  ds_read_b64_tr_b16 v[134:135], v177 offset:3840
  ds_read_b64_tr_b16 v[136:137], v177 offset:3136
  ds_read_b64_tr_b16 v[138:139], v177 offset:3904
  ds_read_b64_tr_b16 v[140:141], v177 offset:3200
  ds_read_b64_tr_b16 v[142:143], v177 offset:3968
  s_waitcnt lgkmcnt(7)
  v_mfma_f32_32x32x16_bf16 v[48:63], v[116:119], v[112:115], v[48:63]
  v_mfma_f32_32x32x16_bf16 v[64:79], v[120:123], v[112:115], v[64:79]
  v_mfma_f32_32x32x16_bf16 v[80:95], v[112:115], v[124:127], v[80:95]
  ds_read_b128 v[112:115], v182
  ds_read_b64_tr_b16 v[116:117], v177 offset:6144
  ds_read_b64_tr_b16 v[118:119], v177 offset:6912
  ds_read_b64_tr_b16 v[120:121], v177 offset:6208
  ds_read_b64_tr_b16 v[122:123], v177 offset:6976
  ds_read_b64_tr_b16 v[124:125], v177 offset:6272
  ds_read_b64_tr_b16 v[126:127], v177 offset:7040
  s_waitcnt lgkmcnt(7)
  v_mfma_f32_32x32x16_bf16 v[48:63], v[132:135], v[128:131], v[48:63]
  v_mfma_f32_32x32x16_bf16 v[64:79], v[136:139], v[128:131], v[64:79]
  v_mfma_f32_32x32x16_bf16 v[80:95], v[128:131], v[140:143], v[80:95]
  ds_read_b128 v[128:131], v183
  ds_read_b64_tr_b16 v[132:133], v177 offset:9216
  ds_read_b64_tr_b16 v[134:135], v177 offset:9984
  ds_read_b64_tr_b16 v[136:137], v177 offset:9280
  ds_read_b64_tr_b16 v[138:139], v177 offset:10048
  ds_read_b64_tr_b16 v[140:141], v177 offset:9344
  ds_read_b64_tr_b16 v[142:143], v177 offset:10112
  s_waitcnt lgkmcnt(7)
  v_mfma_f32_32x32x16_bf16 v[48:63], v[116:119], v[112:115], v[48:63]
  v_mfma_f32_32x32x16_bf16 v[64:79], v[120:123], v[112:115], v[64:79]
  v_mfma_f32_32x32x16_bf16 v[80:95], v[112:115], v[124:127], v[80:95]
  s_waitcnt lgkmcnt(0)
  s_barrier
  v_mfma_f32_32x32x16_bf16 v[48:63], v[132:135], v[128:131], v[48:63]
  v_mfma_f32_32x32x16_bf16 v[64:79], v[136:139], v[128:131], v[64:79]
  v_mfma_f32_32x32x16_bf16 v[80:95], v[128:131], v[140:143], v[80:95]
  v_and_b32 v236, 31, v1
  v_lshrrev_b32 v237, 5, v1
  s_lshl_b32 s60, s44, 5
  v_add_u32 v194, s60, v236
  v_lshlrev_b32 v194, 2, v194
  v_add_u32 v194, 159744, v194
  ds_read_b32 v192, v194 offset:0
  ds_read_b32 v193, v194 offset:512
  v_lshlrev_b32 v195, 4, v237
  v_add_u32 v195, 161792, v195
  s_lshl_b32 s60, s50, 2
  s_add_u32 s60, s60, s44
  s_lshl_b32 s61, s49, 7
  s_add_u32 s61, s61, s60
  s_lshl_b32 s61, s61, 10
  s_add_u32 s62, s61, 2097152
  s_add_u32 s63, s62, 65536
  ds_read_b128 v[176:179], v195 offset:0
  ds_read_b128 v[180:183], v195 offset:32
  ds_read_b128 v[184:187], v195 offset:64
  ds_read_b128 v[188:191], v195 offset:96
  s_waitcnt lgkmcnt(0)
  v_mul_f32 v196, 0x3eb8aa3b, v192
  v_mul_f32 v197, 0x3eb8aa3b, v193
  v_pk_mul_f32 v[176:177], v[176:177], v[196:197] op_sel:[0,1] op_sel_hi:[1,1]
  v_pk_mul_f32 v[178:179], v[178:179], v[196:197] op_sel:[0,1] op_sel_hi:[1,1]
  v_pk_mul_f32 v[180:181], v[180:181], v[196:197] op_sel:[0,1] op_sel_hi:[1,1]
  v_pk_mul_f32 v[182:183], v[182:183], v[196:197] op_sel:[0,1] op_sel_hi:[1,1]
  v_pk_mul_f32 v[184:185], v[184:185], v[196:197] op_sel:[0,1] op_sel_hi:[1,1]
  v_pk_mul_f32 v[186:187], v[186:187], v[196:197] op_sel:[0,1] op_sel_hi:[1,1]
  v_pk_mul_f32 v[188:189], v[188:189], v[196:197] op_sel:[0,1] op_sel_hi:[1,1]
  v_pk_mul_f32 v[190:191], v[190:191], v[196:197] op_sel:[0,1] op_sel_hi:[1,1]
  v_pk_fma_f32 v[48:49], v[48:49], v[196:197], v[176:177] op_sel_hi:[1,0,1] neg_lo:[0,0,1] neg_hi:[0,0,1]
  v_pk_fma_f32 v[50:51], v[50:51], v[196:197], v[178:179] op_sel_hi:[1,0,1] neg_lo:[0,0,1] neg_hi:[0,0,1]
  v_pk_fma_f32 v[52:53], v[52:53], v[196:197], v[180:181] op_sel_hi:[1,0,1] neg_lo:[0,0,1] neg_hi:[0,0,1]
  v_pk_fma_f32 v[54:55], v[54:55], v[196:197], v[182:183] op_sel_hi:[1,0,1] neg_lo:[0,0,1] neg_hi:[0,0,1]
  v_pk_fma_f32 v[56:57], v[56:57], v[196:197], v[184:185] op_sel_hi:[1,0,1] neg_lo:[0,0,1] neg_hi:[0,0,1]
  v_pk_fma_f32 v[58:59], v[58:59], v[196:197], v[186:187] op_sel_hi:[1,0,1] neg_lo:[0,0,1] neg_hi:[0,0,1]
  v_pk_fma_f32 v[60:61], v[60:61], v[196:197], v[188:189] op_sel_hi:[1,0,1] neg_lo:[0,0,1] neg_hi:[0,0,1]
  v_pk_fma_f32 v[62:63], v[62:63], v[196:197], v[190:191] op_sel_hi:[1,0,1] neg_lo:[0,0,1] neg_hi:[0,0,1]
  v_cvt_pk_bf16_f32 v200, v48, v49
  v_cvt_pk_bf16_f32 v201, v50, v51
  v_cvt_pk_bf16_f32 v202, v52, v53
  v_cvt_pk_bf16_f32 v203, v54, v55
  v_cvt_pk_bf16_f32 v204, v56, v57
  v_cvt_pk_bf16_f32 v205, v58, v59
  v_cvt_pk_bf16_f32 v206, v60, v61
  v_cvt_pk_bf16_f32 v207, v62, v63
  buffer_store_dwordx4 v[200:203], v12, s[36:39], s62 offen offset:0 sc1
  buffer_store_dwordx4 v[204:207], v12, s[36:39], s63 offen offset:0 sc1
  ds_read_b128 v[176:179], v195 offset:128
  ds_read_b128 v[180:183], v195 offset:160
  ds_read_b128 v[184:187], v195 offset:192
  ds_read_b128 v[188:191], v195 offset:224
  s_waitcnt lgkmcnt(0)
  v_pk_mul_f32 v[176:177], v[176:177], v[192:193] op_sel:[0,1] op_sel_hi:[1,1]
  v_pk_mul_f32 v[178:179], v[178:179], v[192:193] op_sel:[0,1] op_sel_hi:[1,1]
  v_pk_mul_f32 v[180:181], v[180:181], v[192:193] op_sel:[0,1] op_sel_hi:[1,1]
  v_pk_mul_f32 v[182:183], v[182:183], v[192:193] op_sel:[0,1] op_sel_hi:[1,1]
  v_pk_mul_f32 v[184:185], v[184:185], v[192:193] op_sel:[0,1] op_sel_hi:[1,1]
  v_pk_mul_f32 v[186:187], v[186:187], v[192:193] op_sel:[0,1] op_sel_hi:[1,1]
  v_pk_mul_f32 v[188:189], v[188:189], v[192:193] op_sel:[0,1] op_sel_hi:[1,1]
  v_pk_mul_f32 v[190:191], v[190:191], v[192:193] op_sel:[0,1] op_sel_hi:[1,1]
  v_pk_fma_f32 v[64:65], v[64:65], v[192:193], v[176:177] op_sel_hi:[1,0,1] neg_lo:[0,0,1] neg_hi:[0,0,1]
  v_pk_fma_f32 v[66:67], v[66:67], v[192:193], v[178:179] op_sel_hi:[1,0,1] neg_lo:[0,0,1] neg_hi:[0,0,1]
  v_pk_fma_f32 v[68:69], v[68:69], v[192:193], v[180:181] op_sel_hi:[1,0,1] neg_lo:[0,0,1] neg_hi:[0,0,1]
  v_pk_fma_f32 v[70:71], v[70:71], v[192:193], v[182:183] op_sel_hi:[1,0,1] neg_lo:[0,0,1] neg_hi:[0,0,1]
  v_pk_fma_f32 v[72:73], v[72:73], v[192:193], v[184:185] op_sel_hi:[1,0,1] neg_lo:[0,0,1] neg_hi:[0,0,1]
  v_pk_fma_f32 v[74:75], v[74:75], v[192:193], v[186:187] op_sel_hi:[1,0,1] neg_lo:[0,0,1] neg_hi:[0,0,1]
  v_pk_fma_f32 v[76:77], v[76:77], v[192:193], v[188:189] op_sel_hi:[1,0,1] neg_lo:[0,0,1] neg_hi:[0,0,1]
  v_pk_fma_f32 v[78:79], v[78:79], v[192:193], v[190:191] op_sel_hi:[1,0,1] neg_lo:[0,0,1] neg_hi:[0,0,1]
  v_cvt_pk_bf16_f32 v208, v64, v65
  v_cvt_pk_bf16_f32 v209, v66, v67
  v_cvt_pk_bf16_f32 v210, v68, v69
  v_cvt_pk_bf16_f32 v211, v70, v71
  v_cvt_pk_bf16_f32 v212, v72, v73
  v_cvt_pk_bf16_f32 v213, v74, v75
  v_cvt_pk_bf16_f32 v214, v76, v77
  v_cvt_pk_bf16_f32 v215, v78, v79
  s_add_u32 s62, s62, 2097152
  s_add_u32 s63, s63, 2097152
  buffer_store_dwordx4 v[208:211], v12, s[36:39], s62 offen offset:0 sc1
  buffer_store_dwordx4 v[212:215], v12, s[36:39], s63 offen offset:0 sc1
  s_lshl_b32 s60, s44, 7
  v_lshlrev_b32 v194, 4, v237
  v_add_u32 v194, s60, v194
  v_add_u32 v194, 159744, v194
  v_lshlrev_b32 v195, 2, v236
  v_add_u32 v195, 162048, v195
  ds_read_b128 v[176:179], v194 offset:0
  ds_read_b128 v[220:223], v194 offset:512
  ds_read_b128 v[180:183], v194 offset:32
  ds_read_b128 v[224:227], v194 offset:544
  ds_read_b128 v[184:187], v194 offset:64
  ds_read_b128 v[228:231], v194 offset:576
  ds_read_b128 v[188:191], v194 offset:96
  ds_read_b128 v[232:235], v194 offset:608
  ds_read_b32 v192, v195
  s_waitcnt lgkmcnt(0)
  v_pk_mul_f32 v[220:221], v[220:221], v[192:193] op_sel_hi:[1,0]
  v_pk_mul_f32 v[222:223], v[222:223], v[192:193] op_sel_hi:[1,0]
  v_pk_mul_f32 v[224:225], v[224:225], v[192:193] op_sel_hi:[1,0]
  v_pk_mul_f32 v[226:227], v[226:227], v[192:193] op_sel_hi:[1,0]
  v_pk_mul_f32 v[228:229], v[228:229], v[192:193] op_sel_hi:[1,0]
  v_pk_mul_f32 v[230:231], v[230:231], v[192:193] op_sel_hi:[1,0]
  v_pk_mul_f32 v[232:233], v[232:233], v[192:193] op_sel_hi:[1,0]
  v_pk_mul_f32 v[234:235], v[234:235], v[192:193] op_sel_hi:[1,0]
  v_pk_fma_f32 v[80:81], v[80:81], v[176:177], v[220:221] neg_lo:[0,0,1] neg_hi:[0,0,1]
  v_pk_fma_f32 v[82:83], v[82:83], v[178:179], v[222:223] neg_lo:[0,0,1] neg_hi:[0,0,1]
  v_pk_fma_f32 v[84:85], v[84:85], v[180:181], v[224:225] neg_lo:[0,0,1] neg_hi:[0,0,1]
  v_pk_fma_f32 v[86:87], v[86:87], v[182:183], v[226:227] neg_lo:[0,0,1] neg_hi:[0,0,1]
  v_pk_fma_f32 v[88:89], v[88:89], v[184:185], v[228:229] neg_lo:[0,0,1] neg_hi:[0,0,1]
  v_pk_fma_f32 v[90:91], v[90:91], v[186:187], v[230:231] neg_lo:[0,0,1] neg_hi:[0,0,1]
  v_pk_fma_f32 v[92:93], v[92:93], v[188:189], v[232:233] neg_lo:[0,0,1] neg_hi:[0,0,1]
  v_pk_fma_f32 v[94:95], v[94:95], v[190:191], v[234:235] neg_lo:[0,0,1] neg_hi:[0,0,1]
  v_cvt_pk_bf16_f32 v200, v80, v81
  v_cvt_pk_bf16_f32 v201, v82, v83
  v_cvt_pk_bf16_f32 v202, v84, v85
  v_cvt_pk_bf16_f32 v203, v86, v87
  v_cvt_pk_bf16_f32 v204, v88, v89
  v_cvt_pk_bf16_f32 v205, v90, v91
  v_cvt_pk_bf16_f32 v206, v92, v93
  v_cvt_pk_bf16_f32 v207, v94, v95
  v_lshrrev_b32 v194, 4, v236
  v_lshlrev_b32 v194, 16, v194
  v_and_b32 v195, 15, v236
  v_lshl_add_u32 v195, v237, 4, v195
  v_lshl_add_u32 v194, v195, 4, v194
  s_add_u32 s62, s61, 6291456
  buffer_store_dwordx4 v[200:203], v194, s[36:39], s62 offen offset:0 sc1
  buffer_store_dwordx4 v[204:207], v194, s[36:39], s62 offen offset:512 sc1
  v_add_u32 v176, 0, v5
  v_add_u32 v177, 102400, v4
  ds_read_b128 v[112:115], v176 offset:0
  ds_read_b64_tr_b16 v[116:117], v177 offset:0
  ds_read_b64_tr_b16 v[118:119], v177 offset:1024
  ds_read_b128 v[120:123], v176 offset:1024
  ds_read_b64_tr_b16 v[124:125], v177 offset:2048
  ds_read_b64_tr_b16 v[126:127], v177 offset:3072
  ds_read_b128 v[128:131], v176 offset:2048
  ds_read_b64_tr_b16 v[132:133], v177 offset:4096
  ds_read_b64_tr_b16 v[134:135], v177 offset:5120
  ds_read_b128 v[136:139], v176 offset:3072
  ds_read_b64_tr_b16 v[140:141], v177 offset:6144
  ds_read_b64_tr_b16 v[142:143], v177 offset:7168
  s_waitcnt lgkmcnt(9)
  v_mfma_f32_32x32x16_bf16 v[48:63], v[116:119], v[112:115], 0
  ds_read_b128 v[112:115], v176 offset:4096
  ds_read_b64_tr_b16 v[116:117], v177 offset:8192
  ds_read_b64_tr_b16 v[118:119], v177 offset:9216
  s_waitcnt lgkmcnt(9)
  v_mfma_f32_32x32x16_bf16 v[48:63], v[124:127], v[120:123], v[48:63]
  ds_read_b128 v[120:123], v176 offset:5120
  ds_read_b64_tr_b16 v[124:125], v177 offset:10240
  ds_read_b64_tr_b16 v[126:127], v177 offset:11264
  s_waitcnt lgkmcnt(9)
  v_mfma_f32_32x32x16_bf16 v[48:63], v[132:135], v[128:131], v[48:63]
  ds_read_b128 v[128:131], v176 offset:6144
  ds_read_b64_tr_b16 v[132:133], v177 offset:12288
  ds_read_b64_tr_b16 v[134:135], v177 offset:13312
  s_waitcnt lgkmcnt(9)
  v_mfma_f32_32x32x16_bf16 v[48:63], v[140:143], v[136:139], v[48:63]
  ds_read_b128 v[136:139], v176 offset:7168
  ds_read_b64_tr_b16 v[140:141], v177 offset:14336
  ds_read_b64_tr_b16 v[142:143], v177 offset:15360
  s_waitcnt lgkmcnt(9)
  v_mfma_f32_32x32x16_bf16 v[48:63], v[116:119], v[112:115], v[48:63]
  s_waitcnt lgkmcnt(6)
  v_mfma_f32_32x32x16_bf16 v[48:63], v[124:127], v[120:123], v[48:63]
  s_waitcnt lgkmcnt(3)
  v_mfma_f32_32x32x16_bf16 v[48:63], v[132:135], v[128:131], v[48:63]
  s_waitcnt lgkmcnt(0)
  v_mfma_f32_32x32x16_bf16 v[48:63], v[140:143], v[136:139], v[48:63]
  s_barrier
  s_waitcnt vmcnt(0)
  s_lshl_b32 s64, s49, 4
  s_add_u32 s64, s64, s50
  s_lshl_b32 s64, s64, 2
  s_add_u32 s64, s64, s44
  s_lshl_b32 s64, s64, 2
  s_add_u32 s64, s64, 20979712
  s_mov_b64 exec, 1
  buffer_store_dword v13, off, s[36:39], s64 sc1
  s_mov_b64 exec, -1
  v_add_u32 v176, 17408, v5
  v_add_u32 v177, 118784, v4
  ds_read_b128 v[112:115], v176 offset:0
  ds_read_b64_tr_b16 v[116:117], v177 offset:0
  ds_read_b64_tr_b16 v[118:119], v177 offset:1024
  ds_read_b128 v[120:123], v176 offset:1024
  ds_read_b64_tr_b16 v[124:125], v177 offset:2048
  ds_read_b64_tr_b16 v[126:127], v177 offset:3072
  ds_read_b128 v[128:131], v176 offset:2048
  ds_read_b64_tr_b16 v[132:133], v177 offset:4096
  ds_read_b64_tr_b16 v[134:135], v177 offset:5120
  ds_read_b128 v[136:139], v176 offset:3072
  ds_read_b64_tr_b16 v[140:141], v177 offset:6144
  ds_read_b64_tr_b16 v[142:143], v177 offset:7168
  s_waitcnt lgkmcnt(9)
  v_mfma_f32_32x32x16_bf16 v[48:63], v[116:119], v[112:115], v[48:63]
  ds_read_b128 v[112:115], v176 offset:4096
  ds_read_b64_tr_b16 v[116:117], v177 offset:8192
  ds_read_b64_tr_b16 v[118:119], v177 offset:9216
  s_waitcnt lgkmcnt(9)
  v_mfma_f32_32x32x16_bf16 v[48:63], v[124:127], v[120:123], v[48:63]
  ds_read_b128 v[120:123], v176 offset:5120
  ds_read_b64_tr_b16 v[124:125], v177 offset:10240
  ds_read_b64_tr_b16 v[126:127], v177 offset:11264
  s_waitcnt lgkmcnt(9)
  v_mfma_f32_32x32x16_bf16 v[48:63], v[132:135], v[128:131], v[48:63]
  ds_read_b128 v[128:131], v176 offset:6144
  ds_read_b64_tr_b16 v[132:133], v177 offset:12288
  ds_read_b64_tr_b16 v[134:135], v177 offset:13312
  s_waitcnt lgkmcnt(9)
  v_mfma_f32_32x32x16_bf16 v[48:63], v[140:143], v[136:139], v[48:63]
  ds_read_b128 v[136:139], v176 offset:7168
  ds_read_b64_tr_b16 v[140:141], v177 offset:14336
  ds_read_b64_tr_b16 v[142:143], v177 offset:15360
  s_waitcnt lgkmcnt(9)
  v_mfma_f32_32x32x16_bf16 v[48:63], v[116:119], v[112:115], v[48:63]
  s_waitcnt lgkmcnt(6)
  v_mfma_f32_32x32x16_bf16 v[48:63], v[124:127], v[120:123], v[48:63]
  s_waitcnt lgkmcnt(3)
  v_mfma_f32_32x32x16_bf16 v[48:63], v[132:135], v[128:131], v[48:63]
  s_waitcnt lgkmcnt(0)
  v_mfma_f32_32x32x16_bf16 v[48:63], v[140:143], v[136:139], v[48:63]
  s_barrier
  v_add_u32 v176, 34816, v5
  v_add_u32 v177, 135168, v4
  ds_read_b128 v[112:115], v176 offset:0
  ds_read_b64_tr_b16 v[116:117], v177 offset:0
  ds_read_b64_tr_b16 v[118:119], v177 offset:1024
  ds_read_b128 v[120:123], v176 offset:1024
  ds_read_b64_tr_b16 v[124:125], v177 offset:2048
  ds_read_b64_tr_b16 v[126:127], v177 offset:3072
  ds_read_b128 v[128:131], v176 offset:2048
  ds_read_b64_tr_b16 v[132:133], v177 offset:4096
  ds_read_b64_tr_b16 v[134:135], v177 offset:5120
  ds_read_b128 v[136:139], v176 offset:3072
  ds_read_b64_tr_b16 v[140:141], v177 offset:6144
  ds_read_b64_tr_b16 v[142:143], v177 offset:7168
  s_waitcnt lgkmcnt(9)
  v_mfma_f32_32x32x16_bf16 v[48:63], v[116:119], v[112:115], v[48:63]
  ds_read_b128 v[112:115], v176 offset:4096
  ds_read_b64_tr_b16 v[116:117], v177 offset:8192
  ds_read_b64_tr_b16 v[118:119], v177 offset:9216
  s_waitcnt lgkmcnt(9)
  v_mfma_f32_32x32x16_bf16 v[48:63], v[124:127], v[120:123], v[48:63]
  ds_read_b128 v[120:123], v176 offset:5120
  ds_read_b64_tr_b16 v[124:125], v177 offset:10240
  ds_read_b64_tr_b16 v[126:127], v177 offset:11264
  s_waitcnt lgkmcnt(9)
  v_mfma_f32_32x32x16_bf16 v[48:63], v[132:135], v[128:131], v[48:63]
  ds_read_b128 v[128:131], v176 offset:6144
  ds_read_b64_tr_b16 v[132:133], v177 offset:12288
  ds_read_b64_tr_b16 v[134:135], v177 offset:13312
  s_waitcnt lgkmcnt(9)
  v_mfma_f32_32x32x16_bf16 v[48:63], v[140:143], v[136:139], v[48:63]
  ds_read_b128 v[136:139], v176 offset:7168
  ds_read_b64_tr_b16 v[140:141], v177 offset:14336
  ds_read_b64_tr_b16 v[142:143], v177 offset:15360
  s_waitcnt lgkmcnt(9)
  v_mfma_f32_32x32x16_bf16 v[48:63], v[116:119], v[112:115], v[48:63]
  s_waitcnt lgkmcnt(6)
  v_mfma_f32_32x32x16_bf16 v[48:63], v[124:127], v[120:123], v[48:63]
  s_waitcnt lgkmcnt(3)
  v_mfma_f32_32x32x16_bf16 v[48:63], v[132:135], v[128:131], v[48:63]
  s_waitcnt lgkmcnt(0)
  v_mfma_f32_32x32x16_bf16 v[48:63], v[140:143], v[136:139], v[48:63]
  s_barrier
  v_add_u32 v176, 52224, v5
  v_add_u32 v177, 69632, v4
  ds_read_b128 v[112:115], v176 offset:0
  ds_read_b64_tr_b16 v[116:117], v177 offset:0
  ds_read_b64_tr_b16 v[118:119], v177 offset:1024
  ds_read_b128 v[120:123], v176 offset:1024
  ds_read_b64_tr_b16 v[124:125], v177 offset:2048
  ds_read_b64_tr_b16 v[126:127], v177 offset:3072
  ds_read_b128 v[128:131], v176 offset:2048
  ds_read_b64_tr_b16 v[132:133], v177 offset:4096
  ds_read_b64_tr_b16 v[134:135], v177 offset:5120
  ds_read_b128 v[136:139], v176 offset:3072
  ds_read_b64_tr_b16 v[140:141], v177 offset:6144
  ds_read_b64_tr_b16 v[142:143], v177 offset:7168
  s_waitcnt lgkmcnt(9)
  v_mfma_f32_32x32x16_bf16 v[48:63], v[116:119], v[112:115], v[48:63]
  ds_read_b128 v[112:115], v176 offset:4096
  ds_read_b64_tr_b16 v[116:117], v177 offset:8192
  ds_read_b64_tr_b16 v[118:119], v177 offset:9216
  s_waitcnt lgkmcnt(9)
  v_mfma_f32_32x32x16_bf16 v[48:63], v[124:127], v[120:123], v[48:63]
  ds_read_b128 v[120:123], v176 offset:5120
  ds_read_b64_tr_b16 v[124:125], v177 offset:10240
  ds_read_b64_tr_b16 v[126:127], v177 offset:11264
  s_waitcnt lgkmcnt(9)
  v_mfma_f32_32x32x16_bf16 v[48:63], v[132:135], v[128:131], v[48:63]
  ds_read_b128 v[128:131], v176 offset:6144
  ds_read_b64_tr_b16 v[132:133], v177 offset:12288
  ds_read_b64_tr_b16 v[134:135], v177 offset:13312
  s_waitcnt lgkmcnt(9)
  v_mfma_f32_32x32x16_bf16 v[48:63], v[140:143], v[136:139], v[48:63]
  ds_read_b128 v[136:139], v176 offset:7168
  ds_read_b64_tr_b16 v[140:141], v177 offset:14336
  ds_read_b64_tr_b16 v[142:143], v177 offset:15360
  s_waitcnt lgkmcnt(9)
  v_mfma_f32_32x32x16_bf16 v[48:63], v[116:119], v[112:115], v[48:63]
  s_waitcnt lgkmcnt(6)
  v_mfma_f32_32x32x16_bf16 v[48:63], v[124:127], v[120:123], v[48:63]
  s_waitcnt lgkmcnt(3)
  v_mfma_f32_32x32x16_bf16 v[48:63], v[132:135], v[128:131], v[48:63]
  s_waitcnt lgkmcnt(0)
  v_mfma_f32_32x32x16_bf16 v[48:63], v[140:143], v[136:139], v[48:63]
  s_barrier
  v_lshlrev_b32 v176, 16, v16
  v_and_b32 v177, 0xffff0000, v16
  v_lshlrev_b32 v178, 16, v17
  v_and_b32 v179, 0xffff0000, v17
  v_lshlrev_b32 v180, 16, v18
  v_and_b32 v181, 0xffff0000, v18
  v_lshlrev_b32 v182, 16, v19
  v_and_b32 v183, 0xffff0000, v19
  v_lshlrev_b32 v184, 16, v20
  v_and_b32 v185, 0xffff0000, v20
  v_lshlrev_b32 v186, 16, v21
  v_and_b32 v187, 0xffff0000, v21
  v_lshlrev_b32 v188, 16, v22
  v_and_b32 v189, 0xffff0000, v22
  v_lshlrev_b32 v190, 16, v23
  v_and_b32 v191, 0xffff0000, v23
  v_pk_fma_f32 v[176:177], v[176:177], v[14:15], v[14:15] op_sel:[0,0,1] op_sel_hi:[1,0,1] neg_lo:[0,0,1] neg_hi:[0,0,1]
  v_pk_fma_f32 v[178:179], v[178:179], v[14:15], v[14:15] op_sel:[0,0,1] op_sel_hi:[1,0,1] neg_lo:[0,0,1] neg_hi:[0,0,1]
  v_pk_fma_f32 v[180:181], v[180:181], v[14:15], v[14:15] op_sel:[0,0,1] op_sel_hi:[1,0,1] neg_lo:[0,0,1] neg_hi:[0,0,1]
  v_pk_fma_f32 v[182:183], v[182:183], v[14:15], v[14:15] op_sel:[0,0,1] op_sel_hi:[1,0,1] neg_lo:[0,0,1] neg_hi:[0,0,1]
  v_pk_fma_f32 v[184:185], v[184:185], v[14:15], v[14:15] op_sel:[0,0,1] op_sel_hi:[1,0,1] neg_lo:[0,0,1] neg_hi:[0,0,1]
  v_pk_fma_f32 v[186:187], v[186:187], v[14:15], v[14:15] op_sel:[0,0,1] op_sel_hi:[1,0,1] neg_lo:[0,0,1] neg_hi:[0,0,1]
  v_pk_fma_f32 v[188:189], v[188:189], v[14:15], v[14:15] op_sel:[0,0,1] op_sel_hi:[1,0,1] neg_lo:[0,0,1] neg_hi:[0,0,1]
  v_pk_fma_f32 v[190:191], v[190:191], v[14:15], v[14:15] op_sel:[0,0,1] op_sel_hi:[1,0,1] neg_lo:[0,0,1] neg_hi:[0,0,1]
  v_pk_add_f32 v[176:177], v[176:177], v[48:49]
  v_pk_add_f32 v[178:179], v[178:179], v[50:51]
  v_pk_add_f32 v[180:181], v[180:181], v[52:53]
  v_pk_add_f32 v[182:183], v[182:183], v[54:55]
  v_pk_add_f32 v[184:185], v[184:185], v[56:57]
  v_pk_add_f32 v[186:187], v[186:187], v[58:59]
  v_pk_add_f32 v[188:189], v[188:189], v[60:61]
  v_pk_add_f32 v[190:191], v[190:191], v[62:63]
  v_cvt_pk_bf16_f32 v24, v176, v177
  v_cvt_pk_bf16_f32 v25, v178, v179
  v_cvt_pk_bf16_f32 v26, v180, v181
  v_cvt_pk_bf16_f32 v27, v182, v183
  v_cvt_pk_bf16_f32 v28, v184, v185
  v_cvt_pk_bf16_f32 v29, v186, v187
  v_cvt_pk_bf16_f32 v30, v188, v189
  v_cvt_pk_bf16_f32 v31, v190, v191
  s_lshl_b32 s60, s47, 1
  s_add_u32 s60, s60, s68
  s_mul_i32 s60, s60, 32
  s_lshl_b32 s61, s48, 2
  s_add_u32 s60, s60, s61
  s_lshl_b32 s61, s69, 1
  s_add_u32 s60, s60, s61
  s_lshl_b32 s60, s60, 10
  s_add_u32 s61, s60, 8388608
  buffer_store_dwordx4 v[24:27], v12, s[36:39], s61 offen offset:0 sc1
  buffer_store_dwordx4 v[28:31], v12, s[36:39], s61 offen offset:1024 sc1
  s_branch L_ATT
L_ATT_RET_C:
  s_cmp_eq_u32 s57, 1
  s_cbranch_scc1 L_IDLE_C
  s_barrier
  v_add_u32 v176, 17408, v8
  v_add_u32 v177, 102400, v9
  v_add_u32 v178, 102400, v10
  ds_read_b128 v[112:115], v176 offset:0
  ds_read_b128 v[116:119], v176 offset:4096
  ds_read_b64_tr_b16 v[120:121], v177 offset:0
  ds_read_b64_tr_b16 v[122:123], v177 offset:2048
  ds_read_b64_tr_b16 v[124:125], v178 offset:0
  ds_read_b64_tr_b16 v[126:127], v178 offset:2048
  ds_read_b128 v[128:131], v176 offset:1024
  ds_read_b128 v[132:135], v176 offset:5120
  ds_read_b64_tr_b16 v[136:137], v177 offset:4096
  ds_read_b64_tr_b16 v[138:139], v177 offset:6144
  ds_read_b64_tr_b16 v[140:141], v178 offset:4096
  ds_read_b64_tr_b16 v[142:143], v178 offset:6144
  s_waitcnt lgkmcnt(6)
  v_mfma_f32_32x32x16_bf16 v[48:63], v[120:123], v[112:115], 0
  v_mfma_f32_32x32x16_bf16 v[64:79], v[124:127], v[112:115], 0
  v_mfma_f32_32x32x16_bf16 v[80:95], v[120:123], v[116:119], 0
  v_mfma_f32_32x32x16_bf16 v[96:111], v[124:127], v[116:119], 0
  ds_read_b128 v[112:115], v176 offset:2048
  ds_read_b128 v[116:119], v176 offset:6144
  ds_read_b64_tr_b16 v[120:121], v177 offset:8192
  ds_read_b64_tr_b16 v[122:123], v177 offset:10240
  ds_read_b64_tr_b16 v[124:125], v178 offset:8192
  ds_read_b64_tr_b16 v[126:127], v178 offset:10240
  s_waitcnt lgkmcnt(6)
  v_mfma_f32_32x32x16_bf16 v[48:63], v[136:139], v[128:131], v[48:63]
  v_mfma_f32_32x32x16_bf16 v[64:79], v[140:143], v[128:131], v[64:79]
  v_mfma_f32_32x32x16_bf16 v[80:95], v[136:139], v[132:135], v[80:95]
  v_mfma_f32_32x32x16_bf16 v[96:111], v[140:143], v[132:135], v[96:111]
  ds_read_b128 v[128:131], v176 offset:3072
  ds_read_b128 v[132:135], v176 offset:7168
  ds_read_b64_tr_b16 v[136:137], v177 offset:12288
  ds_read_b64_tr_b16 v[138:139], v177 offset:14336
  ds_read_b64_tr_b16 v[140:141], v178 offset:12288
  ds_read_b64_tr_b16 v[142:143], v178 offset:14336
  s_waitcnt lgkmcnt(6)
  v_mfma_f32_32x32x16_bf16 v[48:63], v[120:123], v[112:115], v[48:63]
  v_mfma_f32_32x32x16_bf16 v[64:79], v[124:127], v[112:115], v[64:79]
  v_mfma_f32_32x32x16_bf16 v[80:95], v[120:123], v[116:119], v[80:95]
  v_mfma_f32_32x32x16_bf16 v[96:111], v[124:127], v[116:119], v[96:111]
  s_waitcnt lgkmcnt(0)
  s_barrier
  s_waitcnt vmcnt(0)
  s_lshl_b32 s64, s52, 3
  s_add_u32 s64, s64, s44
  s_lshl_b32 s64, s64, 5
  s_add_u32 s64, s64, s51
  s_lshl_b32 s64, s64, 2
  s_add_u32 s64, s64, 20996096
  s_mov_b64 exec, 1
  buffer_store_dword v13, off, s[36:39], s64 sc1
  s_mov_b64 exec, -1
  v_add_u32 v176, 34816, v8
  v_add_u32 v177, 118784, v9
  v_add_u32 v178, 118784, v10
  ds_read_b128 v[112:115], v176 offset:0
  ds_read_b128 v[116:119], v176 offset:4096
  ds_read_b64_tr_b16 v[120:121], v177 offset:0
  ds_read_b64_tr_b16 v[122:123], v177 offset:2048
  ds_read_b64_tr_b16 v[124:125], v178 offset:0
  ds_read_b64_tr_b16 v[126:127], v178 offset:2048
  v_mfma_f32_32x32x16_bf16 v[48:63], v[136:139], v[128:131], v[48:63]
  v_mfma_f32_32x32x16_bf16 v[64:79], v[140:143], v[128:131], v[64:79]
  v_mfma_f32_32x32x16_bf16 v[80:95], v[136:139], v[132:135], v[80:95]
  v_mfma_f32_32x32x16_bf16 v[96:111], v[140:143], v[132:135], v[96:111]
  ds_read_b128 v[128:131], v176 offset:1024
  ds_read_b128 v[132:135], v176 offset:5120
  ds_read_b64_tr_b16 v[136:137], v177 offset:4096
  ds_read_b64_tr_b16 v[138:139], v177 offset:6144
  ds_read_b64_tr_b16 v[140:141], v178 offset:4096
  ds_read_b64_tr_b16 v[142:143], v178 offset:6144
  s_waitcnt lgkmcnt(6)
  v_mfma_f32_32x32x16_bf16 v[48:63], v[120:123], v[112:115], v[48:63]
  v_mfma_f32_32x32x16_bf16 v[64:79], v[124:127], v[112:115], v[64:79]
  v_mfma_f32_32x32x16_bf16 v[80:95], v[120:123], v[116:119], v[80:95]
  v_mfma_f32_32x32x16_bf16 v[96:111], v[124:127], v[116:119], v[96:111]
  ds_read_b128 v[112:115], v176 offset:2048
  ds_read_b128 v[116:119], v176 offset:6144
  ds_read_b64_tr_b16 v[120:121], v177 offset:8192
  ds_read_b64_tr_b16 v[122:123], v177 offset:10240
  ds_read_b64_tr_b16 v[124:125], v178 offset:8192
  ds_read_b64_tr_b16 v[126:127], v178 offset:10240
  s_waitcnt lgkmcnt(6)
  v_mfma_f32_32x32x16_bf16 v[48:63], v[136:139], v[128:131], v[48:63]
  v_mfma_f32_32x32x16_bf16 v[64:79], v[140:143], v[128:131], v[64:79]
  v_mfma_f32_32x32x16_bf16 v[80:95], v[136:139], v[132:135], v[80:95]
  v_mfma_f32_32x32x16_bf16 v[96:111], v[140:143], v[132:135], v[96:111]
  ds_read_b128 v[128:131], v176 offset:3072
  ds_read_b128 v[132:135], v176 offset:7168
  ds_read_b64_tr_b16 v[136:137], v177 offset:12288
  ds_read_b64_tr_b16 v[138:139], v177 offset:14336
  ds_read_b64_tr_b16 v[140:141], v178 offset:12288
  ds_read_b64_tr_b16 v[142:143], v178 offset:14336
  s_waitcnt lgkmcnt(6)
  v_mfma_f32_32x32x16_bf16 v[48:63], v[120:123], v[112:115], v[48:63]
  v_mfma_f32_32x32x16_bf16 v[64:79], v[124:127], v[112:115], v[64:79]
  v_mfma_f32_32x32x16_bf16 v[80:95], v[120:123], v[116:119], v[80:95]
  v_mfma_f32_32x32x16_bf16 v[96:111], v[124:127], v[116:119], v[96:111]
  s_waitcnt lgkmcnt(0)
  s_barrier
  v_add_u32 v176, 52224, v8
  v_add_u32 v177, 135168, v9
  v_add_u32 v178, 135168, v10
  ds_read_b128 v[112:115], v176 offset:0
  ds_read_b128 v[116:119], v176 offset:4096
  ds_read_b64_tr_b16 v[120:121], v177 offset:0
  ds_read_b64_tr_b16 v[122:123], v177 offset:2048
  ds_read_b64_tr_b16 v[124:125], v178 offset:0
  ds_read_b64_tr_b16 v[126:127], v178 offset:2048
  v_mfma_f32_32x32x16_bf16 v[48:63], v[136:139], v[128:131], v[48:63]
  v_mfma_f32_32x32x16_bf16 v[64:79], v[140:143], v[128:131], v[64:79]
  v_mfma_f32_32x32x16_bf16 v[80:95], v[136:139], v[132:135], v[80:95]
  v_mfma_f32_32x32x16_bf16 v[96:111], v[140:143], v[132:135], v[96:111]
  ds_read_b128 v[128:131], v176 offset:1024
  ds_read_b128 v[132:135], v176 offset:5120
  ds_read_b64_tr_b16 v[136:137], v177 offset:4096
  ds_read_b64_tr_b16 v[138:139], v177 offset:6144
  ds_read_b64_tr_b16 v[140:141], v178 offset:4096
  ds_read_b64_tr_b16 v[142:143], v178 offset:6144
  s_waitcnt lgkmcnt(6)
  v_mfma_f32_32x32x16_bf16 v[48:63], v[120:123], v[112:115], v[48:63]
  v_mfma_f32_32x32x16_bf16 v[64:79], v[124:127], v[112:115], v[64:79]
  v_mfma_f32_32x32x16_bf16 v[80:95], v[120:123], v[116:119], v[80:95]
  v_mfma_f32_32x32x16_bf16 v[96:111], v[124:127], v[116:119], v[96:111]
  ds_read_b128 v[112:115], v176 offset:2048
  ds_read_b128 v[116:119], v176 offset:6144
  ds_read_b64_tr_b16 v[120:121], v177 offset:8192
  ds_read_b64_tr_b16 v[122:123], v177 offset:10240
  ds_read_b64_tr_b16 v[124:125], v178 offset:8192
  ds_read_b64_tr_b16 v[126:127], v178 offset:10240
  s_waitcnt lgkmcnt(6)
  v_mfma_f32_32x32x16_bf16 v[48:63], v[136:139], v[128:131], v[48:63]
  v_mfma_f32_32x32x16_bf16 v[64:79], v[140:143], v[128:131], v[64:79]
  v_mfma_f32_32x32x16_bf16 v[80:95], v[136:139], v[132:135], v[80:95]
  v_mfma_f32_32x32x16_bf16 v[96:111], v[140:143], v[132:135], v[96:111]
  ds_read_b128 v[128:131], v176 offset:3072
  ds_read_b128 v[132:135], v176 offset:7168
  ds_read_b64_tr_b16 v[136:137], v177 offset:12288
  ds_read_b64_tr_b16 v[138:139], v177 offset:14336
  ds_read_b64_tr_b16 v[140:141], v178 offset:12288
  ds_read_b64_tr_b16 v[142:143], v178 offset:14336
  s_waitcnt lgkmcnt(6)
  v_mfma_f32_32x32x16_bf16 v[48:63], v[120:123], v[112:115], v[48:63]
  v_mfma_f32_32x32x16_bf16 v[64:79], v[124:127], v[112:115], v[64:79]
  v_mfma_f32_32x32x16_bf16 v[80:95], v[120:123], v[116:119], v[80:95]
  v_mfma_f32_32x32x16_bf16 v[96:111], v[124:127], v[116:119], v[96:111]
  s_waitcnt lgkmcnt(0)
  s_barrier
  v_add_u32 v176, 0, v8
  v_add_u32 v177, 69632, v9
  v_add_u32 v178, 69632, v10
  ds_read_b128 v[112:115], v176 offset:0
  ds_read_b128 v[116:119], v176 offset:4096
  ds_read_b64_tr_b16 v[120:121], v177 offset:0
  ds_read_b64_tr_b16 v[122:123], v177 offset:2048
  ds_read_b64_tr_b16 v[124:125], v178 offset:0
  ds_read_b64_tr_b16 v[126:127], v178 offset:2048
  v_mfma_f32_32x32x16_bf16 v[48:63], v[136:139], v[128:131], v[48:63]
  v_mfma_f32_32x32x16_bf16 v[64:79], v[140:143], v[128:131], v[64:79]
  v_mfma_f32_32x32x16_bf16 v[80:95], v[136:139], v[132:135], v[80:95]
  v_mfma_f32_32x32x16_bf16 v[96:111], v[140:143], v[132:135], v[96:111]
  ds_read_b128 v[128:131], v176 offset:1024
  ds_read_b128 v[132:135], v176 offset:5120
  ds_read_b64_tr_b16 v[136:137], v177 offset:4096
  ds_read_b64_tr_b16 v[138:139], v177 offset:6144
  ds_read_b64_tr_b16 v[140:141], v178 offset:4096
  ds_read_b64_tr_b16 v[142:143], v178 offset:6144
  s_waitcnt lgkmcnt(6)
  v_mfma_f32_32x32x16_bf16 v[48:63], v[120:123], v[112:115], v[48:63]
  v_mfma_f32_32x32x16_bf16 v[64:79], v[124:127], v[112:115], v[64:79]
  v_mfma_f32_32x32x16_bf16 v[80:95], v[120:123], v[116:119], v[80:95]
  v_mfma_f32_32x32x16_bf16 v[96:111], v[124:127], v[116:119], v[96:111]
  ds_read_b128 v[112:115], v176 offset:2048
  ds_read_b128 v[116:119], v176 offset:6144
  ds_read_b64_tr_b16 v[120:121], v177 offset:8192
  ds_read_b64_tr_b16 v[122:123], v177 offset:10240
  ds_read_b64_tr_b16 v[124:125], v178 offset:8192
  ds_read_b64_tr_b16 v[126:127], v178 offset:10240
  s_waitcnt lgkmcnt(6)
  v_mfma_f32_32x32x16_bf16 v[48:63], v[136:139], v[128:131], v[48:63]
  v_mfma_f32_32x32x16_bf16 v[64:79], v[140:143], v[128:131], v[64:79]
  v_mfma_f32_32x32x16_bf16 v[80:95], v[136:139], v[132:135], v[80:95]
  v_mfma_f32_32x32x16_bf16 v[96:111], v[140:143], v[132:135], v[96:111]
  ds_read_b128 v[128:131], v176 offset:3072
  ds_read_b128 v[132:135], v176 offset:7168
  ds_read_b64_tr_b16 v[136:137], v177 offset:12288
  ds_read_b64_tr_b16 v[138:139], v177 offset:14336
  ds_read_b64_tr_b16 v[140:141], v178 offset:12288
  ds_read_b64_tr_b16 v[142:143], v178 offset:14336
  s_waitcnt lgkmcnt(6)
  v_mfma_f32_32x32x16_bf16 v[48:63], v[120:123], v[112:115], v[48:63]
  v_mfma_f32_32x32x16_bf16 v[64:79], v[124:127], v[112:115], v[64:79]
  v_mfma_f32_32x32x16_bf16 v[80:95], v[120:123], v[116:119], v[80:95]
  v_mfma_f32_32x32x16_bf16 v[96:111], v[124:127], v[116:119], v[96:111]
  s_waitcnt lgkmcnt(0)
  s_barrier
  v_add_u32 v176, 17408, v8
  v_add_u32 v177, 86016, v9
  v_add_u32 v178, 86016, v10
  ds_read_b128 v[112:115], v176 offset:0
  ds_read_b128 v[116:119], v176 offset:4096
  ds_read_b64_tr_b16 v[120:121], v177 offset:0
  ds_read_b64_tr_b16 v[122:123], v177 offset:2048
  ds_read_b64_tr_b16 v[124:125], v178 offset:0
  ds_read_b64_tr_b16 v[126:127], v178 offset:2048
  v_mfma_f32_32x32x16_bf16 v[48:63], v[136:139], v[128:131], v[48:63]
  v_mfma_f32_32x32x16_bf16 v[64:79], v[140:143], v[128:131], v[64:79]
  v_mfma_f32_32x32x16_bf16 v[80:95], v[136:139], v[132:135], v[80:95]
  v_mfma_f32_32x32x16_bf16 v[96:111], v[140:143], v[132:135], v[96:111]
  ds_read_b128 v[128:131], v176 offset:1024
  ds_read_b128 v[132:135], v176 offset:5120
  ds_read_b64_tr_b16 v[136:137], v177 offset:4096
  ds_read_b64_tr_b16 v[138:139], v177 offset:6144
  ds_read_b64_tr_b16 v[140:141], v178 offset:4096
  ds_read_b64_tr_b16 v[142:143], v178 offset:6144
  s_waitcnt lgkmcnt(6)
  v_mfma_f32_32x32x16_bf16 v[48:63], v[120:123], v[112:115], v[48:63]
  v_mfma_f32_32x32x16_bf16 v[64:79], v[124:127], v[112:115], v[64:79]
  v_mfma_f32_32x32x16_bf16 v[80:95], v[120:123], v[116:119], v[80:95]
  v_mfma_f32_32x32x16_bf16 v[96:111], v[124:127], v[116:119], v[96:111]
  ds_read_b128 v[112:115], v176 offset:2048
  ds_read_b128 v[116:119], v176 offset:6144
  ds_read_b64_tr_b16 v[120:121], v177 offset:8192
  ds_read_b64_tr_b16 v[122:123], v177 offset:10240
  ds_read_b64_tr_b16 v[124:125], v178 offset:8192
  ds_read_b64_tr_b16 v[126:127], v178 offset:10240
  s_waitcnt lgkmcnt(6)
  v_mfma_f32_32x32x16_bf16 v[48:63], v[136:139], v[128:131], v[48:63]
  v_mfma_f32_32x32x16_bf16 v[64:79], v[140:143], v[128:131], v[64:79]
  v_mfma_f32_32x32x16_bf16 v[80:95], v[136:139], v[132:135], v[80:95]
  v_mfma_f32_32x32x16_bf16 v[96:111], v[140:143], v[132:135], v[96:111]
  ds_read_b128 v[128:131], v176 offset:3072
  ds_read_b128 v[132:135], v176 offset:7168
  ds_read_b64_tr_b16 v[136:137], v177 offset:12288
  ds_read_b64_tr_b16 v[138:139], v177 offset:14336
  ds_read_b64_tr_b16 v[140:141], v178 offset:12288
  ds_read_b64_tr_b16 v[142:143], v178 offset:14336
  s_waitcnt lgkmcnt(6)
  v_mfma_f32_32x32x16_bf16 v[48:63], v[120:123], v[112:115], v[48:63]
  v_mfma_f32_32x32x16_bf16 v[64:79], v[124:127], v[112:115], v[64:79]
  v_mfma_f32_32x32x16_bf16 v[80:95], v[120:123], v[116:119], v[80:95]
  v_mfma_f32_32x32x16_bf16 v[96:111], v[124:127], v[116:119], v[96:111]
  s_waitcnt lgkmcnt(0)
  s_barrier
  v_add_u32 v176, 34816, v8
  v_add_u32 v177, 102400, v9
  v_add_u32 v178, 102400, v10
  ds_read_b128 v[112:115], v176 offset:0
  ds_read_b128 v[116:119], v176 offset:4096
  ds_read_b64_tr_b16 v[120:121], v177 offset:0
  ds_read_b64_tr_b16 v[122:123], v177 offset:2048
  ds_read_b64_tr_b16 v[124:125], v178 offset:0
  ds_read_b64_tr_b16 v[126:127], v178 offset:2048
  v_mfma_f32_32x32x16_bf16 v[48:63], v[136:139], v[128:131], v[48:63]
  v_mfma_f32_32x32x16_bf16 v[64:79], v[140:143], v[128:131], v[64:79]
  v_mfma_f32_32x32x16_bf16 v[80:95], v[136:139], v[132:135], v[80:95]
  v_mfma_f32_32x32x16_bf16 v[96:111], v[140:143], v[132:135], v[96:111]
  ds_read_b128 v[128:131], v176 offset:1024
  ds_read_b128 v[132:135], v176 offset:5120
  ds_read_b64_tr_b16 v[136:137], v177 offset:4096
  ds_read_b64_tr_b16 v[138:139], v177 offset:6144
  ds_read_b64_tr_b16 v[140:141], v178 offset:4096
  ds_read_b64_tr_b16 v[142:143], v178 offset:6144
  s_waitcnt lgkmcnt(6)
  v_mfma_f32_32x32x16_bf16 v[48:63], v[120:123], v[112:115], v[48:63]
  v_mfma_f32_32x32x16_bf16 v[64:79], v[124:127], v[112:115], v[64:79]
  v_mfma_f32_32x32x16_bf16 v[80:95], v[120:123], v[116:119], v[80:95]
  v_mfma_f32_32x32x16_bf16 v[96:111], v[124:127], v[116:119], v[96:111]
  ds_read_b128 v[112:115], v176 offset:2048
  ds_read_b128 v[116:119], v176 offset:6144
  ds_read_b64_tr_b16 v[120:121], v177 offset:8192
  ds_read_b64_tr_b16 v[122:123], v177 offset:10240
  ds_read_b64_tr_b16 v[124:125], v178 offset:8192
  ds_read_b64_tr_b16 v[126:127], v178 offset:10240
  s_waitcnt lgkmcnt(6)
  v_mfma_f32_32x32x16_bf16 v[48:63], v[136:139], v[128:131], v[48:63]
  v_mfma_f32_32x32x16_bf16 v[64:79], v[140:143], v[128:131], v[64:79]
  v_mfma_f32_32x32x16_bf16 v[80:95], v[136:139], v[132:135], v[80:95]
  v_mfma_f32_32x32x16_bf16 v[96:111], v[140:143], v[132:135], v[96:111]
  ds_read_b128 v[128:131], v176 offset:3072
  ds_read_b128 v[132:135], v176 offset:7168
  ds_read_b64_tr_b16 v[136:137], v177 offset:12288
  ds_read_b64_tr_b16 v[138:139], v177 offset:14336
  ds_read_b64_tr_b16 v[140:141], v178 offset:12288
  ds_read_b64_tr_b16 v[142:143], v178 offset:14336
  s_waitcnt lgkmcnt(6)
  v_mfma_f32_32x32x16_bf16 v[48:63], v[120:123], v[112:115], v[48:63]
  v_mfma_f32_32x32x16_bf16 v[64:79], v[124:127], v[112:115], v[64:79]
  v_mfma_f32_32x32x16_bf16 v[80:95], v[120:123], v[116:119], v[80:95]
  v_mfma_f32_32x32x16_bf16 v[96:111], v[124:127], v[116:119], v[96:111]
  s_waitcnt lgkmcnt(0)
  s_barrier
  v_add_u32 v176, 52224, v8
  v_add_u32 v177, 118784, v9
  v_add_u32 v178, 118784, v10
  ds_read_b128 v[112:115], v176 offset:0
  ds_read_b128 v[116:119], v176 offset:4096
  ds_read_b64_tr_b16 v[120:121], v177 offset:0
  ds_read_b64_tr_b16 v[122:123], v177 offset:2048
  ds_read_b64_tr_b16 v[124:125], v178 offset:0
  ds_read_b64_tr_b16 v[126:127], v178 offset:2048
  v_mfma_f32_32x32x16_bf16 v[48:63], v[136:139], v[128:131], v[48:63]
  v_mfma_f32_32x32x16_bf16 v[64:79], v[140:143], v[128:131], v[64:79]
  v_mfma_f32_32x32x16_bf16 v[80:95], v[136:139], v[132:135], v[80:95]
  v_mfma_f32_32x32x16_bf16 v[96:111], v[140:143], v[132:135], v[96:111]
  ds_read_b128 v[128:131], v176 offset:1024
  ds_read_b128 v[132:135], v176 offset:5120
  ds_read_b64_tr_b16 v[136:137], v177 offset:4096
  ds_read_b64_tr_b16 v[138:139], v177 offset:6144
  ds_read_b64_tr_b16 v[140:141], v178 offset:4096
  ds_read_b64_tr_b16 v[142:143], v178 offset:6144
  s_waitcnt lgkmcnt(6)
  v_mfma_f32_32x32x16_bf16 v[48:63], v[120:123], v[112:115], v[48:63]
  v_mfma_f32_32x32x16_bf16 v[64:79], v[124:127], v[112:115], v[64:79]
  v_mfma_f32_32x32x16_bf16 v[80:95], v[120:123], v[116:119], v[80:95]
  v_mfma_f32_32x32x16_bf16 v[96:111], v[124:127], v[116:119], v[96:111]
  ds_read_b128 v[112:115], v176 offset:2048
  ds_read_b128 v[116:119], v176 offset:6144
  ds_read_b64_tr_b16 v[120:121], v177 offset:8192
  ds_read_b64_tr_b16 v[122:123], v177 offset:10240
  ds_read_b64_tr_b16 v[124:125], v178 offset:8192
  ds_read_b64_tr_b16 v[126:127], v178 offset:10240
  s_waitcnt lgkmcnt(6)
  v_mfma_f32_32x32x16_bf16 v[48:63], v[136:139], v[128:131], v[48:63]
  v_mfma_f32_32x32x16_bf16 v[64:79], v[140:143], v[128:131], v[64:79]
  v_mfma_f32_32x32x16_bf16 v[80:95], v[136:139], v[132:135], v[80:95]
  v_mfma_f32_32x32x16_bf16 v[96:111], v[140:143], v[132:135], v[96:111]
  ds_read_b128 v[128:131], v176 offset:3072
  ds_read_b128 v[132:135], v176 offset:7168
  ds_read_b64_tr_b16 v[136:137], v177 offset:12288
  ds_read_b64_tr_b16 v[138:139], v177 offset:14336
  ds_read_b64_tr_b16 v[140:141], v178 offset:12288
  ds_read_b64_tr_b16 v[142:143], v178 offset:14336
  s_waitcnt lgkmcnt(6)
  v_mfma_f32_32x32x16_bf16 v[48:63], v[120:123], v[112:115], v[48:63]
  v_mfma_f32_32x32x16_bf16 v[64:79], v[124:127], v[112:115], v[64:79]
  v_mfma_f32_32x32x16_bf16 v[80:95], v[120:123], v[116:119], v[80:95]
  v_mfma_f32_32x32x16_bf16 v[96:111], v[124:127], v[116:119], v[96:111]
  s_waitcnt lgkmcnt(0)
  s_barrier
  v_add_u32 v176, 0, v8
  v_add_u32 v177, 135168, v9
  v_add_u32 v178, 135168, v10
  ds_read_b128 v[112:115], v176 offset:0
  ds_read_b128 v[116:119], v176 offset:4096
  ds_read_b64_tr_b16 v[120:121], v177 offset:0
  ds_read_b64_tr_b16 v[122:123], v177 offset:2048
  ds_read_b64_tr_b16 v[124:125], v178 offset:0
  ds_read_b64_tr_b16 v[126:127], v178 offset:2048
  v_mfma_f32_32x32x16_bf16 v[48:63], v[136:139], v[128:131], v[48:63]
  v_mfma_f32_32x32x16_bf16 v[64:79], v[140:143], v[128:131], v[64:79]
  v_mfma_f32_32x32x16_bf16 v[80:95], v[136:139], v[132:135], v[80:95]
  v_mfma_f32_32x32x16_bf16 v[96:111], v[140:143], v[132:135], v[96:111]
  ds_read_b128 v[128:131], v176 offset:1024
  ds_read_b128 v[132:135], v176 offset:5120
  ds_read_b64_tr_b16 v[136:137], v177 offset:4096
  ds_read_b64_tr_b16 v[138:139], v177 offset:6144
  ds_read_b64_tr_b16 v[140:141], v178 offset:4096
  ds_read_b64_tr_b16 v[142:143], v178 offset:6144
  s_waitcnt lgkmcnt(6)
  v_mfma_f32_32x32x16_bf16 v[48:63], v[120:123], v[112:115], v[48:63]
  v_mfma_f32_32x32x16_bf16 v[64:79], v[124:127], v[112:115], v[64:79]
  v_mfma_f32_32x32x16_bf16 v[80:95], v[120:123], v[116:119], v[80:95]
  v_mfma_f32_32x32x16_bf16 v[96:111], v[124:127], v[116:119], v[96:111]
  ds_read_b128 v[112:115], v176 offset:2048
  ds_read_b128 v[116:119], v176 offset:6144
  ds_read_b64_tr_b16 v[120:121], v177 offset:8192
  ds_read_b64_tr_b16 v[122:123], v177 offset:10240
  ds_read_b64_tr_b16 v[124:125], v178 offset:8192
  ds_read_b64_tr_b16 v[126:127], v178 offset:10240
  s_waitcnt lgkmcnt(6)
  v_mfma_f32_32x32x16_bf16 v[48:63], v[136:139], v[128:131], v[48:63]
  v_mfma_f32_32x32x16_bf16 v[64:79], v[140:143], v[128:131], v[64:79]
  v_mfma_f32_32x32x16_bf16 v[80:95], v[136:139], v[132:135], v[80:95]
  v_mfma_f32_32x32x16_bf16 v[96:111], v[140:143], v[132:135], v[96:111]
  ds_read_b128 v[128:131], v176 offset:3072
  ds_read_b128 v[132:135], v176 offset:7168
  ds_read_b64_tr_b16 v[136:137], v177 offset:12288
  ds_read_b64_tr_b16 v[138:139], v177 offset:14336
  ds_read_b64_tr_b16 v[140:141], v178 offset:12288
  ds_read_b64_tr_b16 v[142:143], v178 offset:14336
  s_waitcnt lgkmcnt(6)
  v_mfma_f32_32x32x16_bf16 v[48:63], v[120:123], v[112:115], v[48:63]
  v_mfma_f32_32x32x16_bf16 v[64:79], v[124:127], v[112:115], v[64:79]
  v_mfma_f32_32x32x16_bf16 v[80:95], v[120:123], v[116:119], v[80:95]
  v_mfma_f32_32x32x16_bf16 v[96:111], v[124:127], v[116:119], v[96:111]
  s_waitcnt lgkmcnt(0)
  s_barrier
  v_mfma_f32_32x32x16_bf16 v[48:63], v[136:139], v[128:131], v[48:63]
  v_mfma_f32_32x32x16_bf16 v[64:79], v[140:143], v[128:131], v[64:79]
  v_mfma_f32_32x32x16_bf16 v[80:95], v[136:139], v[132:135], v[80:95]
  v_mfma_f32_32x32x16_bf16 v[96:111], v[140:143], v[132:135], v[96:111]
  v_and_b32 v236, 31, v1
  v_lshrrev_b32 v237, 5, v1
  s_lshl_b32 s60, s68, 6
  v_add_u32 v194, s60, v236
  v_lshlrev_b32 v194, 2, v194
  v_add_u32 v194, 159744, v194
  s_lshl_b32 s61, s69, 8
  v_lshlrev_b32 v195, 4, v237
  v_add_u32 v195, s61, v195
  v_add_u32 v195, 161792, v195
  v_mov_b32 v196, 0xc0135761
  v_mov_b32 v197, 0xc0135761
  s_lshl_b32 s60, s53, 2
  s_lshl_b32 s61, s68, 1
  s_add_u32 s60, s60, s61
  s_mul_i32 s60, s60, 112
  s_lshl_b32 s61, s54, 3
  s_add_u32 s60, s60, s61
  s_lshl_b32 s61, s69, 2
  s_add_u32 s60, s60, s61
  s_lshl_b32 s60, s60, 10
  s_add_u32 s62, s60, 12582912
  ds_read_b32 v192, v194 offset:0
  ds_read_b32 v193, v194 offset:512
  ds_read_b128 v[176:179], v195 offset:0
  ds_read_b128 v[180:183], v195 offset:32
  ds_read_b128 v[184:187], v195 offset:64
  ds_read_b128 v[188:191], v195 offset:96
  s_waitcnt lgkmcnt(0)
  v_pk_mul_f32 v[176:177], v[176:177], v[192:193] op_sel:[0,1] op_sel_hi:[1,1]
  v_pk_mul_f32 v[178:179], v[178:179], v[192:193] op_sel:[0,1] op_sel_hi:[1,1]
  v_pk_mul_f32 v[180:181], v[180:181], v[192:193] op_sel:[0,1] op_sel_hi:[1,1]
  v_pk_mul_f32 v[182:183], v[182:183], v[192:193] op_sel:[0,1] op_sel_hi:[1,1]
  v_pk_mul_f32 v[184:185], v[184:185], v[192:193] op_sel:[0,1] op_sel_hi:[1,1]
  v_pk_mul_f32 v[186:187], v[186:187], v[192:193] op_sel:[0,1] op_sel_hi:[1,1]
  v_pk_mul_f32 v[188:189], v[188:189], v[192:193] op_sel:[0,1] op_sel_hi:[1,1]
  v_pk_mul_f32 v[190:191], v[190:191], v[192:193] op_sel:[0,1] op_sel_hi:[1,1]
  v_pk_fma_f32 v[48:49], v[48:49], v[192:193], v[176:177] op_sel_hi:[1,0,1] neg_lo:[0,0,1] neg_hi:[0,0,1]
  v_pk_fma_f32 v[50:51], v[50:51], v[192:193], v[178:179] op_sel_hi:[1,0,1] neg_lo:[0,0,1] neg_hi:[0,0,1]
  v_pk_fma_f32 v[52:53], v[52:53], v[192:193], v[180:181] op_sel_hi:[1,0,1] neg_lo:[0,0,1] neg_hi:[0,0,1]
  v_pk_fma_f32 v[54:55], v[54:55], v[192:193], v[182:183] op_sel_hi:[1,0,1] neg_lo:[0,0,1] neg_hi:[0,0,1]
  v_pk_fma_f32 v[56:57], v[56:57], v[192:193], v[184:185] op_sel_hi:[1,0,1] neg_lo:[0,0,1] neg_hi:[0,0,1]
  v_pk_fma_f32 v[58:59], v[58:59], v[192:193], v[186:187] op_sel_hi:[1,0,1] neg_lo:[0,0,1] neg_hi:[0,0,1]
  v_pk_fma_f32 v[60:61], v[60:61], v[192:193], v[188:189] op_sel_hi:[1,0,1] neg_lo:[0,0,1] neg_hi:[0,0,1]
  v_pk_fma_f32 v[62:63], v[62:63], v[192:193], v[190:191] op_sel_hi:[1,0,1] neg_lo:[0,0,1] neg_hi:[0,0,1]
  v_pk_mul_f32 v[200:201], v[48:49], v[48:49]
  v_pk_mul_f32 v[202:203], v[50:51], v[50:51]
  v_pk_mul_f32 v[204:205], v[52:53], v[52:53]
  v_pk_mul_f32 v[206:207], v[54:55], v[54:55]
  v_pk_mul_f32 v[208:209], v[56:57], v[56:57]
  v_pk_mul_f32 v[210:211], v[58:59], v[58:59]
  v_pk_mul_f32 v[212:213], v[60:61], v[60:61]
  v_pk_mul_f32 v[214:215], v[62:63], v[62:63]
  v_pk_fma_f32 v[200:201], v[200:201], s[96:97], v[196:197]
  v_pk_fma_f32 v[202:203], v[202:203], s[96:97], v[196:197]
  v_pk_fma_f32 v[204:205], v[204:205], s[96:97], v[196:197]
  v_pk_fma_f32 v[206:207], v[206:207], s[96:97], v[196:197]
  v_pk_fma_f32 v[208:209], v[208:209], s[96:97], v[196:197]
  v_pk_fma_f32 v[210:211], v[210:211], s[96:97], v[196:197]
  v_pk_fma_f32 v[212:213], v[212:213], s[96:97], v[196:197]
  v_pk_fma_f32 v[214:215], v[214:215], s[96:97], v[196:197]
  v_pk_mul_f32 v[200:201], v[200:201], v[48:49]
  v_pk_mul_f32 v[202:203], v[202:203], v[50:51]
  v_pk_mul_f32 v[204:205], v[204:205], v[52:53]
  v_pk_mul_f32 v[206:207], v[206:207], v[54:55]
  v_pk_mul_f32 v[208:209], v[208:209], v[56:57]
  v_pk_mul_f32 v[210:211], v[210:211], v[58:59]
  v_pk_mul_f32 v[212:213], v[212:213], v[60:61]
  v_pk_mul_f32 v[214:215], v[214:215], v[62:63]
  v_exp_f32 v200, v200
  v_exp_f32 v201, v201
  v_exp_f32 v202, v202
  v_exp_f32 v203, v203
  v_exp_f32 v204, v204
  v_exp_f32 v205, v205
  v_exp_f32 v206, v206
  v_exp_f32 v207, v207
  v_exp_f32 v208, v208
  v_exp_f32 v209, v209
  v_exp_f32 v210, v210
  v_exp_f32 v211, v211
  v_exp_f32 v212, v212
  v_exp_f32 v213, v213
  v_exp_f32 v214, v214
  v_exp_f32 v215, v215
  v_pk_add_f32 v[200:201], v[200:201], 1.0 op_sel_hi:[1,0]
  v_pk_add_f32 v[202:203], v[202:203], 1.0 op_sel_hi:[1,0]
  v_pk_add_f32 v[204:205], v[204:205], 1.0 op_sel_hi:[1,0]
  v_pk_add_f32 v[206:207], v[206:207], 1.0 op_sel_hi:[1,0]
  v_pk_add_f32 v[208:209], v[208:209], 1.0 op_sel_hi:[1,0]
  v_pk_add_f32 v[210:211], v[210:211], 1.0 op_sel_hi:[1,0]
  v_pk_add_f32 v[212:213], v[212:213], 1.0 op_sel_hi:[1,0]
  v_pk_add_f32 v[214:215], v[214:215], 1.0 op_sel_hi:[1,0]
  v_rcp_f32 v200, v200
  v_rcp_f32 v201, v201
  v_rcp_f32 v202, v202
  v_rcp_f32 v203, v203
  v_rcp_f32 v204, v204
  v_rcp_f32 v205, v205
  v_rcp_f32 v206, v206
  v_rcp_f32 v207, v207
  v_rcp_f32 v208, v208
  v_rcp_f32 v209, v209
  v_rcp_f32 v210, v210
  v_rcp_f32 v211, v211
  v_rcp_f32 v212, v212
  v_rcp_f32 v213, v213
  v_rcp_f32 v214, v214
  v_rcp_f32 v215, v215
  v_pk_mul_f32 v[48:49], v[48:49], v[200:201]
  v_pk_mul_f32 v[50:51], v[50:51], v[202:203]
  v_pk_mul_f32 v[52:53], v[52:53], v[204:205]
  v_pk_mul_f32 v[54:55], v[54:55], v[206:207]
  v_pk_mul_f32 v[56:57], v[56:57], v[208:209]
  v_pk_mul_f32 v[58:59], v[58:59], v[210:211]
  v_pk_mul_f32 v[60:61], v[60:61], v[212:213]
  v_pk_mul_f32 v[62:63], v[62:63], v[214:215]
  v_cvt_pk_bf16_f32 v216, v48, v49
  v_cvt_pk_bf16_f32 v217, v50, v51
  v_cvt_pk_bf16_f32 v218, v52, v53
  v_cvt_pk_bf16_f32 v219, v54, v55
  v_cvt_pk_bf16_f32 v220, v56, v57
  v_cvt_pk_bf16_f32 v221, v58, v59
  v_cvt_pk_bf16_f32 v222, v60, v61
  v_cvt_pk_bf16_f32 v223, v62, v63
  s_add_u32 s63, s62, 0
  buffer_store_dwordx4 v[216:219], v12, s[36:39], s63 offen offset:0 sc1
  buffer_store_dwordx4 v[220:223], v12, s[36:39], s63 offen offset:1024 sc1
  ds_read_b32 v192, v194 offset:0
  ds_read_b32 v193, v194 offset:512
  ds_read_b128 v[176:179], v195 offset:128
  ds_read_b128 v[180:183], v195 offset:160
  ds_read_b128 v[184:187], v195 offset:192
  ds_read_b128 v[188:191], v195 offset:224
  s_waitcnt lgkmcnt(0)
  v_pk_mul_f32 v[176:177], v[176:177], v[192:193] op_sel:[0,1] op_sel_hi:[1,1]
  v_pk_mul_f32 v[178:179], v[178:179], v[192:193] op_sel:[0,1] op_sel_hi:[1,1]
  v_pk_mul_f32 v[180:181], v[180:181], v[192:193] op_sel:[0,1] op_sel_hi:[1,1]
  v_pk_mul_f32 v[182:183], v[182:183], v[192:193] op_sel:[0,1] op_sel_hi:[1,1]
  v_pk_mul_f32 v[184:185], v[184:185], v[192:193] op_sel:[0,1] op_sel_hi:[1,1]
  v_pk_mul_f32 v[186:187], v[186:187], v[192:193] op_sel:[0,1] op_sel_hi:[1,1]
  v_pk_mul_f32 v[188:189], v[188:189], v[192:193] op_sel:[0,1] op_sel_hi:[1,1]
  v_pk_mul_f32 v[190:191], v[190:191], v[192:193] op_sel:[0,1] op_sel_hi:[1,1]
  v_pk_fma_f32 v[64:65], v[64:65], v[192:193], v[176:177] op_sel_hi:[1,0,1] neg_lo:[0,0,1] neg_hi:[0,0,1]
  v_pk_fma_f32 v[66:67], v[66:67], v[192:193], v[178:179] op_sel_hi:[1,0,1] neg_lo:[0,0,1] neg_hi:[0,0,1]
  v_pk_fma_f32 v[68:69], v[68:69], v[192:193], v[180:181] op_sel_hi:[1,0,1] neg_lo:[0,0,1] neg_hi:[0,0,1]
  v_pk_fma_f32 v[70:71], v[70:71], v[192:193], v[182:183] op_sel_hi:[1,0,1] neg_lo:[0,0,1] neg_hi:[0,0,1]
  v_pk_fma_f32 v[72:73], v[72:73], v[192:193], v[184:185] op_sel_hi:[1,0,1] neg_lo:[0,0,1] neg_hi:[0,0,1]
  v_pk_fma_f32 v[74:75], v[74:75], v[192:193], v[186:187] op_sel_hi:[1,0,1] neg_lo:[0,0,1] neg_hi:[0,0,1]
  v_pk_fma_f32 v[76:77], v[76:77], v[192:193], v[188:189] op_sel_hi:[1,0,1] neg_lo:[0,0,1] neg_hi:[0,0,1]
  v_pk_fma_f32 v[78:79], v[78:79], v[192:193], v[190:191] op_sel_hi:[1,0,1] neg_lo:[0,0,1] neg_hi:[0,0,1]
  v_pk_mul_f32 v[200:201], v[64:65], v[64:65]
  v_pk_mul_f32 v[202:203], v[66:67], v[66:67]
  v_pk_mul_f32 v[204:205], v[68:69], v[68:69]
  v_pk_mul_f32 v[206:207], v[70:71], v[70:71]
  v_pk_mul_f32 v[208:209], v[72:73], v[72:73]
  v_pk_mul_f32 v[210:211], v[74:75], v[74:75]
  v_pk_mul_f32 v[212:213], v[76:77], v[76:77]
  v_pk_mul_f32 v[214:215], v[78:79], v[78:79]
  v_pk_fma_f32 v[200:201], v[200:201], s[96:97], v[196:197]
  v_pk_fma_f32 v[202:203], v[202:203], s[96:97], v[196:197]
  v_pk_fma_f32 v[204:205], v[204:205], s[96:97], v[196:197]
  v_pk_fma_f32 v[206:207], v[206:207], s[96:97], v[196:197]
  v_pk_fma_f32 v[208:209], v[208:209], s[96:97], v[196:197]
  v_pk_fma_f32 v[210:211], v[210:211], s[96:97], v[196:197]
  v_pk_fma_f32 v[212:213], v[212:213], s[96:97], v[196:197]
  v_pk_fma_f32 v[214:215], v[214:215], s[96:97], v[196:197]
  v_pk_mul_f32 v[200:201], v[200:201], v[64:65]
  v_pk_mul_f32 v[202:203], v[202:203], v[66:67]
  v_pk_mul_f32 v[204:205], v[204:205], v[68:69]
  v_pk_mul_f32 v[206:207], v[206:207], v[70:71]
  v_pk_mul_f32 v[208:209], v[208:209], v[72:73]
  v_pk_mul_f32 v[210:211], v[210:211], v[74:75]
  v_pk_mul_f32 v[212:213], v[212:213], v[76:77]
  v_pk_mul_f32 v[214:215], v[214:215], v[78:79]
  v_exp_f32 v200, v200
  v_exp_f32 v201, v201
  v_exp_f32 v202, v202
  v_exp_f32 v203, v203
  v_exp_f32 v204, v204
  v_exp_f32 v205, v205
  v_exp_f32 v206, v206
  v_exp_f32 v207, v207
  v_exp_f32 v208, v208
  v_exp_f32 v209, v209
  v_exp_f32 v210, v210
  v_exp_f32 v211, v211
  v_exp_f32 v212, v212
  v_exp_f32 v213, v213
  v_exp_f32 v214, v214
  v_exp_f32 v215, v215
  v_pk_add_f32 v[200:201], v[200:201], 1.0 op_sel_hi:[1,0]
  v_pk_add_f32 v[202:203], v[202:203], 1.0 op_sel_hi:[1,0]
  v_pk_add_f32 v[204:205], v[204:205], 1.0 op_sel_hi:[1,0]
  v_pk_add_f32 v[206:207], v[206:207], 1.0 op_sel_hi:[1,0]
  v_pk_add_f32 v[208:209], v[208:209], 1.0 op_sel_hi:[1,0]
  v_pk_add_f32 v[210:211], v[210:211], 1.0 op_sel_hi:[1,0]
  v_pk_add_f32 v[212:213], v[212:213], 1.0 op_sel_hi:[1,0]
  v_pk_add_f32 v[214:215], v[214:215], 1.0 op_sel_hi:[1,0]
  v_rcp_f32 v200, v200
  v_rcp_f32 v201, v201
  v_rcp_f32 v202, v202
  v_rcp_f32 v203, v203
  v_rcp_f32 v204, v204
  v_rcp_f32 v205, v205
  v_rcp_f32 v206, v206
  v_rcp_f32 v207, v207
  v_rcp_f32 v208, v208
  v_rcp_f32 v209, v209
  v_rcp_f32 v210, v210
  v_rcp_f32 v211, v211
  v_rcp_f32 v212, v212
  v_rcp_f32 v213, v213
  v_rcp_f32 v214, v214
  v_rcp_f32 v215, v215
  v_pk_mul_f32 v[64:65], v[64:65], v[200:201]
  v_pk_mul_f32 v[66:67], v[66:67], v[202:203]
  v_pk_mul_f32 v[68:69], v[68:69], v[204:205]
  v_pk_mul_f32 v[70:71], v[70:71], v[206:207]
  v_pk_mul_f32 v[72:73], v[72:73], v[208:209]
  v_pk_mul_f32 v[74:75], v[74:75], v[210:211]
  v_pk_mul_f32 v[76:77], v[76:77], v[212:213]
  v_pk_mul_f32 v[78:79], v[78:79], v[214:215]
  v_cvt_pk_bf16_f32 v224, v64, v65
  v_cvt_pk_bf16_f32 v225, v66, v67
  v_cvt_pk_bf16_f32 v226, v68, v69
  v_cvt_pk_bf16_f32 v227, v70, v71
  v_cvt_pk_bf16_f32 v228, v72, v73
  v_cvt_pk_bf16_f32 v229, v74, v75
  v_cvt_pk_bf16_f32 v230, v76, v77
  v_cvt_pk_bf16_f32 v231, v78, v79
  s_add_u32 s63, s62, 2048
  buffer_store_dwordx4 v[224:227], v12, s[36:39], s63 offen offset:0 sc1
  buffer_store_dwordx4 v[228:231], v12, s[36:39], s63 offen offset:1024 sc1
  ds_read_b32 v192, v194 offset:128
  ds_read_b32 v193, v194 offset:640
  ds_read_b128 v[176:179], v195 offset:0
  ds_read_b128 v[180:183], v195 offset:32
  ds_read_b128 v[184:187], v195 offset:64
  ds_read_b128 v[188:191], v195 offset:96
  s_waitcnt lgkmcnt(0)
  v_pk_mul_f32 v[176:177], v[176:177], v[192:193] op_sel:[0,1] op_sel_hi:[1,1]
  v_pk_mul_f32 v[178:179], v[178:179], v[192:193] op_sel:[0,1] op_sel_hi:[1,1]
  v_pk_mul_f32 v[180:181], v[180:181], v[192:193] op_sel:[0,1] op_sel_hi:[1,1]
  v_pk_mul_f32 v[182:183], v[182:183], v[192:193] op_sel:[0,1] op_sel_hi:[1,1]
  v_pk_mul_f32 v[184:185], v[184:185], v[192:193] op_sel:[0,1] op_sel_hi:[1,1]
  v_pk_mul_f32 v[186:187], v[186:187], v[192:193] op_sel:[0,1] op_sel_hi:[1,1]
  v_pk_mul_f32 v[188:189], v[188:189], v[192:193] op_sel:[0,1] op_sel_hi:[1,1]
  v_pk_mul_f32 v[190:191], v[190:191], v[192:193] op_sel:[0,1] op_sel_hi:[1,1]
  v_pk_fma_f32 v[80:81], v[80:81], v[192:193], v[176:177] op_sel_hi:[1,0,1] neg_lo:[0,0,1] neg_hi:[0,0,1]
  v_pk_fma_f32 v[82:83], v[82:83], v[192:193], v[178:179] op_sel_hi:[1,0,1] neg_lo:[0,0,1] neg_hi:[0,0,1]
  v_pk_fma_f32 v[84:85], v[84:85], v[192:193], v[180:181] op_sel_hi:[1,0,1] neg_lo:[0,0,1] neg_hi:[0,0,1]
  v_pk_fma_f32 v[86:87], v[86:87], v[192:193], v[182:183] op_sel_hi:[1,0,1] neg_lo:[0,0,1] neg_hi:[0,0,1]
  v_pk_fma_f32 v[88:89], v[88:89], v[192:193], v[184:185] op_sel_hi:[1,0,1] neg_lo:[0,0,1] neg_hi:[0,0,1]
  v_pk_fma_f32 v[90:91], v[90:91], v[192:193], v[186:187] op_sel_hi:[1,0,1] neg_lo:[0,0,1] neg_hi:[0,0,1]
  v_pk_fma_f32 v[92:93], v[92:93], v[192:193], v[188:189] op_sel_hi:[1,0,1] neg_lo:[0,0,1] neg_hi:[0,0,1]
  v_pk_fma_f32 v[94:95], v[94:95], v[192:193], v[190:191] op_sel_hi:[1,0,1] neg_lo:[0,0,1] neg_hi:[0,0,1]
  v_pk_mul_f32 v[200:201], v[80:81], v[80:81]
  v_pk_mul_f32 v[202:203], v[82:83], v[82:83]
  v_pk_mul_f32 v[204:205], v[84:85], v[84:85]
  v_pk_mul_f32 v[206:207], v[86:87], v[86:87]
  v_pk_mul_f32 v[208:209], v[88:89], v[88:89]
  v_pk_mul_f32 v[210:211], v[90:91], v[90:91]
  v_pk_mul_f32 v[212:213], v[92:93], v[92:93]
  v_pk_mul_f32 v[214:215], v[94:95], v[94:95]
  v_pk_fma_f32 v[200:201], v[200:201], s[96:97], v[196:197]
  v_pk_fma_f32 v[202:203], v[202:203], s[96:97], v[196:197]
  v_pk_fma_f32 v[204:205], v[204:205], s[96:97], v[196:197]
  v_pk_fma_f32 v[206:207], v[206:207], s[96:97], v[196:197]
  v_pk_fma_f32 v[208:209], v[208:209], s[96:97], v[196:197]
  v_pk_fma_f32 v[210:211], v[210:211], s[96:97], v[196:197]
  v_pk_fma_f32 v[212:213], v[212:213], s[96:97], v[196:197]
  v_pk_fma_f32 v[214:215], v[214:215], s[96:97], v[196:197]
  v_pk_mul_f32 v[200:201], v[200:201], v[80:81]
  v_pk_mul_f32 v[202:203], v[202:203], v[82:83]
  v_pk_mul_f32 v[204:205], v[204:205], v[84:85]
  v_pk_mul_f32 v[206:207], v[206:207], v[86:87]
  v_pk_mul_f32 v[208:209], v[208:209], v[88:89]
  v_pk_mul_f32 v[210:211], v[210:211], v[90:91]
  v_pk_mul_f32 v[212:213], v[212:213], v[92:93]
  v_pk_mul_f32 v[214:215], v[214:215], v[94:95]
  v_exp_f32 v200, v200
  v_exp_f32 v201, v201
  v_exp_f32 v202, v202
  v_exp_f32 v203, v203
  v_exp_f32 v204, v204
  v_exp_f32 v205, v205
  v_exp_f32 v206, v206
  v_exp_f32 v207, v207
  v_exp_f32 v208, v208
  v_exp_f32 v209, v209
  v_exp_f32 v210, v210
  v_exp_f32 v211, v211
  v_exp_f32 v212, v212
  v_exp_f32 v213, v213
  v_exp_f32 v214, v214
  v_exp_f32 v215, v215
  v_pk_add_f32 v[200:201], v[200:201], 1.0 op_sel_hi:[1,0]
  v_pk_add_f32 v[202:203], v[202:203], 1.0 op_sel_hi:[1,0]
  v_pk_add_f32 v[204:205], v[204:205], 1.0 op_sel_hi:[1,0]
  v_pk_add_f32 v[206:207], v[206:207], 1.0 op_sel_hi:[1,0]
  v_pk_add_f32 v[208:209], v[208:209], 1.0 op_sel_hi:[1,0]
  v_pk_add_f32 v[210:211], v[210:211], 1.0 op_sel_hi:[1,0]
  v_pk_add_f32 v[212:213], v[212:213], 1.0 op_sel_hi:[1,0]
  v_pk_add_f32 v[214:215], v[214:215], 1.0 op_sel_hi:[1,0]
  v_rcp_f32 v200, v200
  v_rcp_f32 v201, v201
  v_rcp_f32 v202, v202
  v_rcp_f32 v203, v203
  v_rcp_f32 v204, v204
  v_rcp_f32 v205, v205
  v_rcp_f32 v206, v206
  v_rcp_f32 v207, v207
  v_rcp_f32 v208, v208
  v_rcp_f32 v209, v209
  v_rcp_f32 v210, v210
  v_rcp_f32 v211, v211
  v_rcp_f32 v212, v212
  v_rcp_f32 v213, v213
  v_rcp_f32 v214, v214
  v_rcp_f32 v215, v215
  v_pk_mul_f32 v[80:81], v[80:81], v[200:201]
  v_pk_mul_f32 v[82:83], v[82:83], v[202:203]
  v_pk_mul_f32 v[84:85], v[84:85], v[204:205]
  v_pk_mul_f32 v[86:87], v[86:87], v[206:207]
  v_pk_mul_f32 v[88:89], v[88:89], v[208:209]
  v_pk_mul_f32 v[90:91], v[90:91], v[210:211]
  v_pk_mul_f32 v[92:93], v[92:93], v[212:213]
  v_pk_mul_f32 v[94:95], v[94:95], v[214:215]
  v_cvt_pk_bf16_f32 v216, v80, v81
  v_cvt_pk_bf16_f32 v217, v82, v83
  v_cvt_pk_bf16_f32 v218, v84, v85
  v_cvt_pk_bf16_f32 v219, v86, v87
  v_cvt_pk_bf16_f32 v220, v88, v89
  v_cvt_pk_bf16_f32 v221, v90, v91
  v_cvt_pk_bf16_f32 v222, v92, v93
  v_cvt_pk_bf16_f32 v223, v94, v95
  s_add_u32 s63, s62, 114688
  buffer_store_dwordx4 v[216:219], v12, s[36:39], s63 offen offset:0 sc1
  buffer_store_dwordx4 v[220:223], v12, s[36:39], s63 offen offset:1024 sc1
  ds_read_b32 v192, v194 offset:128
  ds_read_b32 v193, v194 offset:640
  ds_read_b128 v[176:179], v195 offset:128
  ds_read_b128 v[180:183], v195 offset:160
  ds_read_b128 v[184:187], v195 offset:192
  ds_read_b128 v[188:191], v195 offset:224
  s_waitcnt lgkmcnt(0)
  v_pk_mul_f32 v[176:177], v[176:177], v[192:193] op_sel:[0,1] op_sel_hi:[1,1]
  v_pk_mul_f32 v[178:179], v[178:179], v[192:193] op_sel:[0,1] op_sel_hi:[1,1]
  v_pk_mul_f32 v[180:181], v[180:181], v[192:193] op_sel:[0,1] op_sel_hi:[1,1]
  v_pk_mul_f32 v[182:183], v[182:183], v[192:193] op_sel:[0,1] op_sel_hi:[1,1]
  v_pk_mul_f32 v[184:185], v[184:185], v[192:193] op_sel:[0,1] op_sel_hi:[1,1]
  v_pk_mul_f32 v[186:187], v[186:187], v[192:193] op_sel:[0,1] op_sel_hi:[1,1]
  v_pk_mul_f32 v[188:189], v[188:189], v[192:193] op_sel:[0,1] op_sel_hi:[1,1]
  v_pk_mul_f32 v[190:191], v[190:191], v[192:193] op_sel:[0,1] op_sel_hi:[1,1]
  v_pk_fma_f32 v[96:97], v[96:97], v[192:193], v[176:177] op_sel_hi:[1,0,1] neg_lo:[0,0,1] neg_hi:[0,0,1]
  v_pk_fma_f32 v[98:99], v[98:99], v[192:193], v[178:179] op_sel_hi:[1,0,1] neg_lo:[0,0,1] neg_hi:[0,0,1]
  v_pk_fma_f32 v[100:101], v[100:101], v[192:193], v[180:181] op_sel_hi:[1,0,1] neg_lo:[0,0,1] neg_hi:[0,0,1]
  v_pk_fma_f32 v[102:103], v[102:103], v[192:193], v[182:183] op_sel_hi:[1,0,1] neg_lo:[0,0,1] neg_hi:[0,0,1]
  v_pk_fma_f32 v[104:105], v[104:105], v[192:193], v[184:185] op_sel_hi:[1,0,1] neg_lo:[0,0,1] neg_hi:[0,0,1]
  v_pk_fma_f32 v[106:107], v[106:107], v[192:193], v[186:187] op_sel_hi:[1,0,1] neg_lo:[0,0,1] neg_hi:[0,0,1]
  v_pk_fma_f32 v[108:109], v[108:109], v[192:193], v[188:189] op_sel_hi:[1,0,1] neg_lo:[0,0,1] neg_hi:[0,0,1]
  v_pk_fma_f32 v[110:111], v[110:111], v[192:193], v[190:191] op_sel_hi:[1,0,1] neg_lo:[0,0,1] neg_hi:[0,0,1]
  v_pk_mul_f32 v[200:201], v[96:97], v[96:97]
  v_pk_mul_f32 v[202:203], v[98:99], v[98:99]
  v_pk_mul_f32 v[204:205], v[100:101], v[100:101]
  v_pk_mul_f32 v[206:207], v[102:103], v[102:103]
  v_pk_mul_f32 v[208:209], v[104:105], v[104:105]
  v_pk_mul_f32 v[210:211], v[106:107], v[106:107]
  v_pk_mul_f32 v[212:213], v[108:109], v[108:109]
  v_pk_mul_f32 v[214:215], v[110:111], v[110:111]
  v_pk_fma_f32 v[200:201], v[200:201], s[96:97], v[196:197]
  v_pk_fma_f32 v[202:203], v[202:203], s[96:97], v[196:197]
  v_pk_fma_f32 v[204:205], v[204:205], s[96:97], v[196:197]
  v_pk_fma_f32 v[206:207], v[206:207], s[96:97], v[196:197]
  v_pk_fma_f32 v[208:209], v[208:209], s[96:97], v[196:197]
  v_pk_fma_f32 v[210:211], v[210:211], s[96:97], v[196:197]
  v_pk_fma_f32 v[212:213], v[212:213], s[96:97], v[196:197]
  v_pk_fma_f32 v[214:215], v[214:215], s[96:97], v[196:197]
  v_pk_mul_f32 v[200:201], v[200:201], v[96:97]
  v_pk_mul_f32 v[202:203], v[202:203], v[98:99]
  v_pk_mul_f32 v[204:205], v[204:205], v[100:101]
  v_pk_mul_f32 v[206:207], v[206:207], v[102:103]
  v_pk_mul_f32 v[208:209], v[208:209], v[104:105]
  v_pk_mul_f32 v[210:211], v[210:211], v[106:107]
  v_pk_mul_f32 v[212:213], v[212:213], v[108:109]
  v_pk_mul_f32 v[214:215], v[214:215], v[110:111]
  v_exp_f32 v200, v200
  v_exp_f32 v201, v201
  v_exp_f32 v202, v202
  v_exp_f32 v203, v203
  v_exp_f32 v204, v204
  v_exp_f32 v205, v205
  v_exp_f32 v206, v206
  v_exp_f32 v207, v207
  v_exp_f32 v208, v208
  v_exp_f32 v209, v209
  v_exp_f32 v210, v210
  v_exp_f32 v211, v211
  v_exp_f32 v212, v212
  v_exp_f32 v213, v213
  v_exp_f32 v214, v214
  v_exp_f32 v215, v215
  v_pk_add_f32 v[200:201], v[200:201], 1.0 op_sel_hi:[1,0]
  v_pk_add_f32 v[202:203], v[202:203], 1.0 op_sel_hi:[1,0]
  v_pk_add_f32 v[204:205], v[204:205], 1.0 op_sel_hi:[1,0]
  v_pk_add_f32 v[206:207], v[206:207], 1.0 op_sel_hi:[1,0]
  v_pk_add_f32 v[208:209], v[208:209], 1.0 op_sel_hi:[1,0]
  v_pk_add_f32 v[210:211], v[210:211], 1.0 op_sel_hi:[1,0]
  v_pk_add_f32 v[212:213], v[212:213], 1.0 op_sel_hi:[1,0]
  v_pk_add_f32 v[214:215], v[214:215], 1.0 op_sel_hi:[1,0]
  v_rcp_f32 v200, v200
  v_rcp_f32 v201, v201
  v_rcp_f32 v202, v202
  v_rcp_f32 v203, v203
  v_rcp_f32 v204, v204
  v_rcp_f32 v205, v205
  v_rcp_f32 v206, v206
  v_rcp_f32 v207, v207
  v_rcp_f32 v208, v208
  v_rcp_f32 v209, v209
  v_rcp_f32 v210, v210
  v_rcp_f32 v211, v211
  v_rcp_f32 v212, v212
  v_rcp_f32 v213, v213
  v_rcp_f32 v214, v214
  v_rcp_f32 v215, v215
  v_pk_mul_f32 v[96:97], v[96:97], v[200:201]
  v_pk_mul_f32 v[98:99], v[98:99], v[202:203]
  v_pk_mul_f32 v[100:101], v[100:101], v[204:205]
  v_pk_mul_f32 v[102:103], v[102:103], v[206:207]
  v_pk_mul_f32 v[104:105], v[104:105], v[208:209]
  v_pk_mul_f32 v[106:107], v[106:107], v[210:211]
  v_pk_mul_f32 v[108:109], v[108:109], v[212:213]
  v_pk_mul_f32 v[110:111], v[110:111], v[214:215]
  v_cvt_pk_bf16_f32 v224, v96, v97
  v_cvt_pk_bf16_f32 v225, v98, v99
  v_cvt_pk_bf16_f32 v226, v100, v101
  v_cvt_pk_bf16_f32 v227, v102, v103
  v_cvt_pk_bf16_f32 v228, v104, v105
  v_cvt_pk_bf16_f32 v229, v106, v107
  v_cvt_pk_bf16_f32 v230, v108, v109
  v_cvt_pk_bf16_f32 v231, v110, v111
  s_add_u32 s63, s62, 116736
  buffer_store_dwordx4 v[224:227], v12, s[36:39], s63 offen offset:0 sc1
  buffer_store_dwordx4 v[228:231], v12, s[36:39], s63 offen offset:1024 sc1
L_A3_ENTRY_C:
  v_add_u32 v176, 17408, v5
  v_add_u32 v177, 69632, v4
  ds_read_b128 v[112:115], v176 offset:0
  ds_read_b64_tr_b16 v[116:117], v177 offset:0
  ds_read_b64_tr_b16 v[118:119], v177 offset:1024
  ds_read_b128 v[120:123], v176 offset:1024
  ds_read_b64_tr_b16 v[124:125], v177 offset:2048
  ds_read_b64_tr_b16 v[126:127], v177 offset:3072
  ds_read_b128 v[128:131], v176 offset:2048
  ds_read_b64_tr_b16 v[132:133], v177 offset:4096
  ds_read_b64_tr_b16 v[134:135], v177 offset:5120
  ds_read_b128 v[136:139], v176 offset:3072
  ds_read_b64_tr_b16 v[140:141], v177 offset:6144
  ds_read_b64_tr_b16 v[142:143], v177 offset:7168
  s_waitcnt lgkmcnt(9)
  v_mfma_f32_32x32x16_bf16 v[32:47], v[116:119], v[112:115], 0
  ds_read_b128 v[112:115], v176 offset:4096
  ds_read_b64_tr_b16 v[116:117], v177 offset:8192
  ds_read_b64_tr_b16 v[118:119], v177 offset:9216
  s_waitcnt lgkmcnt(9)
  v_mfma_f32_32x32x16_bf16 v[32:47], v[124:127], v[120:123], v[32:47]
  ds_read_b128 v[120:123], v176 offset:5120
  ds_read_b64_tr_b16 v[124:125], v177 offset:10240
  ds_read_b64_tr_b16 v[126:127], v177 offset:11264
  s_waitcnt lgkmcnt(9)
  v_mfma_f32_32x32x16_bf16 v[32:47], v[132:135], v[128:131], v[32:47]
  ds_read_b128 v[128:131], v176 offset:6144
  ds_read_b64_tr_b16 v[132:133], v177 offset:12288
  ds_read_b64_tr_b16 v[134:135], v177 offset:13312
  s_waitcnt lgkmcnt(9)
  v_mfma_f32_32x32x16_bf16 v[32:47], v[140:143], v[136:139], v[32:47]
  ds_read_b128 v[136:139], v176 offset:7168
  ds_read_b64_tr_b16 v[140:141], v177 offset:14336
  ds_read_b64_tr_b16 v[142:143], v177 offset:15360
  s_waitcnt lgkmcnt(9)
  v_mfma_f32_32x32x16_bf16 v[32:47], v[116:119], v[112:115], v[32:47]
  s_waitcnt lgkmcnt(6)
  v_mfma_f32_32x32x16_bf16 v[32:47], v[124:127], v[120:123], v[32:47]
  s_waitcnt lgkmcnt(3)
  v_mfma_f32_32x32x16_bf16 v[32:47], v[132:135], v[128:131], v[32:47]
  s_waitcnt lgkmcnt(0)
  v_mfma_f32_32x32x16_bf16 v[32:47], v[140:143], v[136:139], v[32:47]
  s_barrier
  s_cmp_eq_u32 s57, 1
  s_cbranch_scc1 L_fh_8
  s_waitcnt vmcnt(0)
  s_lshl_b32 s64, s53, 4
  s_add_u32 s64, s64, s54
  s_lshl_b32 s64, s64, 2
  s_add_u32 s64, s64, s44
  s_lshl_b32 s64, s64, 2
  s_add_u32 s64, s64, 21004288
  s_mov_b64 exec, 1
  buffer_store_dword v13, off, s[36:39], s64 sc1
  s_mov_b64 exec, -1
L_fh_8:
  v_add_u32 v176, 34816, v5
  v_add_u32 v177, 86016, v4
  ds_read_b128 v[112:115], v176 offset:0
  ds_read_b64_tr_b16 v[116:117], v177 offset:0
  ds_read_b64_tr_b16 v[118:119], v177 offset:1024
  ds_read_b128 v[120:123], v176 offset:1024
  ds_read_b64_tr_b16 v[124:125], v177 offset:2048
  ds_read_b64_tr_b16 v[126:127], v177 offset:3072
  ds_read_b128 v[128:131], v176 offset:2048
  ds_read_b64_tr_b16 v[132:133], v177 offset:4096
  ds_read_b64_tr_b16 v[134:135], v177 offset:5120
  ds_read_b128 v[136:139], v176 offset:3072
  ds_read_b64_tr_b16 v[140:141], v177 offset:6144
  ds_read_b64_tr_b16 v[142:143], v177 offset:7168
  s_waitcnt lgkmcnt(9)
  v_mfma_f32_32x32x16_bf16 v[32:47], v[116:119], v[112:115], v[32:47]
  ds_read_b128 v[112:115], v176 offset:4096
  ds_read_b64_tr_b16 v[116:117], v177 offset:8192
  ds_read_b64_tr_b16 v[118:119], v177 offset:9216
  s_waitcnt lgkmcnt(9)
  v_mfma_f32_32x32x16_bf16 v[32:47], v[124:127], v[120:123], v[32:47]
  ds_read_b128 v[120:123], v176 offset:5120
  ds_read_b64_tr_b16 v[124:125], v177 offset:10240
  ds_read_b64_tr_b16 v[126:127], v177 offset:11264
  s_waitcnt lgkmcnt(9)
  v_mfma_f32_32x32x16_bf16 v[32:47], v[132:135], v[128:131], v[32:47]
  ds_read_b128 v[128:131], v176 offset:6144
  ds_read_b64_tr_b16 v[132:133], v177 offset:12288
  ds_read_b64_tr_b16 v[134:135], v177 offset:13312
  s_waitcnt lgkmcnt(9)
  v_mfma_f32_32x32x16_bf16 v[32:47], v[140:143], v[136:139], v[32:47]
  ds_read_b128 v[136:139], v176 offset:7168
  ds_read_b64_tr_b16 v[140:141], v177 offset:14336
  ds_read_b64_tr_b16 v[142:143], v177 offset:15360
  s_waitcnt lgkmcnt(9)
  v_mfma_f32_32x32x16_bf16 v[32:47], v[116:119], v[112:115], v[32:47]
  s_waitcnt lgkmcnt(6)
  v_mfma_f32_32x32x16_bf16 v[32:47], v[124:127], v[120:123], v[32:47]
  s_waitcnt lgkmcnt(3)
  v_mfma_f32_32x32x16_bf16 v[32:47], v[132:135], v[128:131], v[32:47]
  s_waitcnt lgkmcnt(0)
  v_mfma_f32_32x32x16_bf16 v[32:47], v[140:143], v[136:139], v[32:47]
  s_barrier
  v_add_u32 v176, 52224, v5
  v_add_u32 v177, 102400, v4
  ds_read_b128 v[112:115], v176 offset:0
  ds_read_b64_tr_b16 v[116:117], v177 offset:0
  ds_read_b64_tr_b16 v[118:119], v177 offset:1024
  ds_read_b128 v[120:123], v176 offset:1024
  ds_read_b64_tr_b16 v[124:125], v177 offset:2048
  ds_read_b64_tr_b16 v[126:127], v177 offset:3072
  ds_read_b128 v[128:131], v176 offset:2048
  ds_read_b64_tr_b16 v[132:133], v177 offset:4096
  ds_read_b64_tr_b16 v[134:135], v177 offset:5120
  ds_read_b128 v[136:139], v176 offset:3072
  ds_read_b64_tr_b16 v[140:141], v177 offset:6144
  ds_read_b64_tr_b16 v[142:143], v177 offset:7168
  s_waitcnt lgkmcnt(9)
  v_mfma_f32_32x32x16_bf16 v[32:47], v[116:119], v[112:115], v[32:47]
  ds_read_b128 v[112:115], v176 offset:4096
  ds_read_b64_tr_b16 v[116:117], v177 offset:8192
  ds_read_b64_tr_b16 v[118:119], v177 offset:9216
  s_waitcnt lgkmcnt(9)
  v_mfma_f32_32x32x16_bf16 v[32:47], v[124:127], v[120:123], v[32:47]
  ds_read_b128 v[120:123], v176 offset:5120
  ds_read_b64_tr_b16 v[124:125], v177 offset:10240
  ds_read_b64_tr_b16 v[126:127], v177 offset:11264
  s_waitcnt lgkmcnt(9)
  v_mfma_f32_32x32x16_bf16 v[32:47], v[132:135], v[128:131], v[32:47]
  ds_read_b128 v[128:131], v176 offset:6144
  ds_read_b64_tr_b16 v[132:133], v177 offset:12288
  ds_read_b64_tr_b16 v[134:135], v177 offset:13312
  s_waitcnt lgkmcnt(9)
  v_mfma_f32_32x32x16_bf16 v[32:47], v[140:143], v[136:139], v[32:47]
  ds_read_b128 v[136:139], v176 offset:7168
  ds_read_b64_tr_b16 v[140:141], v177 offset:14336
  ds_read_b64_tr_b16 v[142:143], v177 offset:15360
  s_waitcnt lgkmcnt(9)
  v_mfma_f32_32x32x16_bf16 v[32:47], v[116:119], v[112:115], v[32:47]
  s_waitcnt lgkmcnt(6)
  v_mfma_f32_32x32x16_bf16 v[32:47], v[124:127], v[120:123], v[32:47]
  s_waitcnt lgkmcnt(3)
  v_mfma_f32_32x32x16_bf16 v[32:47], v[132:135], v[128:131], v[32:47]
  s_waitcnt lgkmcnt(0)
  v_mfma_f32_32x32x16_bf16 v[32:47], v[140:143], v[136:139], v[32:47]
  s_barrier
  v_add_u32 v176, 0, v5
  v_add_u32 v177, 118784, v4
  ds_read_b128 v[112:115], v176 offset:0
  ds_read_b64_tr_b16 v[116:117], v177 offset:0
  ds_read_b64_tr_b16 v[118:119], v177 offset:1024
  ds_read_b128 v[120:123], v176 offset:1024
  ds_read_b64_tr_b16 v[124:125], v177 offset:2048
  ds_read_b64_tr_b16 v[126:127], v177 offset:3072
  ds_read_b128 v[128:131], v176 offset:2048
  ds_read_b64_tr_b16 v[132:133], v177 offset:4096
  ds_read_b64_tr_b16 v[134:135], v177 offset:5120
  ds_read_b128 v[136:139], v176 offset:3072
  ds_read_b64_tr_b16 v[140:141], v177 offset:6144
  ds_read_b64_tr_b16 v[142:143], v177 offset:7168
  s_waitcnt lgkmcnt(9)
  v_mfma_f32_32x32x16_bf16 v[32:47], v[116:119], v[112:115], v[32:47]
  ds_read_b128 v[112:115], v176 offset:4096
  ds_read_b64_tr_b16 v[116:117], v177 offset:8192
  ds_read_b64_tr_b16 v[118:119], v177 offset:9216
  s_waitcnt lgkmcnt(9)
  v_mfma_f32_32x32x16_bf16 v[32:47], v[124:127], v[120:123], v[32:47]
  ds_read_b128 v[120:123], v176 offset:5120
  ds_read_b64_tr_b16 v[124:125], v177 offset:10240
  ds_read_b64_tr_b16 v[126:127], v177 offset:11264
  s_waitcnt lgkmcnt(9)
  v_mfma_f32_32x32x16_bf16 v[32:47], v[132:135], v[128:131], v[32:47]
  ds_read_b128 v[128:131], v176 offset:6144
  ds_read_b64_tr_b16 v[132:133], v177 offset:12288
  ds_read_b64_tr_b16 v[134:135], v177 offset:13312
  s_waitcnt lgkmcnt(9)
  v_mfma_f32_32x32x16_bf16 v[32:47], v[140:143], v[136:139], v[32:47]
  ds_read_b128 v[136:139], v176 offset:7168
  ds_read_b64_tr_b16 v[140:141], v177 offset:14336
  ds_read_b64_tr_b16 v[142:143], v177 offset:15360
  s_waitcnt lgkmcnt(9)
  v_mfma_f32_32x32x16_bf16 v[32:47], v[116:119], v[112:115], v[32:47]
  s_waitcnt lgkmcnt(6)
  v_mfma_f32_32x32x16_bf16 v[32:47], v[124:127], v[120:123], v[32:47]
  s_waitcnt lgkmcnt(3)
  v_mfma_f32_32x32x16_bf16 v[32:47], v[132:135], v[128:131], v[32:47]
  s_waitcnt lgkmcnt(0)
  v_mfma_f32_32x32x16_bf16 v[32:47], v[140:143], v[136:139], v[32:47]
  s_barrier
  v_add_u32 v176, 17408, v5
  v_add_u32 v177, 135168, v4
  ds_read_b128 v[112:115], v176 offset:0
  ds_read_b64_tr_b16 v[116:117], v177 offset:0
  ds_read_b64_tr_b16 v[118:119], v177 offset:1024
  ds_read_b128 v[120:123], v176 offset:1024
  ds_read_b64_tr_b16 v[124:125], v177 offset:2048
  ds_read_b64_tr_b16 v[126:127], v177 offset:3072
  ds_read_b128 v[128:131], v176 offset:2048
  ds_read_b64_tr_b16 v[132:133], v177 offset:4096
  ds_read_b64_tr_b16 v[134:135], v177 offset:5120
  ds_read_b128 v[136:139], v176 offset:3072
  ds_read_b64_tr_b16 v[140:141], v177 offset:6144
  ds_read_b64_tr_b16 v[142:143], v177 offset:7168
  s_waitcnt lgkmcnt(9)
  v_mfma_f32_32x32x16_bf16 v[48:63], v[116:119], v[112:115], 0
  ds_read_b128 v[112:115], v176 offset:4096
  ds_read_b64_tr_b16 v[116:117], v177 offset:8192
  ds_read_b64_tr_b16 v[118:119], v177 offset:9216
  s_waitcnt lgkmcnt(9)
  v_mfma_f32_32x32x16_bf16 v[48:63], v[124:127], v[120:123], v[48:63]
  ds_read_b128 v[120:123], v176 offset:5120
  ds_read_b64_tr_b16 v[124:125], v177 offset:10240
  ds_read_b64_tr_b16 v[126:127], v177 offset:11264
  s_waitcnt lgkmcnt(9)
  v_mfma_f32_32x32x16_bf16 v[48:63], v[132:135], v[128:131], v[48:63]
  ds_read_b128 v[128:131], v176 offset:6144
  ds_read_b64_tr_b16 v[132:133], v177 offset:12288
  ds_read_b64_tr_b16 v[134:135], v177 offset:13312
  s_waitcnt lgkmcnt(9)
  v_mfma_f32_32x32x16_bf16 v[48:63], v[140:143], v[136:139], v[48:63]
  ds_read_b128 v[136:139], v176 offset:7168
  ds_read_b64_tr_b16 v[140:141], v177 offset:14336
  ds_read_b64_tr_b16 v[142:143], v177 offset:15360
  s_waitcnt lgkmcnt(9)
  v_mfma_f32_32x32x16_bf16 v[48:63], v[116:119], v[112:115], v[48:63]
  s_waitcnt lgkmcnt(6)
  v_mfma_f32_32x32x16_bf16 v[48:63], v[124:127], v[120:123], v[48:63]
  s_waitcnt lgkmcnt(3)
  v_mfma_f32_32x32x16_bf16 v[48:63], v[132:135], v[128:131], v[48:63]
  s_waitcnt lgkmcnt(0)
  v_mfma_f32_32x32x16_bf16 v[48:63], v[140:143], v[136:139], v[48:63]
  s_barrier
  v_add_u32 v176, 34816, v5
  v_add_u32 v177, 69632, v4
  ds_read_b128 v[112:115], v176 offset:0
  ds_read_b64_tr_b16 v[116:117], v177 offset:0
  ds_read_b64_tr_b16 v[118:119], v177 offset:1024
  ds_read_b128 v[120:123], v176 offset:1024
  ds_read_b64_tr_b16 v[124:125], v177 offset:2048
  ds_read_b64_tr_b16 v[126:127], v177 offset:3072
  ds_read_b128 v[128:131], v176 offset:2048
  ds_read_b64_tr_b16 v[132:133], v177 offset:4096
  ds_read_b64_tr_b16 v[134:135], v177 offset:5120
  ds_read_b128 v[136:139], v176 offset:3072
  ds_read_b64_tr_b16 v[140:141], v177 offset:6144
  ds_read_b64_tr_b16 v[142:143], v177 offset:7168
  s_waitcnt lgkmcnt(9)
  v_mfma_f32_32x32x16_bf16 v[48:63], v[116:119], v[112:115], v[48:63]
  ds_read_b128 v[112:115], v176 offset:4096
  ds_read_b64_tr_b16 v[116:117], v177 offset:8192
  ds_read_b64_tr_b16 v[118:119], v177 offset:9216
  s_waitcnt lgkmcnt(9)
  v_mfma_f32_32x32x16_bf16 v[48:63], v[124:127], v[120:123], v[48:63]
  ds_read_b128 v[120:123], v176 offset:5120
  ds_read_b64_tr_b16 v[124:125], v177 offset:10240
  ds_read_b64_tr_b16 v[126:127], v177 offset:11264
  s_waitcnt lgkmcnt(9)
  v_mfma_f32_32x32x16_bf16 v[48:63], v[132:135], v[128:131], v[48:63]
  ds_read_b128 v[128:131], v176 offset:6144
  ds_read_b64_tr_b16 v[132:133], v177 offset:12288
  ds_read_b64_tr_b16 v[134:135], v177 offset:13312
  s_waitcnt lgkmcnt(9)
  v_mfma_f32_32x32x16_bf16 v[48:63], v[140:143], v[136:139], v[48:63]
  ds_read_b128 v[136:139], v176 offset:7168
  ds_read_b64_tr_b16 v[140:141], v177 offset:14336
  ds_read_b64_tr_b16 v[142:143], v177 offset:15360
  s_waitcnt lgkmcnt(9)
  v_mfma_f32_32x32x16_bf16 v[48:63], v[116:119], v[112:115], v[48:63]
  s_waitcnt lgkmcnt(6)
  v_mfma_f32_32x32x16_bf16 v[48:63], v[124:127], v[120:123], v[48:63]
  s_waitcnt lgkmcnt(3)
  v_mfma_f32_32x32x16_bf16 v[48:63], v[132:135], v[128:131], v[48:63]
  s_waitcnt lgkmcnt(0)
  v_mfma_f32_32x32x16_bf16 v[48:63], v[140:143], v[136:139], v[48:63]
  s_barrier
  v_add_u32 v176, 52224, v5
  v_add_u32 v177, 86016, v4
  ds_read_b128 v[112:115], v176 offset:0
  ds_read_b64_tr_b16 v[116:117], v177 offset:0
  ds_read_b64_tr_b16 v[118:119], v177 offset:1024
  ds_read_b128 v[120:123], v176 offset:1024
  ds_read_b64_tr_b16 v[124:125], v177 offset:2048
  ds_read_b64_tr_b16 v[126:127], v177 offset:3072
  ds_read_b128 v[128:131], v176 offset:2048
  ds_read_b64_tr_b16 v[132:133], v177 offset:4096
  ds_read_b64_tr_b16 v[134:135], v177 offset:5120
  ds_read_b128 v[136:139], v176 offset:3072
  ds_read_b64_tr_b16 v[140:141], v177 offset:6144
  ds_read_b64_tr_b16 v[142:143], v177 offset:7168
  s_waitcnt lgkmcnt(9)
  v_mfma_f32_32x32x16_bf16 v[48:63], v[116:119], v[112:115], v[48:63]
  ds_read_b128 v[112:115], v176 offset:4096
  ds_read_b64_tr_b16 v[116:117], v177 offset:8192
  ds_read_b64_tr_b16 v[118:119], v177 offset:9216
  s_waitcnt lgkmcnt(9)
  v_mfma_f32_32x32x16_bf16 v[48:63], v[124:127], v[120:123], v[48:63]
  ds_read_b128 v[120:123], v176 offset:5120
  ds_read_b64_tr_b16 v[124:125], v177 offset:10240
  ds_read_b64_tr_b16 v[126:127], v177 offset:11264
  s_waitcnt lgkmcnt(9)
  v_mfma_f32_32x32x16_bf16 v[48:63], v[132:135], v[128:131], v[48:63]
  ds_read_b128 v[128:131], v176 offset:6144
  ds_read_b64_tr_b16 v[132:133], v177 offset:12288
  ds_read_b64_tr_b16 v[134:135], v177 offset:13312
  s_waitcnt lgkmcnt(9)
  v_mfma_f32_32x32x16_bf16 v[48:63], v[140:143], v[136:139], v[48:63]
  ds_read_b128 v[136:139], v176 offset:7168
  ds_read_b64_tr_b16 v[140:141], v177 offset:14336
  ds_read_b64_tr_b16 v[142:143], v177 offset:15360
  s_waitcnt lgkmcnt(9)
  v_mfma_f32_32x32x16_bf16 v[48:63], v[116:119], v[112:115], v[48:63]
  s_waitcnt lgkmcnt(6)
  v_mfma_f32_32x32x16_bf16 v[48:63], v[124:127], v[120:123], v[48:63]
  s_waitcnt lgkmcnt(3)
  v_mfma_f32_32x32x16_bf16 v[48:63], v[132:135], v[128:131], v[48:63]
  s_waitcnt lgkmcnt(0)
  v_mfma_f32_32x32x16_bf16 v[48:63], v[140:143], v[136:139], v[48:63]
  s_barrier
  v_add_u32 v176, 0, v5
  v_add_u32 v177, 102400, v4
  ds_read_b128 v[112:115], v176 offset:0
  ds_read_b64_tr_b16 v[116:117], v177 offset:0
  ds_read_b64_tr_b16 v[118:119], v177 offset:1024
  ds_read_b128 v[120:123], v176 offset:1024
  ds_read_b64_tr_b16 v[124:125], v177 offset:2048
  ds_read_b64_tr_b16 v[126:127], v177 offset:3072
  ds_read_b128 v[128:131], v176 offset:2048
  ds_read_b64_tr_b16 v[132:133], v177 offset:4096
  ds_read_b64_tr_b16 v[134:135], v177 offset:5120
  ds_read_b128 v[136:139], v176 offset:3072
  ds_read_b64_tr_b16 v[140:141], v177 offset:6144
  ds_read_b64_tr_b16 v[142:143], v177 offset:7168
  s_waitcnt lgkmcnt(9)
  v_mfma_f32_32x32x16_bf16 v[48:63], v[116:119], v[112:115], v[48:63]
  ds_read_b128 v[112:115], v176 offset:4096
  ds_read_b64_tr_b16 v[116:117], v177 offset:8192
  ds_read_b64_tr_b16 v[118:119], v177 offset:9216
  s_waitcnt lgkmcnt(9)
  v_mfma_f32_32x32x16_bf16 v[48:63], v[124:127], v[120:123], v[48:63]
  ds_read_b128 v[120:123], v176 offset:5120
  ds_read_b64_tr_b16 v[124:125], v177 offset:10240
  ds_read_b64_tr_b16 v[126:127], v177 offset:11264
  s_waitcnt lgkmcnt(9)
  v_mfma_f32_32x32x16_bf16 v[48:63], v[132:135], v[128:131], v[48:63]
  ds_read_b128 v[128:131], v176 offset:6144
  ds_read_b64_tr_b16 v[132:133], v177 offset:12288
  ds_read_b64_tr_b16 v[134:135], v177 offset:13312
  s_waitcnt lgkmcnt(9)
  v_mfma_f32_32x32x16_bf16 v[48:63], v[140:143], v[136:139], v[48:63]
  ds_read_b128 v[136:139], v176 offset:7168
  ds_read_b64_tr_b16 v[140:141], v177 offset:14336
  ds_read_b64_tr_b16 v[142:143], v177 offset:15360
  s_waitcnt lgkmcnt(9)
  v_mfma_f32_32x32x16_bf16 v[48:63], v[116:119], v[112:115], v[48:63]
  s_waitcnt lgkmcnt(6)
  v_mfma_f32_32x32x16_bf16 v[48:63], v[124:127], v[120:123], v[48:63]
  s_waitcnt lgkmcnt(3)
  v_mfma_f32_32x32x16_bf16 v[48:63], v[132:135], v[128:131], v[48:63]
  s_waitcnt lgkmcnt(0)
  v_mfma_f32_32x32x16_bf16 v[48:63], v[140:143], v[136:139], v[48:63]
  s_barrier
  v_add_u32 v176, 17408, v5
  v_add_u32 v177, 118784, v4
  ds_read_b128 v[112:115], v176 offset:0
  ds_read_b64_tr_b16 v[116:117], v177 offset:0
  ds_read_b64_tr_b16 v[118:119], v177 offset:1024
  ds_read_b128 v[120:123], v176 offset:1024
  ds_read_b64_tr_b16 v[124:125], v177 offset:2048
  ds_read_b64_tr_b16 v[126:127], v177 offset:3072
  ds_read_b128 v[128:131], v176 offset:2048
  ds_read_b64_tr_b16 v[132:133], v177 offset:4096
  ds_read_b64_tr_b16 v[134:135], v177 offset:5120
  ds_read_b128 v[136:139], v176 offset:3072
  ds_read_b64_tr_b16 v[140:141], v177 offset:6144
  ds_read_b64_tr_b16 v[142:143], v177 offset:7168
  s_waitcnt lgkmcnt(9)
  v_mfma_f32_32x32x16_bf16 v[48:63], v[116:119], v[112:115], v[48:63]
  ds_read_b128 v[112:115], v176 offset:4096
  ds_read_b64_tr_b16 v[116:117], v177 offset:8192
  ds_read_b64_tr_b16 v[118:119], v177 offset:9216
  s_waitcnt lgkmcnt(9)
  v_mfma_f32_32x32x16_bf16 v[48:63], v[124:127], v[120:123], v[48:63]
  ds_read_b128 v[120:123], v176 offset:5120
  ds_read_b64_tr_b16 v[124:125], v177 offset:10240
  ds_read_b64_tr_b16 v[126:127], v177 offset:11264
  s_waitcnt lgkmcnt(9)
  v_mfma_f32_32x32x16_bf16 v[48:63], v[132:135], v[128:131], v[48:63]
  ds_read_b128 v[128:131], v176 offset:6144
  ds_read_b64_tr_b16 v[132:133], v177 offset:12288
  ds_read_b64_tr_b16 v[134:135], v177 offset:13312
  s_waitcnt lgkmcnt(9)
  v_mfma_f32_32x32x16_bf16 v[48:63], v[140:143], v[136:139], v[48:63]
  ds_read_b128 v[136:139], v176 offset:7168
  ds_read_b64_tr_b16 v[140:141], v177 offset:14336
  ds_read_b64_tr_b16 v[142:143], v177 offset:15360
  s_waitcnt lgkmcnt(9)
  v_mfma_f32_32x32x16_bf16 v[48:63], v[116:119], v[112:115], v[48:63]
  s_waitcnt lgkmcnt(6)
  v_mfma_f32_32x32x16_bf16 v[48:63], v[124:127], v[120:123], v[48:63]
  s_waitcnt lgkmcnt(3)
  v_mfma_f32_32x32x16_bf16 v[48:63], v[132:135], v[128:131], v[48:63]
  s_waitcnt lgkmcnt(0)
  v_mfma_f32_32x32x16_bf16 v[48:63], v[140:143], v[136:139], v[48:63]
  s_barrier
  v_add_u32 v176, 34816, v5
  v_add_u32 v177, 135168, v4
  ds_read_b128 v[112:115], v176 offset:0
  ds_read_b64_tr_b16 v[116:117], v177 offset:0
  ds_read_b64_tr_b16 v[118:119], v177 offset:1024
  ds_read_b128 v[120:123], v176 offset:1024
  ds_read_b64_tr_b16 v[124:125], v177 offset:2048
  ds_read_b64_tr_b16 v[126:127], v177 offset:3072
  ds_read_b128 v[128:131], v176 offset:2048
  ds_read_b64_tr_b16 v[132:133], v177 offset:4096
  ds_read_b64_tr_b16 v[134:135], v177 offset:5120
  ds_read_b128 v[136:139], v176 offset:3072
  ds_read_b64_tr_b16 v[140:141], v177 offset:6144
  ds_read_b64_tr_b16 v[142:143], v177 offset:7168
  s_waitcnt lgkmcnt(9)
  v_mfma_f32_32x32x16_bf16 v[48:63], v[116:119], v[112:115], v[48:63]
  ds_read_b128 v[112:115], v176 offset:4096
  ds_read_b64_tr_b16 v[116:117], v177 offset:8192
  ds_read_b64_tr_b16 v[118:119], v177 offset:9216
  s_waitcnt lgkmcnt(9)
  v_mfma_f32_32x32x16_bf16 v[48:63], v[124:127], v[120:123], v[48:63]
  ds_read_b128 v[120:123], v176 offset:5120
  ds_read_b64_tr_b16 v[124:125], v177 offset:10240
  ds_read_b64_tr_b16 v[126:127], v177 offset:11264
  s_waitcnt lgkmcnt(9)
  v_mfma_f32_32x32x16_bf16 v[48:63], v[132:135], v[128:131], v[48:63]
  ds_read_b128 v[128:131], v176 offset:6144
  ds_read_b64_tr_b16 v[132:133], v177 offset:12288
  ds_read_b64_tr_b16 v[134:135], v177 offset:13312
  s_waitcnt lgkmcnt(9)
  v_mfma_f32_32x32x16_bf16 v[48:63], v[140:143], v[136:139], v[48:63]
  ds_read_b128 v[136:139], v176 offset:7168
  ds_read_b64_tr_b16 v[140:141], v177 offset:14336
  ds_read_b64_tr_b16 v[142:143], v177 offset:15360
  s_waitcnt lgkmcnt(9)
  v_mfma_f32_32x32x16_bf16 v[48:63], v[116:119], v[112:115], v[48:63]
  s_waitcnt lgkmcnt(6)
  v_mfma_f32_32x32x16_bf16 v[48:63], v[124:127], v[120:123], v[48:63]
  s_waitcnt lgkmcnt(3)
  v_mfma_f32_32x32x16_bf16 v[48:63], v[132:135], v[128:131], v[48:63]
  s_waitcnt lgkmcnt(0)
  v_mfma_f32_32x32x16_bf16 v[48:63], v[140:143], v[136:139], v[48:63]
  s_barrier
  v_add_u32 v176, 52224, v5
  v_add_u32 v177, 69632, v4
  ds_read_b128 v[112:115], v176 offset:0
  ds_read_b64_tr_b16 v[116:117], v177 offset:0
  ds_read_b64_tr_b16 v[118:119], v177 offset:1024
  ds_read_b128 v[120:123], v176 offset:1024
  ds_read_b64_tr_b16 v[124:125], v177 offset:2048
  ds_read_b64_tr_b16 v[126:127], v177 offset:3072
  ds_read_b128 v[128:131], v176 offset:2048
  ds_read_b64_tr_b16 v[132:133], v177 offset:4096
  ds_read_b64_tr_b16 v[134:135], v177 offset:5120
  ds_read_b128 v[136:139], v176 offset:3072
  ds_read_b64_tr_b16 v[140:141], v177 offset:6144
  ds_read_b64_tr_b16 v[142:143], v177 offset:7168
  s_waitcnt lgkmcnt(9)
  v_mfma_f32_32x32x16_bf16 v[48:63], v[116:119], v[112:115], v[48:63]
  ds_read_b128 v[112:115], v176 offset:4096
  ds_read_b64_tr_b16 v[116:117], v177 offset:8192
  ds_read_b64_tr_b16 v[118:119], v177 offset:9216
  s_waitcnt lgkmcnt(9)
  v_mfma_f32_32x32x16_bf16 v[48:63], v[124:127], v[120:123], v[48:63]
  ds_read_b128 v[120:123], v176 offset:5120
  ds_read_b64_tr_b16 v[124:125], v177 offset:10240
  ds_read_b64_tr_b16 v[126:127], v177 offset:11264
  s_waitcnt lgkmcnt(9)
  v_mfma_f32_32x32x16_bf16 v[48:63], v[132:135], v[128:131], v[48:63]
  ds_read_b128 v[128:131], v176 offset:6144
  ds_read_b64_tr_b16 v[132:133], v177 offset:12288
  ds_read_b64_tr_b16 v[134:135], v177 offset:13312
  s_waitcnt lgkmcnt(9)
  v_mfma_f32_32x32x16_bf16 v[48:63], v[140:143], v[136:139], v[48:63]
  ds_read_b128 v[136:139], v176 offset:7168
  ds_read_b64_tr_b16 v[140:141], v177 offset:14336
  ds_read_b64_tr_b16 v[142:143], v177 offset:15360
  s_waitcnt lgkmcnt(9)
  v_mfma_f32_32x32x16_bf16 v[48:63], v[116:119], v[112:115], v[48:63]
  s_waitcnt lgkmcnt(6)
  v_mfma_f32_32x32x16_bf16 v[48:63], v[124:127], v[120:123], v[48:63]
  s_waitcnt lgkmcnt(3)
  v_mfma_f32_32x32x16_bf16 v[48:63], v[132:135], v[128:131], v[48:63]
  s_waitcnt lgkmcnt(0)
  v_mfma_f32_32x32x16_bf16 v[48:63], v[140:143], v[136:139], v[48:63]
  s_barrier
  v_add_u32 v176, 0, v5
  v_add_u32 v177, 86016, v4
  ds_read_b128 v[112:115], v176 offset:0
  ds_read_b64_tr_b16 v[116:117], v177 offset:0
  ds_read_b64_tr_b16 v[118:119], v177 offset:1024
  ds_read_b128 v[120:123], v176 offset:1024
  ds_read_b64_tr_b16 v[124:125], v177 offset:2048
  ds_read_b64_tr_b16 v[126:127], v177 offset:3072
  ds_read_b128 v[128:131], v176 offset:2048
  ds_read_b64_tr_b16 v[132:133], v177 offset:4096
  ds_read_b64_tr_b16 v[134:135], v177 offset:5120
  ds_read_b128 v[136:139], v176 offset:3072
  ds_read_b64_tr_b16 v[140:141], v177 offset:6144
  ds_read_b64_tr_b16 v[142:143], v177 offset:7168
  s_waitcnt lgkmcnt(9)
  v_mfma_f32_32x32x16_bf16 v[48:63], v[116:119], v[112:115], v[48:63]
  ds_read_b128 v[112:115], v176 offset:4096
  ds_read_b64_tr_b16 v[116:117], v177 offset:8192
  ds_read_b64_tr_b16 v[118:119], v177 offset:9216
  s_waitcnt lgkmcnt(9)
  v_mfma_f32_32x32x16_bf16 v[48:63], v[124:127], v[120:123], v[48:63]
  ds_read_b128 v[120:123], v176 offset:5120
  ds_read_b64_tr_b16 v[124:125], v177 offset:10240
  ds_read_b64_tr_b16 v[126:127], v177 offset:11264
  s_waitcnt lgkmcnt(9)
  v_mfma_f32_32x32x16_bf16 v[48:63], v[132:135], v[128:131], v[48:63]
  ds_read_b128 v[128:131], v176 offset:6144
  ds_read_b64_tr_b16 v[132:133], v177 offset:12288
  ds_read_b64_tr_b16 v[134:135], v177 offset:13312
  s_waitcnt lgkmcnt(9)
  v_mfma_f32_32x32x16_bf16 v[48:63], v[140:143], v[136:139], v[48:63]
  ds_read_b128 v[136:139], v176 offset:7168
  ds_read_b64_tr_b16 v[140:141], v177 offset:14336
  ds_read_b64_tr_b16 v[142:143], v177 offset:15360
  s_waitcnt lgkmcnt(9)
  v_mfma_f32_32x32x16_bf16 v[48:63], v[116:119], v[112:115], v[48:63]
  s_waitcnt lgkmcnt(6)
  v_mfma_f32_32x32x16_bf16 v[48:63], v[124:127], v[120:123], v[48:63]
  s_waitcnt lgkmcnt(3)
  v_mfma_f32_32x32x16_bf16 v[48:63], v[132:135], v[128:131], v[48:63]
  s_waitcnt lgkmcnt(0)
  v_mfma_f32_32x32x16_bf16 v[48:63], v[140:143], v[136:139], v[48:63]
  s_barrier
  v_add_u32 v176, 17408, v5
  v_add_u32 v177, 102400, v4
  ds_read_b128 v[112:115], v176 offset:0
  ds_read_b64_tr_b16 v[116:117], v177 offset:0
  ds_read_b64_tr_b16 v[118:119], v177 offset:1024
  ds_read_b128 v[120:123], v176 offset:1024
  ds_read_b64_tr_b16 v[124:125], v177 offset:2048
  ds_read_b64_tr_b16 v[126:127], v177 offset:3072
  ds_read_b128 v[128:131], v176 offset:2048
  ds_read_b64_tr_b16 v[132:133], v177 offset:4096
  ds_read_b64_tr_b16 v[134:135], v177 offset:5120
  ds_read_b128 v[136:139], v176 offset:3072
  ds_read_b64_tr_b16 v[140:141], v177 offset:6144
  ds_read_b64_tr_b16 v[142:143], v177 offset:7168
  s_waitcnt lgkmcnt(9)
  v_mfma_f32_32x32x16_bf16 v[48:63], v[116:119], v[112:115], v[48:63]
  ds_read_b128 v[112:115], v176 offset:4096
  ds_read_b64_tr_b16 v[116:117], v177 offset:8192
  ds_read_b64_tr_b16 v[118:119], v177 offset:9216
  s_waitcnt lgkmcnt(9)
  v_mfma_f32_32x32x16_bf16 v[48:63], v[124:127], v[120:123], v[48:63]
  ds_read_b128 v[120:123], v176 offset:5120
  ds_read_b64_tr_b16 v[124:125], v177 offset:10240
  ds_read_b64_tr_b16 v[126:127], v177 offset:11264
  s_waitcnt lgkmcnt(9)
  v_mfma_f32_32x32x16_bf16 v[48:63], v[132:135], v[128:131], v[48:63]
  ds_read_b128 v[128:131], v176 offset:6144
  ds_read_b64_tr_b16 v[132:133], v177 offset:12288
  ds_read_b64_tr_b16 v[134:135], v177 offset:13312
  s_waitcnt lgkmcnt(9)
  v_mfma_f32_32x32x16_bf16 v[48:63], v[140:143], v[136:139], v[48:63]
  ds_read_b128 v[136:139], v176 offset:7168
  ds_read_b64_tr_b16 v[140:141], v177 offset:14336
  ds_read_b64_tr_b16 v[142:143], v177 offset:15360
  s_waitcnt lgkmcnt(9)
  v_mfma_f32_32x32x16_bf16 v[48:63], v[116:119], v[112:115], v[48:63]
  s_waitcnt lgkmcnt(6)
  v_mfma_f32_32x32x16_bf16 v[48:63], v[124:127], v[120:123], v[48:63]
  s_waitcnt lgkmcnt(3)
  v_mfma_f32_32x32x16_bf16 v[48:63], v[132:135], v[128:131], v[48:63]
  s_waitcnt lgkmcnt(0)
  v_mfma_f32_32x32x16_bf16 v[48:63], v[140:143], v[136:139], v[48:63]
  s_barrier
  v_add_u32 v176, 34816, v5
  v_add_u32 v177, 118784, v4
  ds_read_b128 v[112:115], v176 offset:0
  ds_read_b64_tr_b16 v[116:117], v177 offset:0
  ds_read_b64_tr_b16 v[118:119], v177 offset:1024
  ds_read_b128 v[120:123], v176 offset:1024
  ds_read_b64_tr_b16 v[124:125], v177 offset:2048
  ds_read_b64_tr_b16 v[126:127], v177 offset:3072
  ds_read_b128 v[128:131], v176 offset:2048
  ds_read_b64_tr_b16 v[132:133], v177 offset:4096
  ds_read_b64_tr_b16 v[134:135], v177 offset:5120
  ds_read_b128 v[136:139], v176 offset:3072
  ds_read_b64_tr_b16 v[140:141], v177 offset:6144
  ds_read_b64_tr_b16 v[142:143], v177 offset:7168
  s_waitcnt lgkmcnt(9)
  v_mfma_f32_32x32x16_bf16 v[48:63], v[116:119], v[112:115], v[48:63]
  ds_read_b128 v[112:115], v176 offset:4096
  ds_read_b64_tr_b16 v[116:117], v177 offset:8192
  ds_read_b64_tr_b16 v[118:119], v177 offset:9216
  s_waitcnt lgkmcnt(9)
  v_mfma_f32_32x32x16_bf16 v[48:63], v[124:127], v[120:123], v[48:63]
  ds_read_b128 v[120:123], v176 offset:5120
  ds_read_b64_tr_b16 v[124:125], v177 offset:10240
  ds_read_b64_tr_b16 v[126:127], v177 offset:11264
  s_waitcnt lgkmcnt(9)
  v_mfma_f32_32x32x16_bf16 v[48:63], v[132:135], v[128:131], v[48:63]
  ds_read_b128 v[128:131], v176 offset:6144
  ds_read_b64_tr_b16 v[132:133], v177 offset:12288
  ds_read_b64_tr_b16 v[134:135], v177 offset:13312
  s_waitcnt lgkmcnt(9)
  v_mfma_f32_32x32x16_bf16 v[48:63], v[140:143], v[136:139], v[48:63]
  ds_read_b128 v[136:139], v176 offset:7168
  ds_read_b64_tr_b16 v[140:141], v177 offset:14336
  ds_read_b64_tr_b16 v[142:143], v177 offset:15360
  s_waitcnt lgkmcnt(9)
  v_mfma_f32_32x32x16_bf16 v[48:63], v[116:119], v[112:115], v[48:63]
  s_waitcnt lgkmcnt(6)
  v_mfma_f32_32x32x16_bf16 v[48:63], v[124:127], v[120:123], v[48:63]
  s_waitcnt lgkmcnt(3)
  v_mfma_f32_32x32x16_bf16 v[48:63], v[132:135], v[128:131], v[48:63]
  s_waitcnt lgkmcnt(0)
  v_mfma_f32_32x32x16_bf16 v[48:63], v[140:143], v[136:139], v[48:63]
  s_barrier
  v_add_u32 v176, 52224, v5
  v_add_u32 v177, 135168, v4
  ds_read_b128 v[112:115], v176 offset:0
  ds_read_b64_tr_b16 v[116:117], v177 offset:0
  ds_read_b64_tr_b16 v[118:119], v177 offset:1024
  ds_read_b128 v[120:123], v176 offset:1024
  ds_read_b64_tr_b16 v[124:125], v177 offset:2048
  ds_read_b64_tr_b16 v[126:127], v177 offset:3072
  ds_read_b128 v[128:131], v176 offset:2048
  ds_read_b64_tr_b16 v[132:133], v177 offset:4096
  ds_read_b64_tr_b16 v[134:135], v177 offset:5120
  ds_read_b128 v[136:139], v176 offset:3072
  ds_read_b64_tr_b16 v[140:141], v177 offset:6144
  ds_read_b64_tr_b16 v[142:143], v177 offset:7168
  s_waitcnt lgkmcnt(9)
  v_mfma_f32_32x32x16_bf16 v[48:63], v[116:119], v[112:115], v[48:63]
  ds_read_b128 v[112:115], v176 offset:4096
  ds_read_b64_tr_b16 v[116:117], v177 offset:8192
  ds_read_b64_tr_b16 v[118:119], v177 offset:9216
  s_waitcnt lgkmcnt(9)
  v_mfma_f32_32x32x16_bf16 v[48:63], v[124:127], v[120:123], v[48:63]
  ds_read_b128 v[120:123], v176 offset:5120
  ds_read_b64_tr_b16 v[124:125], v177 offset:10240
  ds_read_b64_tr_b16 v[126:127], v177 offset:11264
  s_waitcnt lgkmcnt(9)
  v_mfma_f32_32x32x16_bf16 v[48:63], v[132:135], v[128:131], v[48:63]
  ds_read_b128 v[128:131], v176 offset:6144
  ds_read_b64_tr_b16 v[132:133], v177 offset:12288
  ds_read_b64_tr_b16 v[134:135], v177 offset:13312
  s_waitcnt lgkmcnt(9)
  v_mfma_f32_32x32x16_bf16 v[48:63], v[140:143], v[136:139], v[48:63]
  ds_read_b128 v[136:139], v176 offset:7168
  ds_read_b64_tr_b16 v[140:141], v177 offset:14336
  ds_read_b64_tr_b16 v[142:143], v177 offset:15360
  s_waitcnt lgkmcnt(9)
  v_mfma_f32_32x32x16_bf16 v[48:63], v[116:119], v[112:115], v[48:63]
  s_waitcnt lgkmcnt(6)
  v_mfma_f32_32x32x16_bf16 v[48:63], v[124:127], v[120:123], v[48:63]
  s_waitcnt lgkmcnt(3)
  v_mfma_f32_32x32x16_bf16 v[48:63], v[132:135], v[128:131], v[48:63]
  s_waitcnt lgkmcnt(0)
  v_mfma_f32_32x32x16_bf16 v[48:63], v[140:143], v[136:139], v[48:63]
  s_barrier
  v_add_u32 v176, 0, v5
  v_add_u32 v177, 69632, v4
  ds_read_b128 v[112:115], v176 offset:0
  ds_read_b64_tr_b16 v[116:117], v177 offset:0
  ds_read_b64_tr_b16 v[118:119], v177 offset:1024
  ds_read_b128 v[120:123], v176 offset:1024
  ds_read_b64_tr_b16 v[124:125], v177 offset:2048
  ds_read_b64_tr_b16 v[126:127], v177 offset:3072
  ds_read_b128 v[128:131], v176 offset:2048
  ds_read_b64_tr_b16 v[132:133], v177 offset:4096
  ds_read_b64_tr_b16 v[134:135], v177 offset:5120
  ds_read_b128 v[136:139], v176 offset:3072
  ds_read_b64_tr_b16 v[140:141], v177 offset:6144
  ds_read_b64_tr_b16 v[142:143], v177 offset:7168
  s_waitcnt lgkmcnt(9)
  v_mfma_f32_32x32x16_bf16 v[48:63], v[116:119], v[112:115], v[48:63]
  ds_read_b128 v[112:115], v176 offset:4096
  ds_read_b64_tr_b16 v[116:117], v177 offset:8192
  ds_read_b64_tr_b16 v[118:119], v177 offset:9216
  s_waitcnt lgkmcnt(9)
  v_mfma_f32_32x32x16_bf16 v[48:63], v[124:127], v[120:123], v[48:63]
  ds_read_b128 v[120:123], v176 offset:5120
  ds_read_b64_tr_b16 v[124:125], v177 offset:10240
  ds_read_b64_tr_b16 v[126:127], v177 offset:11264
  s_waitcnt lgkmcnt(9)
  v_mfma_f32_32x32x16_bf16 v[48:63], v[132:135], v[128:131], v[48:63]
  ds_read_b128 v[128:131], v176 offset:6144
  ds_read_b64_tr_b16 v[132:133], v177 offset:12288
  ds_read_b64_tr_b16 v[134:135], v177 offset:13312
  s_waitcnt lgkmcnt(9)
  v_mfma_f32_32x32x16_bf16 v[48:63], v[140:143], v[136:139], v[48:63]
  ds_read_b128 v[136:139], v176 offset:7168
  ds_read_b64_tr_b16 v[140:141], v177 offset:14336
  ds_read_b64_tr_b16 v[142:143], v177 offset:15360
  s_waitcnt lgkmcnt(9)
  v_mfma_f32_32x32x16_bf16 v[48:63], v[116:119], v[112:115], v[48:63]
  s_waitcnt lgkmcnt(6)
  v_mfma_f32_32x32x16_bf16 v[48:63], v[124:127], v[120:123], v[48:63]
  s_waitcnt lgkmcnt(3)
  v_mfma_f32_32x32x16_bf16 v[48:63], v[132:135], v[128:131], v[48:63]
  s_waitcnt lgkmcnt(0)
  v_mfma_f32_32x32x16_bf16 v[48:63], v[140:143], v[136:139], v[48:63]
  s_barrier
  v_add_u32 v176, 17408, v5
  v_add_u32 v177, 86016, v4
  ds_read_b128 v[112:115], v176 offset:0
  ds_read_b64_tr_b16 v[116:117], v177 offset:0
  ds_read_b64_tr_b16 v[118:119], v177 offset:1024
  ds_read_b128 v[120:123], v176 offset:1024
  ds_read_b64_tr_b16 v[124:125], v177 offset:2048
  ds_read_b64_tr_b16 v[126:127], v177 offset:3072
  ds_read_b128 v[128:131], v176 offset:2048
  ds_read_b64_tr_b16 v[132:133], v177 offset:4096
  ds_read_b64_tr_b16 v[134:135], v177 offset:5120
  ds_read_b128 v[136:139], v176 offset:3072
  ds_read_b64_tr_b16 v[140:141], v177 offset:6144
  ds_read_b64_tr_b16 v[142:143], v177 offset:7168
  s_waitcnt lgkmcnt(9)
  v_mfma_f32_32x32x16_bf16 v[48:63], v[116:119], v[112:115], v[48:63]
  ds_read_b128 v[112:115], v176 offset:4096
  ds_read_b64_tr_b16 v[116:117], v177 offset:8192
  ds_read_b64_tr_b16 v[118:119], v177 offset:9216
  s_waitcnt lgkmcnt(9)
  v_mfma_f32_32x32x16_bf16 v[48:63], v[124:127], v[120:123], v[48:63]
  ds_read_b128 v[120:123], v176 offset:5120
  ds_read_b64_tr_b16 v[124:125], v177 offset:10240
  ds_read_b64_tr_b16 v[126:127], v177 offset:11264
  s_waitcnt lgkmcnt(9)
  v_mfma_f32_32x32x16_bf16 v[48:63], v[132:135], v[128:131], v[48:63]
  ds_read_b128 v[128:131], v176 offset:6144
  ds_read_b64_tr_b16 v[132:133], v177 offset:12288
  ds_read_b64_tr_b16 v[134:135], v177 offset:13312
  s_waitcnt lgkmcnt(9)
  v_mfma_f32_32x32x16_bf16 v[48:63], v[140:143], v[136:139], v[48:63]
  ds_read_b128 v[136:139], v176 offset:7168
  ds_read_b64_tr_b16 v[140:141], v177 offset:14336
  ds_read_b64_tr_b16 v[142:143], v177 offset:15360
  s_waitcnt lgkmcnt(9)
  v_mfma_f32_32x32x16_bf16 v[48:63], v[116:119], v[112:115], v[48:63]
  s_waitcnt lgkmcnt(6)
  v_mfma_f32_32x32x16_bf16 v[48:63], v[124:127], v[120:123], v[48:63]
  s_waitcnt lgkmcnt(3)
  v_mfma_f32_32x32x16_bf16 v[48:63], v[132:135], v[128:131], v[48:63]
  s_waitcnt lgkmcnt(0)
  v_mfma_f32_32x32x16_bf16 v[48:63], v[140:143], v[136:139], v[48:63]
  s_barrier
  v_add_u32 v176, 34816, v5
  v_add_u32 v177, 102400, v4
  ds_read_b128 v[112:115], v176 offset:0
  ds_read_b64_tr_b16 v[116:117], v177 offset:0
  ds_read_b64_tr_b16 v[118:119], v177 offset:1024
  ds_read_b128 v[120:123], v176 offset:1024
  ds_read_b64_tr_b16 v[124:125], v177 offset:2048
  ds_read_b64_tr_b16 v[126:127], v177 offset:3072
  ds_read_b128 v[128:131], v176 offset:2048
  ds_read_b64_tr_b16 v[132:133], v177 offset:4096
  ds_read_b64_tr_b16 v[134:135], v177 offset:5120
  ds_read_b128 v[136:139], v176 offset:3072
  ds_read_b64_tr_b16 v[140:141], v177 offset:6144
  ds_read_b64_tr_b16 v[142:143], v177 offset:7168
  s_waitcnt lgkmcnt(9)
  v_mfma_f32_32x32x16_bf16 v[48:63], v[116:119], v[112:115], v[48:63]
  ds_read_b128 v[112:115], v176 offset:4096
  ds_read_b64_tr_b16 v[116:117], v177 offset:8192
  ds_read_b64_tr_b16 v[118:119], v177 offset:9216
  s_waitcnt lgkmcnt(9)
  v_mfma_f32_32x32x16_bf16 v[48:63], v[124:127], v[120:123], v[48:63]
  ds_read_b128 v[120:123], v176 offset:5120
  ds_read_b64_tr_b16 v[124:125], v177 offset:10240
  ds_read_b64_tr_b16 v[126:127], v177 offset:11264
  s_waitcnt lgkmcnt(9)
  v_mfma_f32_32x32x16_bf16 v[48:63], v[132:135], v[128:131], v[48:63]
  ds_read_b128 v[128:131], v176 offset:6144
  ds_read_b64_tr_b16 v[132:133], v177 offset:12288
  ds_read_b64_tr_b16 v[134:135], v177 offset:13312
  s_waitcnt lgkmcnt(9)
  v_mfma_f32_32x32x16_bf16 v[48:63], v[140:143], v[136:139], v[48:63]
  ds_read_b128 v[136:139], v176 offset:7168
  ds_read_b64_tr_b16 v[140:141], v177 offset:14336
  ds_read_b64_tr_b16 v[142:143], v177 offset:15360
  s_waitcnt lgkmcnt(9)
  v_mfma_f32_32x32x16_bf16 v[48:63], v[116:119], v[112:115], v[48:63]
  s_waitcnt lgkmcnt(6)
  v_mfma_f32_32x32x16_bf16 v[48:63], v[124:127], v[120:123], v[48:63]
  s_waitcnt lgkmcnt(3)
  v_mfma_f32_32x32x16_bf16 v[48:63], v[132:135], v[128:131], v[48:63]
  s_waitcnt lgkmcnt(0)
  v_mfma_f32_32x32x16_bf16 v[48:63], v[140:143], v[136:139], v[48:63]
  s_barrier
  v_lshlrev_b32 v176, 16, v24
  v_and_b32 v177, 0xffff0000, v24
  v_lshlrev_b32 v178, 16, v25
  v_and_b32 v179, 0xffff0000, v25
  v_lshlrev_b32 v180, 16, v26
  v_and_b32 v181, 0xffff0000, v26
  v_lshlrev_b32 v182, 16, v27
  v_and_b32 v183, 0xffff0000, v27
  v_lshlrev_b32 v184, 16, v28
  v_and_b32 v185, 0xffff0000, v28
  v_lshlrev_b32 v186, 16, v29
  v_and_b32 v187, 0xffff0000, v29
  v_lshlrev_b32 v188, 16, v30
  v_and_b32 v189, 0xffff0000, v30
  v_lshlrev_b32 v190, 16, v31
  v_and_b32 v191, 0xffff0000, v31
  v_pk_add_f32 v[48:49], v[48:49], v[176:177]
  v_pk_add_f32 v[50:51], v[50:51], v[178:179]
  v_pk_add_f32 v[52:53], v[52:53], v[180:181]
  v_pk_add_f32 v[54:55], v[54:55], v[182:183]
  v_pk_add_f32 v[56:57], v[56:57], v[184:185]
  v_pk_add_f32 v[58:59], v[58:59], v[186:187]
  v_pk_add_f32 v[60:61], v[60:61], v[188:189]
  v_pk_add_f32 v[62:63], v[62:63], v[190:191]
  v_pk_mul_f32 v[208:209], v[48:49], s[98:99]
  v_pk_mul_f32 v[210:211], v[50:51], s[98:99]
  v_pk_mul_f32 v[212:213], v[52:53], s[98:99]
  v_pk_mul_f32 v[214:215], v[54:55], s[98:99]
  v_pk_mul_f32 v[216:217], v[56:57], s[98:99]
  v_pk_mul_f32 v[218:219], v[58:59], s[98:99]
  v_pk_mul_f32 v[220:221], v[60:61], s[98:99]
  v_pk_mul_f32 v[222:223], v[62:63], s[98:99]
  v_exp_f32 v208, v208
  v_exp_f32 v209, v209
  v_exp_f32 v210, v210
  v_exp_f32 v211, v211
  v_exp_f32 v212, v212
  v_exp_f32 v213, v213
  v_exp_f32 v214, v214
  v_exp_f32 v215, v215
  v_exp_f32 v216, v216
  v_exp_f32 v217, v217
  v_exp_f32 v218, v218
  v_exp_f32 v219, v219
  v_exp_f32 v220, v220
  v_exp_f32 v221, v221
  v_exp_f32 v222, v222
  v_exp_f32 v223, v223
  v_pk_add_f32 v[208:209], v[208:209], 1.0 op_sel_hi:[1,0]
  v_pk_add_f32 v[210:211], v[210:211], 1.0 op_sel_hi:[1,0]
  v_pk_add_f32 v[212:213], v[212:213], 1.0 op_sel_hi:[1,0]
  v_pk_add_f32 v[214:215], v[214:215], 1.0 op_sel_hi:[1,0]
  v_pk_add_f32 v[216:217], v[216:217], 1.0 op_sel_hi:[1,0]
  v_pk_add_f32 v[218:219], v[218:219], 1.0 op_sel_hi:[1,0]
  v_pk_add_f32 v[220:221], v[220:221], 1.0 op_sel_hi:[1,0]
  v_pk_add_f32 v[222:223], v[222:223], 1.0 op_sel_hi:[1,0]
  v_rcp_f32 v208, v208
  v_rcp_f32 v209, v209
  v_rcp_f32 v210, v210
  v_rcp_f32 v211, v211
  v_rcp_f32 v212, v212
  v_rcp_f32 v213, v213
  v_rcp_f32 v214, v214
  v_rcp_f32 v215, v215
  v_rcp_f32 v216, v216
  v_rcp_f32 v217, v217
  v_rcp_f32 v218, v218
  v_rcp_f32 v219, v219
  v_rcp_f32 v220, v220
  v_rcp_f32 v221, v221
  v_rcp_f32 v222, v222
  v_rcp_f32 v223, v223
  v_lshlrev_b32 v192, 16, v16
  v_and_b32 v193, 0xffff0000, v16
  v_lshlrev_b32 v194, 16, v17
  v_and_b32 v195, 0xffff0000, v17
  v_lshlrev_b32 v196, 16, v18
  v_and_b32 v197, 0xffff0000, v18
  v_lshlrev_b32 v198, 16, v19
  v_and_b32 v199, 0xffff0000, v19
  v_lshlrev_b32 v200, 16, v20
  v_and_b32 v201, 0xffff0000, v20
  v_lshlrev_b32 v202, 16, v21
  v_and_b32 v203, 0xffff0000, v21
  v_lshlrev_b32 v204, 16, v22
  v_and_b32 v205, 0xffff0000, v22
  v_lshlrev_b32 v206, 16, v23
  v_and_b32 v207, 0xffff0000, v23
  v_pk_mul_f32 v[48:49], v[48:49], v[208:209]
  v_pk_mul_f32 v[50:51], v[50:51], v[210:211]
  v_pk_mul_f32 v[52:53], v[52:53], v[212:213]
  v_pk_mul_f32 v[54:55], v[54:55], v[214:215]
  v_pk_mul_f32 v[56:57], v[56:57], v[216:217]
  v_pk_mul_f32 v[58:59], v[58:59], v[218:219]
  v_pk_mul_f32 v[60:61], v[60:61], v[220:221]
  v_pk_mul_f32 v[62:63], v[62:63], v[222:223]
  v_pk_fma_f32 v[48:49], v[48:49], v[32:33], v[192:193]
  v_pk_fma_f32 v[50:51], v[50:51], v[34:35], v[194:195]
  v_pk_fma_f32 v[52:53], v[52:53], v[36:37], v[196:197]
  v_pk_fma_f32 v[54:55], v[54:55], v[38:39], v[198:199]
  v_pk_fma_f32 v[56:57], v[56:57], v[40:41], v[200:201]
  v_pk_fma_f32 v[58:59], v[58:59], v[42:43], v[202:203]
  v_pk_fma_f32 v[60:61], v[60:61], v[44:45], v[204:205]
  v_pk_fma_f32 v[62:63], v[62:63], v[46:47], v[206:207]
  v_cvt_pk_bf16_f32 v208, v48, v49
  v_cvt_pk_bf16_f32 v209, v50, v51
  v_cvt_pk_bf16_f32 v210, v52, v53
  v_cvt_pk_bf16_f32 v211, v54, v55
  v_cvt_pk_bf16_f32 v212, v56, v57
  v_cvt_pk_bf16_f32 v213, v58, v59
  v_cvt_pk_bf16_f32 v214, v60, v61
  v_cvt_pk_bf16_f32 v215, v62, v63
  s_nop 1
  v_permlane32_swap_b32 v208, v210
  v_permlane32_swap_b32 v209, v211
  v_permlane32_swap_b32 v212, v214
  v_permlane32_swap_b32 v213, v215
  v_and_b32 v236, 31, v1
  v_lshrrev_b32 v237, 5, v1
  v_lshlrev_b32 v236, 10, v236
  v_lshl_add_u32 v236, v237, 4, v236
  s_lshl_b32 s60, s47, 16
  s_lshl_b32 s61, s68, 15
  s_add_u32 s60, s60, s61
  s_lshl_b32 s61, s48, 7
  s_add_u32 s60, s60, s61
  s_lshl_b32 s61, s69, 6
  s_add_u32 s60, s60, s61
  buffer_store_dwordx4 v[208:211], v236, s[32:35], s60 offen offset:0
  buffer_store_dwordx4 v[212:215], v236, s[32:35], s60 offen offset:32
  s_branch L_END
L_IDLE_C:
  s_waitcnt vmcnt(0)
  s_lshl_b32 s64, s52, 3
  s_add_u32 s64, s64, s44
  s_lshl_b32 s64, s64, 5
  s_add_u32 s64, s64, s51
  s_lshl_b32 s64, s64, 2
  s_add_u32 s64, s64, 20996096
  s_mov_b64 exec, 1
  buffer_store_dword v13, off, s[36:39], s64 sc1
  s_mov_b64 exec, -1
  s_barrier
  s_barrier
  s_branch L_A3_ENTRY_C
L_LOADA:
  s_mov_b32 s59, 1
  s_mul_i32 s68, s58, 9216
  s_lshl_b32 s69, s58, 13
  v_lshrrev_b32 v51, 4, v1
  v_and_b32 v50, 15, v1
  s_lshl_b32 s60, s47, 6
  s_sub_u32 s60, s60, 2
  s_mul_i32 s61, s58, 9
  s_add_u32 s62, s61, 0
  s_min_u32 s62, s62, 16
  s_lshl_b32 s62, s62, 2
  v_add_u32 v52, s62, v51
  v_and_b32 v53, 15, v52
  v_xor_b32 v53, v53, v50
  v_add_u32 v52, s60, v52
  v_lshlrev_b32 v52, 10, v52
  v_lshl_add_u32 v2, v53, 4, v52
  s_add_u32 s62, s61, 1
  s_min_u32 s62, s62, 16
  s_lshl_b32 s62, s62, 2
  v_add_u32 v52, s62, v51
  v_and_b32 v53, 15, v52
  v_xor_b32 v53, v53, v50
  v_add_u32 v52, s60, v52
  v_lshlrev_b32 v52, 10, v52
  v_lshl_add_u32 v3, v53, 4, v52
  s_add_u32 s62, s61, 2
  s_min_u32 s62, s62, 16
  s_lshl_b32 s62, s62, 2
  v_add_u32 v52, s62, v51
  v_and_b32 v53, 15, v52
  v_xor_b32 v53, v53, v50
  v_add_u32 v52, s60, v52
  v_lshlrev_b32 v52, 10, v52
  v_lshl_add_u32 v4, v53, 4, v52
  s_add_u32 s62, s61, 3
  s_min_u32 s62, s62, 16
  s_lshl_b32 s62, s62, 2
  v_add_u32 v52, s62, v51
  v_and_b32 v53, 15, v52
  v_xor_b32 v53, v53, v50
  v_add_u32 v52, s60, v52
  v_lshlrev_b32 v52, 10, v52
  v_lshl_add_u32 v5, v53, 4, v52
  s_add_u32 s62, s61, 4
  s_min_u32 s62, s62, 16
  s_lshl_b32 s62, s62, 2
  v_add_u32 v52, s62, v51
  v_and_b32 v53, 15, v52
  v_xor_b32 v53, v53, v50
  v_add_u32 v52, s60, v52
  v_lshlrev_b32 v52, 10, v52
  v_lshl_add_u32 v6, v53, 4, v52
  s_add_u32 s62, s61, 5
  s_min_u32 s62, s62, 16
  s_lshl_b32 s62, s62, 2
  v_add_u32 v52, s62, v51
  v_and_b32 v53, 15, v52
  v_xor_b32 v53, v53, v50
  v_add_u32 v52, s60, v52
  v_lshlrev_b32 v52, 10, v52
  v_lshl_add_u32 v7, v53, 4, v52
  s_add_u32 s62, s61, 6
  s_min_u32 s62, s62, 16
  s_lshl_b32 s62, s62, 2
  v_add_u32 v52, s62, v51
  v_and_b32 v53, 15, v52
  v_xor_b32 v53, v53, v50
  v_add_u32 v52, s60, v52
  v_lshlrev_b32 v52, 10, v52
  v_lshl_add_u32 v8, v53, 4, v52
  s_add_u32 s62, s61, 7
  s_min_u32 s62, s62, 16
  s_lshl_b32 s62, s62, 2
  v_add_u32 v52, s62, v51
  v_and_b32 v53, 15, v52
  v_xor_b32 v53, v53, v50
  v_add_u32 v52, s60, v52
  v_lshlrev_b32 v52, 10, v52
  v_lshl_add_u32 v9, v53, 4, v52
  s_add_u32 s62, s61, 8
  s_min_u32 s62, s62, 16
  s_lshl_b32 s62, s62, 2
  v_add_u32 v52, s62, v51
  v_and_b32 v53, 15, v52
  v_xor_b32 v53, v53, v50
  v_add_u32 v52, s60, v52
  v_lshlrev_b32 v52, 10, v52
  v_lshl_add_u32 v10, v53, 4, v52
  s_mov_b32 s60, 0
  s_add_u32 m0, s68, 0
  s_nop 0
  buffer_load_dwordx4 v2, s[4:7], s60 offen offset:0 lds
  s_add_u32 m0, s68, 1024
  s_nop 0
  buffer_load_dwordx4 v3, s[4:7], s60 offen offset:0 lds
  s_add_u32 m0, s68, 2048
  s_nop 0
  buffer_load_dwordx4 v4, s[4:7], s60 offen offset:0 lds
  s_add_u32 m0, s68, 3072
  s_nop 0
  buffer_load_dwordx4 v5, s[4:7], s60 offen offset:0 lds
  s_add_u32 m0, s68, 4096
  s_nop 0
  buffer_load_dwordx4 v6, s[4:7], s60 offen offset:0 lds
  s_add_u32 m0, s68, 5120
  s_nop 0
  buffer_load_dwordx4 v7, s[4:7], s60 offen offset:0 lds
  s_add_u32 m0, s68, 6144
  s_nop 0
  buffer_load_dwordx4 v8, s[4:7], s60 offen offset:0 lds
  s_add_u32 m0, s68, 7168
  s_nop 0
  buffer_load_dwordx4 v9, s[4:7], s60 offen offset:0 lds
  s_add_u32 m0, s69, 8192
  s_nop 0
  buffer_load_dwordx4 v10, s[4:7], s60 offen offset:0 lds
  s_mov_b32 s60, 256
  s_add_u32 m0, s68, 17408
  s_nop 0
  buffer_load_dwordx4 v2, s[4:7], s60 offen offset:0 lds
  s_add_u32 m0, s68, 18432
  s_nop 0
  buffer_load_dwordx4 v3, s[4:7], s60 offen offset:0 lds
  s_add_u32 m0, s68, 19456
  s_nop 0
  buffer_load_dwordx4 v4, s[4:7], s60 offen offset:0 lds
  s_add_u32 m0, s68, 20480
  s_nop 0
  buffer_load_dwordx4 v5, s[4:7], s60 offen offset:0 lds
  s_add_u32 m0, s68, 21504
  s_nop 0
  buffer_load_dwordx4 v6, s[4:7], s60 offen offset:0 lds
  s_add_u32 m0, s68, 22528
  s_nop 0
  buffer_load_dwordx4 v7, s[4:7], s60 offen offset:0 lds
  s_add_u32 m0, s68, 23552
  s_nop 0
  buffer_load_dwordx4 v8, s[4:7], s60 offen offset:0 lds
  s_add_u32 m0, s68, 24576
  s_nop 0
  buffer_load_dwordx4 v9, s[4:7], s60 offen offset:0 lds
  s_add_u32 m0, s69, 25600
  s_nop 0
  buffer_load_dwordx4 v10, s[4:7], s60 offen offset:0 lds
  s_mov_b32 s60, 512
  s_add_u32 m0, s68, 34816
  s_nop 0
  buffer_load_dwordx4 v2, s[4:7], s60 offen offset:0 lds
  s_add_u32 m0, s68, 35840
  s_nop 0
  buffer_load_dwordx4 v3, s[4:7], s60 offen offset:0 lds
  s_add_u32 m0, s68, 36864
  s_nop 0
  buffer_load_dwordx4 v4, s[4:7], s60 offen offset:0 lds
  s_add_u32 m0, s68, 37888
  s_nop 0
  buffer_load_dwordx4 v5, s[4:7], s60 offen offset:0 lds
  s_add_u32 m0, s68, 38912
  s_nop 0
  buffer_load_dwordx4 v6, s[4:7], s60 offen offset:0 lds
  s_add_u32 m0, s68, 39936
  s_nop 0
  buffer_load_dwordx4 v7, s[4:7], s60 offen offset:0 lds
  s_add_u32 m0, s68, 40960
  s_nop 0
  buffer_load_dwordx4 v8, s[4:7], s60 offen offset:0 lds
  s_add_u32 m0, s68, 41984
  s_nop 0
  buffer_load_dwordx4 v9, s[4:7], s60 offen offset:0 lds
  s_add_u32 m0, s69, 43008
  s_nop 0
  buffer_load_dwordx4 v10, s[4:7], s60 offen offset:0 lds
  v_lshrrev_b32 v52, 3, v1
  v_lshlrev_b32 v52, 10, v52
  v_lshrrev_b32 v51, 4, v1
  v_and_b32 v53, 7, v1
  v_xor_b32 v54, v53, v51
  v_lshl_add_u32 v11, v54, 4, v52
  v_add_u32 v54, 4, v51
  v_and_b32 v54, 7, v54
  v_xor_b32 v54, v53, v54
  v_lshl_add_u32 v12, v54, 4, v52
  s_lshl_b32 s60, s50, 17
  s_lshl_b32 s61, s58, 16
  s_add_u32 s70, s60, s61
  s_lshl_b32 s60, s47, 1
  s_add_u32 s60, s60, s58
  s_lshl_b32 s61, s60, 15
  s_add_u32 s71, s61, 0
  s_add_u32 s72, s61, 10485760
  s_mul_i32 s61, s60, 114688
  s_add_u32 s73, s61, 12582912
  s_lshl_b32 s60, s53, 1
  s_add_u32 s60, s60, s58
  s_lshl_b32 s60, s60, 16
  s_add_u32 s74, s60, 8388608
  s_lshl_b32 s60, s51, 3
  s_add_u32 s60, s60, s52
  s_lshl_b32 s60, s60, 13
  s_add_u32 s61, s60, s69
  s_add_u32 s75, s61, 4186112
  s_lshr_b32 s61, s69, 1
  s_add_u32 s61, s61, s60
  s_add_u32 s76, s61, 2097152
  v_and_b32 v52, 31, v1
  v_lshlrev_b32 v52, 2, v52
  s_lshl_b32 s60, s47, 7
  s_add_u32 s60, s60, 20971520
  v_add_u32 v15, s60, v52
  v_lshlrev_b32 v52, 2, v1
  s_lshl_b32 s60, s53, 8
  s_add_u32 s60, s60, 20987904
  v_add_u32 v17, s60, v52
  s_lshl_b32 s60, s47, 8
  s_add_u32 s60, s60, 20996096
  v_add_u32 v18, s60, v52
  v_min_u32 v52, 55, v1
  v_lshlrev_b32 v52, 2, v52
  s_lshr_b32 s60, s47, 1
  s_lshl_b32 s60, s60, 8
  s_add_u32 s60, s60, 21004288
  v_add_u32 v19, s60, v52
  v_and_b32 v48, 31, v1
  v_lshrrev_b32 v49, 5, v1
  v_and_b32 v50, 15, v1
  v_lshrrev_b32 v51, 4, v1
  s_sub_u32 s67, s44, 4
  v_mov_b32 v26, 0x3f803f80
  v_lshlrev_b32 v13, 4, v1
  s_lshl_b32 s60, s58, 5
  v_add_u32 v52, s60, v48
  v_lshlrev_b32 v31, 2, v52
  v_add_u32 v31, 159744, v31
  v_and_b32 v53, 15, v52
  v_lshlrev_b32 v54, 3, v49
  v_xor_b32 v53, v53, v54
  v_lshlrev_b32 v53, 4, v53
  v_lshl_add_u32 v20, v52, 8, v53
  s_lshl_b32 s60, s67, 5
  v_add_u32 v52, s60, v48
  v_lshlrev_b32 v32, 2, v52
  v_add_u32 v32, 159744, v32
  v_lshrrev_b32 v53, 1, v52
  v_and_b32 v53, 7, v53
  v_lshlrev_b32 v54, 2, v49
  v_xor_b32 v53, v53, v54
  v_lshlrev_b32 v53, 4, v53
  v_lshl_add_u32 v21, v52, 7, v53
  s_lshl_b32 s60, s67, 12
  v_add_u32 v22, s60, v13
  v_lshrrev_b32 v52, 2, v50
  v_mul_u32_u24 v53, 8, v49
  v_add_u32 v53, v53, v52
  v_mul_u32_u24 v28, 128, v53
  v_lshrrev_b32 v53, 3, v50
  v_xor_b32 v53, s58, v53
  v_lshl_add_u32 v28, v53, 6, v28
  v_and_b32 v53, 1, v51
  v_lshl_add_u32 v28, v53, 5, v28
  v_and_b32 v53, 3, v50
  v_lshl_add_u32 v28, v53, 3, v28
  s_min_u32 s61, s67, 2
  v_lshrrev_b32 v52, 2, v50
  v_mul_u32_u24 v53, 8, v49
  v_add_u32 v53, v53, v52
  v_mul_u32_u24 v29, 192, v53
  v_mov_b32 v53, s61
  v_lshl_add_u32 v29, v53, 6, v29
  v_and_b32 v53, 1, v51
  v_lshl_add_u32 v29, v53, 5, v29
  v_and_b32 v53, 3, v50
  v_lshl_add_u32 v29, v53, 3, v29
  v_lshrrev_b32 v52, 2, v50
  v_mul_u32_u24 v53, 8, v49
  v_add_u32 v53, v53, v52
  v_mul_u32_u24 v30, 256, v53
  v_xor_b32 v53, s67, v52
  v_lshl_add_u32 v30, v53, 6, v30
  v_and_b32 v53, 1, v51
  v_lshl_add_u32 v30, v53, 5, v30
  v_and_b32 v53, 3, v50
  v_lshl_add_u32 v30, v53, 3, v30
  s_lshl_b32 s60, s58, 5
  v_add_u32 v33, s60, v48
  v_lshlrev_b32 v33, 2, v33
  v_add_u32 v33, 161792, v33
  s_lshl_b32 s60, s67, 5
  v_add_u32 v34, s60, v48
  v_lshlrev_b32 v34, 2, v34
  v_add_u32 v34, 161792, v34
  s_or_b32 s60, s52, s58
  s_cmp_eq_u32 s60, 0
  s_cselect_b32 s60, 0x40000000, 0
  v_add_u32 v14, s60, v13
  v_lshrrev_b32 v52, 2, v50
  s_lshl_b32 s60, s52, 1
  s_sub_u32 s60, s60, 2
  v_add_u32 v52, s60, v52
  v_max_i32 v52, 0, v52
  s_lshr_b32 s60, s51, 1
  s_lshl_b32 s60, s60, 4
  v_add_u32 v52, s60, v52
  v_and_b32 v53, 3, v50
  v_lshl_add_u32 v52, v52, 2, v53
  v_lshlrev_b32 v16, 2, v52
  v_add_u32 v16, 20979712, v16
  s_waitcnt vmcnt(18)
  s_barrier
  s_mov_b32 s60, 768
  s_add_u32 m0, s68, 52224
  s_nop 0
  buffer_load_dwordx4 v2, s[4:7], s60 offen offset:0 lds
  s_add_u32 m0, s68, 53248
  s_nop 0
  buffer_load_dwordx4 v3, s[4:7], s60 offen offset:0 lds
  s_add_u32 m0, s68, 54272
  s_nop 0
  buffer_load_dwordx4 v4, s[4:7], s60 offen offset:0 lds
  s_add_u32 m0, s68, 55296
  s_nop 0
  buffer_load_dwordx4 v5, s[4:7], s60 offen offset:0 lds
  s_add_u32 m0, s68, 56320
  s_nop 0
  buffer_load_dwordx4 v6, s[4:7], s60 offen offset:0 lds
  s_add_u32 m0, s68, 57344
  s_nop 0
  buffer_load_dwordx4 v7, s[4:7], s60 offen offset:0 lds
  s_add_u32 m0, s68, 58368
  s_nop 0
  buffer_load_dwordx4 v8, s[4:7], s60 offen offset:0 lds
  s_add_u32 m0, s68, 59392
  s_nop 0
  buffer_load_dwordx4 v9, s[4:7], s60 offen offset:0 lds
  s_add_u32 m0, s69, 60416
  s_nop 0
  buffer_load_dwordx4 v10, s[4:7], s60 offen offset:0 lds
  v_mov_b32 v23, 0
  v_mov_b32 v24, 0
  v_mov_b32 v25, 0
  v_add_u32 v108, 0, v20
  v_xor_b32 v110, 0, v108
  v_xor_b32 v111, 16, v108
  v_xor_b32 v112, 32, v108
  v_xor_b32 v113, 48, v108
  v_xor_b32 v114, 64, v108
  v_xor_b32 v115, 80, v108
  v_xor_b32 v116, 96, v108
  v_xor_b32 v117, 112, v108
  ds_read_b128 v[48:51], v110 offset:0
  ds_read_b128 v[52:55], v111 offset:0
  ds_read_b128 v[56:59], v112 offset:0
  ds_read_b128 v[60:63], v113 offset:0
  ds_read_b128 v[64:67], v114 offset:0
  ds_read_b128 v[68:71], v115 offset:0
  ds_read_b128 v[72:75], v116 offset:0
  ds_read_b128 v[76:79], v117 offset:0
  s_waitcnt lgkmcnt(7)
  v_dot2c_f32_bf16 v23, v48, v26
  v_dot2c_f32_bf16 v24, v48, v48
  v_dot2c_f32_bf16 v23, v49, v26
  v_dot2c_f32_bf16 v24, v49, v49
  v_dot2c_f32_bf16 v23, v50, v26
  v_dot2c_f32_bf16 v24, v50, v50
  v_dot2c_f32_bf16 v23, v51, v26
  v_dot2c_f32_bf16 v24, v51, v51
  s_waitcnt lgkmcnt(6)
  v_dot2c_f32_bf16 v23, v52, v26
  v_dot2c_f32_bf16 v24, v52, v52
  v_dot2c_f32_bf16 v23, v53, v26
  v_dot2c_f32_bf16 v24, v53, v53
  v_dot2c_f32_bf16 v23, v54, v26
  v_dot2c_f32_bf16 v24, v54, v54
  v_dot2c_f32_bf16 v23, v55, v26
  v_dot2c_f32_bf16 v24, v55, v55
  s_waitcnt lgkmcnt(5)
  v_dot2c_f32_bf16 v23, v56, v26
  v_dot2c_f32_bf16 v24, v56, v56
  v_dot2c_f32_bf16 v23, v57, v26
  v_dot2c_f32_bf16 v24, v57, v57
  v_dot2c_f32_bf16 v23, v58, v26
  v_dot2c_f32_bf16 v24, v58, v58
  v_dot2c_f32_bf16 v23, v59, v26
  v_dot2c_f32_bf16 v24, v59, v59
  s_waitcnt lgkmcnt(4)
  v_dot2c_f32_bf16 v23, v60, v26
  v_dot2c_f32_bf16 v24, v60, v60
  v_dot2c_f32_bf16 v23, v61, v26
  v_dot2c_f32_bf16 v24, v61, v61
  v_dot2c_f32_bf16 v23, v62, v26
  v_dot2c_f32_bf16 v24, v62, v62
  v_dot2c_f32_bf16 v23, v63, v26
  v_dot2c_f32_bf16 v24, v63, v63
  s_waitcnt lgkmcnt(3)
  v_dot2c_f32_bf16 v23, v64, v26
  v_dot2c_f32_bf16 v24, v64, v64
  v_dot2c_f32_bf16 v23, v65, v26
  v_dot2c_f32_bf16 v24, v65, v65
  v_dot2c_f32_bf16 v23, v66, v26
  v_dot2c_f32_bf16 v24, v66, v66
  v_dot2c_f32_bf16 v23, v67, v26
  v_dot2c_f32_bf16 v24, v67, v67
  s_waitcnt lgkmcnt(2)
  v_dot2c_f32_bf16 v23, v68, v26
  v_dot2c_f32_bf16 v24, v68, v68
  v_dot2c_f32_bf16 v23, v69, v26
  v_dot2c_f32_bf16 v24, v69, v69
  v_dot2c_f32_bf16 v23, v70, v26
  v_dot2c_f32_bf16 v24, v70, v70
  v_dot2c_f32_bf16 v23, v71, v26
  v_dot2c_f32_bf16 v24, v71, v71
  s_waitcnt lgkmcnt(1)
  v_dot2c_f32_bf16 v23, v72, v26
  v_dot2c_f32_bf16 v24, v72, v72
  v_dot2c_f32_bf16 v23, v73, v26
  v_dot2c_f32_bf16 v24, v73, v73
  v_dot2c_f32_bf16 v23, v74, v26
  v_dot2c_f32_bf16 v24, v74, v74
  v_dot2c_f32_bf16 v23, v75, v26
  v_dot2c_f32_bf16 v24, v75, v75
  s_waitcnt lgkmcnt(0)
  v_dot2c_f32_bf16 v23, v76, v26
  v_dot2c_f32_bf16 v24, v76, v76
  v_dot2c_f32_bf16 v23, v77, v26
  v_dot2c_f32_bf16 v24, v77, v77
  v_dot2c_f32_bf16 v23, v78, v26
  v_dot2c_f32_bf16 v24, v78, v78
  v_dot2c_f32_bf16 v23, v79, v26
  v_dot2c_f32_bf16 v24, v79, v79
  s_waitcnt vmcnt(18)
  s_barrier
  s_add_u32 s60, s70, 0
  s_add_u32 m0, s69, 0
  s_nop 0
  buffer_load_dwordx4 v11, s[4:7], s60 offen offset:0 lds
  s_add_u32 s60, s70, 8192
  s_add_u32 m0, s69, 1024
  s_nop 0
  buffer_load_dwordx4 v12, s[4:7], s60 offen offset:0 lds
  s_add_u32 s60, s70, 16384
  s_add_u32 m0, s69, 2048
  s_nop 0
  buffer_load_dwordx4 v11, s[4:7], s60 offen offset:0 lds
  s_add_u32 s60, s70, 24576
  s_add_u32 m0, s69, 3072
  s_nop 0
  buffer_load_dwordx4 v12, s[4:7], s60 offen offset:0 lds
  s_add_u32 s60, s70, 32768
  s_add_u32 m0, s69, 4096
  s_nop 0
  buffer_load_dwordx4 v11, s[4:7], s60 offen offset:0 lds
  s_add_u32 s60, s70, 40960
  s_add_u32 m0, s69, 5120
  s_nop 0
  buffer_load_dwordx4 v12, s[4:7], s60 offen offset:0 lds
  s_add_u32 s60, s70, 49152
  s_add_u32 m0, s69, 6144
  s_nop 0
  buffer_load_dwordx4 v11, s[4:7], s60 offen offset:0 lds
  s_add_u32 s60, s70, 57344
  s_add_u32 m0, s69, 7168
  s_nop 0
  buffer_load_dwordx4 v12, s[4:7], s60 offen offset:0 lds
  v_add_u32 v108, 17408, v20
  v_xor_b32 v110, 0, v108
  v_xor_b32 v111, 16, v108
  v_xor_b32 v112, 32, v108
  v_xor_b32 v113, 48, v108
  v_xor_b32 v114, 64, v108
  v_xor_b32 v115, 80, v108
  v_xor_b32 v116, 96, v108
  v_xor_b32 v117, 112, v108
  ds_read_b128 v[48:51], v110 offset:0
  ds_read_b128 v[52:55], v111 offset:0
  ds_read_b128 v[56:59], v112 offset:0
  ds_read_b128 v[60:63], v113 offset:0
  ds_read_b128 v[64:67], v114 offset:0
  ds_read_b128 v[68:71], v115 offset:0
  ds_read_b128 v[72:75], v116 offset:0
  ds_read_b128 v[76:79], v117 offset:0
  s_waitcnt lgkmcnt(7)
  v_dot2c_f32_bf16 v23, v48, v26
  v_dot2c_f32_bf16 v24, v48, v48
  v_dot2c_f32_bf16 v23, v49, v26
  v_dot2c_f32_bf16 v24, v49, v49
  v_dot2c_f32_bf16 v23, v50, v26
  v_dot2c_f32_bf16 v24, v50, v50
  v_dot2c_f32_bf16 v23, v51, v26
  v_dot2c_f32_bf16 v24, v51, v51
  s_waitcnt lgkmcnt(6)
  v_dot2c_f32_bf16 v23, v52, v26
  v_dot2c_f32_bf16 v24, v52, v52
  v_dot2c_f32_bf16 v23, v53, v26
  v_dot2c_f32_bf16 v24, v53, v53
  v_dot2c_f32_bf16 v23, v54, v26
  v_dot2c_f32_bf16 v24, v54, v54
  v_dot2c_f32_bf16 v23, v55, v26
  v_dot2c_f32_bf16 v24, v55, v55
  s_waitcnt lgkmcnt(5)
  v_dot2c_f32_bf16 v23, v56, v26
  v_dot2c_f32_bf16 v24, v56, v56
  v_dot2c_f32_bf16 v23, v57, v26
  v_dot2c_f32_bf16 v24, v57, v57
  v_dot2c_f32_bf16 v23, v58, v26
  v_dot2c_f32_bf16 v24, v58, v58
  v_dot2c_f32_bf16 v23, v59, v26
  v_dot2c_f32_bf16 v24, v59, v59
  s_waitcnt lgkmcnt(4)
  v_dot2c_f32_bf16 v23, v60, v26
  v_dot2c_f32_bf16 v24, v60, v60
  v_dot2c_f32_bf16 v23, v61, v26
  v_dot2c_f32_bf16 v24, v61, v61
  v_dot2c_f32_bf16 v23, v62, v26
  v_dot2c_f32_bf16 v24, v62, v62
  v_dot2c_f32_bf16 v23, v63, v26
  v_dot2c_f32_bf16 v24, v63, v63
  s_waitcnt lgkmcnt(3)
  v_dot2c_f32_bf16 v23, v64, v26
  v_dot2c_f32_bf16 v24, v64, v64
  v_dot2c_f32_bf16 v23, v65, v26
  v_dot2c_f32_bf16 v24, v65, v65
  v_dot2c_f32_bf16 v23, v66, v26
  v_dot2c_f32_bf16 v24, v66, v66
  v_dot2c_f32_bf16 v23, v67, v26
  v_dot2c_f32_bf16 v24, v67, v67
  s_waitcnt lgkmcnt(2)
  v_dot2c_f32_bf16 v23, v68, v26
  v_dot2c_f32_bf16 v24, v68, v68
  v_dot2c_f32_bf16 v23, v69, v26
  v_dot2c_f32_bf16 v24, v69, v69
  v_dot2c_f32_bf16 v23, v70, v26
  v_dot2c_f32_bf16 v24, v70, v70
  v_dot2c_f32_bf16 v23, v71, v26
  v_dot2c_f32_bf16 v24, v71, v71
  s_waitcnt lgkmcnt(1)
  v_dot2c_f32_bf16 v23, v72, v26
  v_dot2c_f32_bf16 v24, v72, v72
  v_dot2c_f32_bf16 v23, v73, v26
  v_dot2c_f32_bf16 v24, v73, v73
  v_dot2c_f32_bf16 v23, v74, v26
  v_dot2c_f32_bf16 v24, v74, v74
  v_dot2c_f32_bf16 v23, v75, v26
  v_dot2c_f32_bf16 v24, v75, v75
  s_waitcnt lgkmcnt(0)
  v_dot2c_f32_bf16 v23, v76, v26
  v_dot2c_f32_bf16 v24, v76, v76
  v_dot2c_f32_bf16 v23, v77, v26
  v_dot2c_f32_bf16 v24, v77, v77
  v_dot2c_f32_bf16 v23, v78, v26
  v_dot2c_f32_bf16 v24, v78, v78
  v_dot2c_f32_bf16 v23, v79, v26
  v_dot2c_f32_bf16 v24, v79, v79
  s_waitcnt vmcnt(17)
  s_barrier
  s_add_u32 s60, s70, 128
  s_add_u32 m0, s69, 17408
  s_nop 0
  buffer_load_dwordx4 v11, s[4:7], s60 offen offset:0 lds
  s_add_u32 s60, s70, 8320
  s_add_u32 m0, s69, 18432
  s_nop 0
  buffer_load_dwordx4 v12, s[4:7], s60 offen offset:0 lds
  s_add_u32 s60, s70, 16512
  s_add_u32 m0, s69, 19456
  s_nop 0
  buffer_load_dwordx4 v11, s[4:7], s60 offen offset:0 lds
  s_add_u32 s60, s70, 24704
  s_add_u32 m0, s69, 20480
  s_nop 0
  buffer_load_dwordx4 v12, s[4:7], s60 offen offset:0 lds
  s_add_u32 s60, s70, 32896
  s_add_u32 m0, s69, 21504
  s_nop 0
  buffer_load_dwordx4 v11, s[4:7], s60 offen offset:0 lds
  s_add_u32 s60, s70, 41088
  s_add_u32 m0, s69, 22528
  s_nop 0
  buffer_load_dwordx4 v12, s[4:7], s60 offen offset:0 lds
  s_add_u32 s60, s70, 49280
  s_add_u32 m0, s69, 23552
  s_nop 0
  buffer_load_dwordx4 v11, s[4:7], s60 offen offset:0 lds
  s_add_u32 s60, s70, 57472
  s_add_u32 m0, s69, 24576
  s_nop 0
  buffer_load_dwordx4 v12, s[4:7], s60 offen offset:0 lds
  v_add_u32 v108, 34816, v20
  v_xor_b32 v110, 0, v108
  v_xor_b32 v111, 16, v108
  v_xor_b32 v112, 32, v108
  v_xor_b32 v113, 48, v108
  v_xor_b32 v114, 64, v108
  v_xor_b32 v115, 80, v108
  v_xor_b32 v116, 96, v108
  v_xor_b32 v117, 112, v108
  ds_read_b128 v[48:51], v110 offset:0
  ds_read_b128 v[52:55], v111 offset:0
  ds_read_b128 v[56:59], v112 offset:0
  ds_read_b128 v[60:63], v113 offset:0
  ds_read_b128 v[64:67], v114 offset:0
  ds_read_b128 v[68:71], v115 offset:0
  ds_read_b128 v[72:75], v116 offset:0
  ds_read_b128 v[76:79], v117 offset:0
  s_waitcnt lgkmcnt(7)
  v_dot2c_f32_bf16 v23, v48, v26
  v_dot2c_f32_bf16 v24, v48, v48
  v_dot2c_f32_bf16 v23, v49, v26
  v_dot2c_f32_bf16 v24, v49, v49
  v_dot2c_f32_bf16 v23, v50, v26
  v_dot2c_f32_bf16 v24, v50, v50
  v_dot2c_f32_bf16 v23, v51, v26
  v_dot2c_f32_bf16 v24, v51, v51
  s_waitcnt lgkmcnt(6)
  v_dot2c_f32_bf16 v23, v52, v26
  v_dot2c_f32_bf16 v24, v52, v52
  v_dot2c_f32_bf16 v23, v53, v26
  v_dot2c_f32_bf16 v24, v53, v53
  v_dot2c_f32_bf16 v23, v54, v26
  v_dot2c_f32_bf16 v24, v54, v54
  v_dot2c_f32_bf16 v23, v55, v26
  v_dot2c_f32_bf16 v24, v55, v55
  s_waitcnt lgkmcnt(5)
  v_dot2c_f32_bf16 v23, v56, v26
  v_dot2c_f32_bf16 v24, v56, v56
  v_dot2c_f32_bf16 v23, v57, v26
  v_dot2c_f32_bf16 v24, v57, v57
  v_dot2c_f32_bf16 v23, v58, v26
  v_dot2c_f32_bf16 v24, v58, v58
  v_dot2c_f32_bf16 v23, v59, v26
  v_dot2c_f32_bf16 v24, v59, v59
  s_waitcnt lgkmcnt(4)
  v_dot2c_f32_bf16 v23, v60, v26
  v_dot2c_f32_bf16 v24, v60, v60
  v_dot2c_f32_bf16 v23, v61, v26
  v_dot2c_f32_bf16 v24, v61, v61
  v_dot2c_f32_bf16 v23, v62, v26
  v_dot2c_f32_bf16 v24, v62, v62
  v_dot2c_f32_bf16 v23, v63, v26
  v_dot2c_f32_bf16 v24, v63, v63
  s_waitcnt lgkmcnt(3)
  v_dot2c_f32_bf16 v23, v64, v26
  v_dot2c_f32_bf16 v24, v64, v64
  v_dot2c_f32_bf16 v23, v65, v26
  v_dot2c_f32_bf16 v24, v65, v65
  v_dot2c_f32_bf16 v23, v66, v26
  v_dot2c_f32_bf16 v24, v66, v66
  v_dot2c_f32_bf16 v23, v67, v26
  v_dot2c_f32_bf16 v24, v67, v67
  s_waitcnt lgkmcnt(2)
  v_dot2c_f32_bf16 v23, v68, v26
  v_dot2c_f32_bf16 v24, v68, v68
  v_dot2c_f32_bf16 v23, v69, v26
  v_dot2c_f32_bf16 v24, v69, v69
  v_dot2c_f32_bf16 v23, v70, v26
  v_dot2c_f32_bf16 v24, v70, v70
  v_dot2c_f32_bf16 v23, v71, v26
  v_dot2c_f32_bf16 v24, v71, v71
  s_waitcnt lgkmcnt(1)
  v_dot2c_f32_bf16 v23, v72, v26
  v_dot2c_f32_bf16 v24, v72, v72
  v_dot2c_f32_bf16 v23, v73, v26
  v_dot2c_f32_bf16 v24, v73, v73
  v_dot2c_f32_bf16 v23, v74, v26
  v_dot2c_f32_bf16 v24, v74, v74
  v_dot2c_f32_bf16 v23, v75, v26
  v_dot2c_f32_bf16 v24, v75, v75
  s_waitcnt lgkmcnt(0)
  v_dot2c_f32_bf16 v23, v76, v26
  v_dot2c_f32_bf16 v24, v76, v76
  v_dot2c_f32_bf16 v23, v77, v26
  v_dot2c_f32_bf16 v24, v77, v77
  v_dot2c_f32_bf16 v23, v78, v26
  v_dot2c_f32_bf16 v24, v78, v78
  v_dot2c_f32_bf16 v23, v79, v26
  v_dot2c_f32_bf16 v24, v79, v79
  s_waitcnt vmcnt(16)
  s_barrier
  s_add_u32 s60, s70, 256
  s_add_u32 m0, s69, 34816
  s_nop 0
  buffer_load_dwordx4 v11, s[4:7], s60 offen offset:0 lds
  s_add_u32 s60, s70, 8448
  s_add_u32 m0, s69, 35840
  s_nop 0
  buffer_load_dwordx4 v12, s[4:7], s60 offen offset:0 lds
  s_add_u32 s60, s70, 16640
  s_add_u32 m0, s69, 36864
  s_nop 0
  buffer_load_dwordx4 v11, s[4:7], s60 offen offset:0 lds
  s_add_u32 s60, s70, 24832
  s_add_u32 m0, s69, 37888
  s_nop 0
  buffer_load_dwordx4 v12, s[4:7], s60 offen offset:0 lds
  s_add_u32 s60, s70, 33024
  s_add_u32 m0, s69, 38912
  s_nop 0
  buffer_load_dwordx4 v11, s[4:7], s60 offen offset:0 lds
  s_add_u32 s60, s70, 41216
  s_add_u32 m0, s69, 39936
  s_nop 0
  buffer_load_dwordx4 v12, s[4:7], s60 offen offset:0 lds
  s_add_u32 s60, s70, 49408
  s_add_u32 m0, s69, 40960
  s_nop 0
  buffer_load_dwordx4 v11, s[4:7], s60 offen offset:0 lds
  s_add_u32 s60, s70, 57600
  s_add_u32 m0, s69, 41984
  s_nop 0
  buffer_load_dwordx4 v12, s[4:7], s60 offen offset:0 lds
  v_add_u32 v108, 52224, v20
  v_xor_b32 v110, 0, v108
  v_xor_b32 v111, 16, v108
  v_xor_b32 v112, 32, v108
  v_xor_b32 v113, 48, v108
  v_xor_b32 v114, 64, v108
  v_xor_b32 v115, 80, v108
  v_xor_b32 v116, 96, v108
  v_xor_b32 v117, 112, v108
  ds_read_b128 v[48:51], v110 offset:0
  ds_read_b128 v[52:55], v111 offset:0
  ds_read_b128 v[56:59], v112 offset:0
  ds_read_b128 v[60:63], v113 offset:0
  ds_read_b128 v[64:67], v114 offset:0
  ds_read_b128 v[68:71], v115 offset:0
  ds_read_b128 v[72:75], v116 offset:0
  ds_read_b128 v[76:79], v117 offset:0
  s_waitcnt lgkmcnt(7)
  v_dot2c_f32_bf16 v23, v48, v26
  v_dot2c_f32_bf16 v24, v48, v48
  v_dot2c_f32_bf16 v23, v49, v26
  v_dot2c_f32_bf16 v24, v49, v49
  v_dot2c_f32_bf16 v23, v50, v26
  v_dot2c_f32_bf16 v24, v50, v50
  v_dot2c_f32_bf16 v23, v51, v26
  v_dot2c_f32_bf16 v24, v51, v51
  s_waitcnt lgkmcnt(6)
  v_dot2c_f32_bf16 v23, v52, v26
  v_dot2c_f32_bf16 v24, v52, v52
  v_dot2c_f32_bf16 v23, v53, v26
  v_dot2c_f32_bf16 v24, v53, v53
  v_dot2c_f32_bf16 v23, v54, v26
  v_dot2c_f32_bf16 v24, v54, v54
  v_dot2c_f32_bf16 v23, v55, v26
  v_dot2c_f32_bf16 v24, v55, v55
  s_waitcnt lgkmcnt(5)
  v_dot2c_f32_bf16 v23, v56, v26
  v_dot2c_f32_bf16 v24, v56, v56
  v_dot2c_f32_bf16 v23, v57, v26
  v_dot2c_f32_bf16 v24, v57, v57
  v_dot2c_f32_bf16 v23, v58, v26
  v_dot2c_f32_bf16 v24, v58, v58
  v_dot2c_f32_bf16 v23, v59, v26
  v_dot2c_f32_bf16 v24, v59, v59
  s_waitcnt lgkmcnt(4)
  v_dot2c_f32_bf16 v23, v60, v26
  v_dot2c_f32_bf16 v24, v60, v60
  v_dot2c_f32_bf16 v23, v61, v26
  v_dot2c_f32_bf16 v24, v61, v61
  v_dot2c_f32_bf16 v23, v62, v26
  v_dot2c_f32_bf16 v24, v62, v62
  v_dot2c_f32_bf16 v23, v63, v26
  v_dot2c_f32_bf16 v24, v63, v63
  s_waitcnt lgkmcnt(3)
  v_dot2c_f32_bf16 v23, v64, v26
  v_dot2c_f32_bf16 v24, v64, v64
  v_dot2c_f32_bf16 v23, v65, v26
  v_dot2c_f32_bf16 v24, v65, v65
  v_dot2c_f32_bf16 v23, v66, v26
  v_dot2c_f32_bf16 v24, v66, v66
  v_dot2c_f32_bf16 v23, v67, v26
  v_dot2c_f32_bf16 v24, v67, v67
  s_waitcnt lgkmcnt(2)
  v_dot2c_f32_bf16 v23, v68, v26
  v_dot2c_f32_bf16 v24, v68, v68
  v_dot2c_f32_bf16 v23, v69, v26
  v_dot2c_f32_bf16 v24, v69, v69
  v_dot2c_f32_bf16 v23, v70, v26
  v_dot2c_f32_bf16 v24, v70, v70
  v_dot2c_f32_bf16 v23, v71, v26
  v_dot2c_f32_bf16 v24, v71, v71
  s_waitcnt lgkmcnt(1)
  v_dot2c_f32_bf16 v23, v72, v26
  v_dot2c_f32_bf16 v24, v72, v72
  v_dot2c_f32_bf16 v23, v73, v26
  v_dot2c_f32_bf16 v24, v73, v73
  v_dot2c_f32_bf16 v23, v74, v26
  v_dot2c_f32_bf16 v24, v74, v74
  v_dot2c_f32_bf16 v23, v75, v26
  v_dot2c_f32_bf16 v24, v75, v75
  s_waitcnt lgkmcnt(0)
  v_dot2c_f32_bf16 v23, v76, v26
  v_dot2c_f32_bf16 v24, v76, v76
  v_dot2c_f32_bf16 v23, v77, v26
  v_dot2c_f32_bf16 v24, v77, v77
  v_dot2c_f32_bf16 v23, v78, v26
  v_dot2c_f32_bf16 v24, v78, v78
  v_dot2c_f32_bf16 v23, v79, v26
  v_dot2c_f32_bf16 v24, v79, v79
  s_nop 1
  v_mov_b32 v48, v23
  s_nop 1
  v_permlane32_swap_b32 v23, v48
  v_add_f32 v23, v23, v48
  v_mov_b32 v49, v24
  s_nop 1
  v_permlane32_swap_b32 v24, v49
  v_add_f32 v24, v24, v49
  v_mul_f32 v23, 0x3b000000, v23
  v_mul_f32 v24, 0x3b000000, v24
  v_fma_f32 v48, -v23, v23, v24
  v_max_f32 v48, 0, v48
  v_add_f32 v49, 0x3727c5ac, v48
  v_rsq_f32 v50, v49
  s_nop 0
  v_mul_f32 v51, v23, v50
  ds_write_b32 v31, v50 offset:0
  ds_write_b32 v31, v51 offset:512
  v_mul_f32 v52, v50, v50
  v_mul_f32 v52, v52, v48
  v_add_f32 v52, 0x3727c5ac, v52
  v_rsq_f32 v53, v52
  s_nop 0
  v_mul_f32 v53, v53, v50
  v_mul_f32 v54, v23, v53
  ds_write_b32 v31, v53 offset:1024
  ds_write_b32 v31, v54 offset:1536
  s_waitcnt lgkmcnt(0)
  s_waitcnt vmcnt(16)
  s_barrier
  s_add_u32 s60, s70, 384
  s_add_u32 m0, s69, 52224
  s_nop 0
  buffer_load_dwordx4 v11, s[4:7], s60 offen offset:0 lds
  s_add_u32 s60, s70, 8576
  s_add_u32 m0, s69, 53248
  s_nop 0
  buffer_load_dwordx4 v12, s[4:7], s60 offen offset:0 lds
  s_add_u32 s60, s70, 16768
  s_add_u32 m0, s69, 54272
  s_nop 0
  buffer_load_dwordx4 v11, s[4:7], s60 offen offset:0 lds
  s_add_u32 s60, s70, 24960
  s_add_u32 m0, s69, 55296
  s_nop 0
  buffer_load_dwordx4 v12, s[4:7], s60 offen offset:0 lds
  s_add_u32 s60, s70, 33152
  s_add_u32 m0, s69, 56320
  s_nop 0
  buffer_load_dwordx4 v11, s[4:7], s60 offen offset:0 lds
  s_add_u32 s60, s70, 41344
  s_add_u32 m0, s69, 57344
  s_nop 0
  buffer_load_dwordx4 v12, s[4:7], s60 offen offset:0 lds
  s_add_u32 s60, s70, 49536
  s_add_u32 m0, s69, 58368
  s_nop 0
  buffer_load_dwordx4 v11, s[4:7], s60 offen offset:0 lds
  s_add_u32 s60, s70, 57728
  s_add_u32 m0, s69, 59392
  s_nop 0
  buffer_load_dwordx4 v12, s[4:7], s60 offen offset:0 lds
  v_mov_b32 v23, 0
  v_mov_b32 v24, 0
  v_mov_b32 v25, 0
  v_add_u32 v108, 0, v21
  v_xor_b32 v110, 0, v108
  v_xor_b32 v111, 16, v108
  v_xor_b32 v112, 32, v108
  v_xor_b32 v113, 48, v108
  ds_read_b128 v[48:51], v110 offset:0
  ds_read_b128 v[52:55], v111 offset:0
  ds_read_b128 v[56:59], v112 offset:0
  ds_read_b128 v[60:63], v113 offset:0
  s_waitcnt lgkmcnt(3)
  v_dot2c_f32_bf16 v23, v48, v26
  v_dot2c_f32_bf16 v24, v48, v48
  v_dot2c_f32_bf16 v23, v49, v26
  v_dot2c_f32_bf16 v24, v49, v49
  v_dot2c_f32_bf16 v23, v50, v26
  v_dot2c_f32_bf16 v24, v50, v50
  v_dot2c_f32_bf16 v23, v51, v26
  v_dot2c_f32_bf16 v24, v51, v51
  s_waitcnt lgkmcnt(2)
  v_dot2c_f32_bf16 v23, v52, v26
  v_dot2c_f32_bf16 v24, v52, v52
  v_dot2c_f32_bf16 v23, v53, v26
  v_dot2c_f32_bf16 v24, v53, v53
  v_dot2c_f32_bf16 v23, v54, v26
  v_dot2c_f32_bf16 v24, v54, v54
  v_dot2c_f32_bf16 v23, v55, v26
  v_dot2c_f32_bf16 v24, v55, v55
  s_waitcnt lgkmcnt(1)
  v_dot2c_f32_bf16 v23, v56, v26
  v_dot2c_f32_bf16 v24, v56, v56
  v_dot2c_f32_bf16 v23, v57, v26
  v_dot2c_f32_bf16 v24, v57, v57
  v_dot2c_f32_bf16 v23, v58, v26
  v_dot2c_f32_bf16 v24, v58, v58
  v_dot2c_f32_bf16 v23, v59, v26
  v_dot2c_f32_bf16 v24, v59, v59
  s_waitcnt lgkmcnt(0)
  v_dot2c_f32_bf16 v23, v60, v26
  v_dot2c_f32_bf16 v24, v60, v60
  v_dot2c_f32_bf16 v23, v61, v26
  v_dot2c_f32_bf16 v24, v61, v61
  v_dot2c_f32_bf16 v23, v62, v26
  v_dot2c_f32_bf16 v24, v62, v62
  v_dot2c_f32_bf16 v23, v63, v26
  v_dot2c_f32_bf16 v24, v63, v63
  v_add_u32 v109, 135168, v29
  ds_read_b64_tr_b16 v[88:89], v109 offset:0
  ds_read_b64_tr_b16 v[90:91], v109 offset:768
  ds_read_b64_tr_b16 v[92:93], v109 offset:3072
  ds_read_b64_tr_b16 v[94:95], v109 offset:3840
  ds_read_b64_tr_b16 v[96:97], v109 offset:6144
  ds_read_b64_tr_b16 v[98:99], v109 offset:6912
  ds_read_b64_tr_b16 v[100:101], v109 offset:9216
  ds_read_b64_tr_b16 v[102:103], v109 offset:9984
  s_waitcnt lgkmcnt(7)
  v_dot2c_f32_bf16 v25, v88, v26
  v_dot2c_f32_bf16 v25, v89, v26
  s_waitcnt lgkmcnt(6)
  v_dot2c_f32_bf16 v25, v90, v26
  v_dot2c_f32_bf16 v25, v91, v26
  s_waitcnt lgkmcnt(5)
  v_dot2c_f32_bf16 v25, v92, v26
  v_dot2c_f32_bf16 v25, v93, v26
  s_waitcnt lgkmcnt(4)
  v_dot2c_f32_bf16 v25, v94, v26
  v_dot2c_f32_bf16 v25, v95, v26
  s_waitcnt lgkmcnt(3)
  v_dot2c_f32_bf16 v25, v96, v26
  v_dot2c_f32_bf16 v25, v97, v26
  s_waitcnt lgkmcnt(2)
  v_dot2c_f32_bf16 v25, v98, v26
  v_dot2c_f32_bf16 v25, v99, v26
  s_waitcnt lgkmcnt(1)
  v_dot2c_f32_bf16 v25, v100, v26
  v_dot2c_f32_bf16 v25, v101, v26
  s_waitcnt lgkmcnt(0)
  v_dot2c_f32_bf16 v25, v102, v26
  v_dot2c_f32_bf16 v25, v103, v26
  s_waitcnt vmcnt(16)
  s_barrier
  s_add_u32 s60, s70, 512
  s_add_u32 m0, s69, 0
  s_nop 0
  buffer_load_dwordx4 v11, s[4:7], s60 offen offset:0 lds
  s_add_u32 s60, s70, 8704
  s_add_u32 m0, s69, 1024
  s_nop 0
  buffer_load_dwordx4 v12, s[4:7], s60 offen offset:0 lds
  s_add_u32 s60, s70, 16896
  s_add_u32 m0, s69, 2048
  s_nop 0
  buffer_load_dwordx4 v11, s[4:7], s60 offen offset:0 lds
  s_add_u32 s60, s70, 25088
  s_add_u32 m0, s69, 3072
  s_nop 0
  buffer_load_dwordx4 v12, s[4:7], s60 offen offset:0 lds
  s_add_u32 s60, s70, 33280
  s_add_u32 m0, s69, 4096
  s_nop 0
  buffer_load_dwordx4 v11, s[4:7], s60 offen offset:0 lds
  s_add_u32 s60, s70, 41472
  s_add_u32 m0, s69, 5120
  s_nop 0
  buffer_load_dwordx4 v12, s[4:7], s60 offen offset:0 lds
  s_add_u32 s60, s70, 49664
  s_add_u32 m0, s69, 6144
  s_nop 0
  buffer_load_dwordx4 v11, s[4:7], s60 offen offset:0 lds
  s_add_u32 s60, s70, 57856
  s_add_u32 m0, s69, 7168
  s_nop 0
  buffer_load_dwordx4 v12, s[4:7], s60 offen offset:0 lds
  v_add_u32 v108, 17408, v21
  v_xor_b32 v110, 0, v108
  v_xor_b32 v111, 16, v108
  v_xor_b32 v112, 32, v108
  v_xor_b32 v113, 48, v108
  ds_read_b128 v[48:51], v110 offset:0
  ds_read_b128 v[52:55], v111 offset:0
  ds_read_b128 v[56:59], v112 offset:0
  ds_read_b128 v[60:63], v113 offset:0
  s_waitcnt lgkmcnt(3)
  v_dot2c_f32_bf16 v23, v48, v26
  v_dot2c_f32_bf16 v24, v48, v48
  v_dot2c_f32_bf16 v23, v49, v26
  v_dot2c_f32_bf16 v24, v49, v49
  v_dot2c_f32_bf16 v23, v50, v26
  v_dot2c_f32_bf16 v24, v50, v50
  v_dot2c_f32_bf16 v23, v51, v26
  v_dot2c_f32_bf16 v24, v51, v51
  s_waitcnt lgkmcnt(2)
  v_dot2c_f32_bf16 v23, v52, v26
  v_dot2c_f32_bf16 v24, v52, v52
  v_dot2c_f32_bf16 v23, v53, v26
  v_dot2c_f32_bf16 v24, v53, v53
  v_dot2c_f32_bf16 v23, v54, v26
  v_dot2c_f32_bf16 v24, v54, v54
  v_dot2c_f32_bf16 v23, v55, v26
  v_dot2c_f32_bf16 v24, v55, v55
  s_waitcnt lgkmcnt(1)
  v_dot2c_f32_bf16 v23, v56, v26
  v_dot2c_f32_bf16 v24, v56, v56
  v_dot2c_f32_bf16 v23, v57, v26
  v_dot2c_f32_bf16 v24, v57, v57
  v_dot2c_f32_bf16 v23, v58, v26
  v_dot2c_f32_bf16 v24, v58, v58
  v_dot2c_f32_bf16 v23, v59, v26
  v_dot2c_f32_bf16 v24, v59, v59
  s_waitcnt lgkmcnt(0)
  v_dot2c_f32_bf16 v23, v60, v26
  v_dot2c_f32_bf16 v24, v60, v60
  v_dot2c_f32_bf16 v23, v61, v26
  v_dot2c_f32_bf16 v24, v61, v61
  v_dot2c_f32_bf16 v23, v62, v26
  v_dot2c_f32_bf16 v24, v62, v62
  v_dot2c_f32_bf16 v23, v63, v26
  v_dot2c_f32_bf16 v24, v63, v63
  v_add_u32 v109, 69632, v29
  ds_read_b64_tr_b16 v[88:89], v109 offset:0
  ds_read_b64_tr_b16 v[90:91], v109 offset:768
  ds_read_b64_tr_b16 v[92:93], v109 offset:3072
  ds_read_b64_tr_b16 v[94:95], v109 offset:3840
  ds_read_b64_tr_b16 v[96:97], v109 offset:6144
  ds_read_b64_tr_b16 v[98:99], v109 offset:6912
  ds_read_b64_tr_b16 v[100:101], v109 offset:9216
  ds_read_b64_tr_b16 v[102:103], v109 offset:9984
  s_waitcnt lgkmcnt(7)
  v_dot2c_f32_bf16 v25, v88, v26
  v_dot2c_f32_bf16 v25, v89, v26
  s_waitcnt lgkmcnt(6)
  v_dot2c_f32_bf16 v25, v90, v26
  v_dot2c_f32_bf16 v25, v91, v26
  s_waitcnt lgkmcnt(5)
  v_dot2c_f32_bf16 v25, v92, v26
  v_dot2c_f32_bf16 v25, v93, v26
  s_waitcnt lgkmcnt(4)
  v_dot2c_f32_bf16 v25, v94, v26
  v_dot2c_f32_bf16 v25, v95, v26
  s_waitcnt lgkmcnt(3)
  v_dot2c_f32_bf16 v25, v96, v26
  v_dot2c_f32_bf16 v25, v97, v26
  s_waitcnt lgkmcnt(2)
  v_dot2c_f32_bf16 v25, v98, v26
  v_dot2c_f32_bf16 v25, v99, v26
  s_waitcnt lgkmcnt(1)
  v_dot2c_f32_bf16 v25, v100, v26
  v_dot2c_f32_bf16 v25, v101, v26
  s_waitcnt lgkmcnt(0)
  v_dot2c_f32_bf16 v25, v102, v26
  v_dot2c_f32_bf16 v25, v103, v26
  s_waitcnt vmcnt(16)
  s_barrier
  v_mov_b32 v48, 162304
  ds_read_b32 v27, v48
  s_waitcnt lgkmcnt(0)
  v_readfirstlane_b32 s56, v27
  s_add_u32 s60, s70, 640
  s_add_u32 m0, s69, 17408
  s_nop 0
  buffer_load_dwordx4 v11, s[4:7], s60 offen offset:0 lds
  s_add_u32 s60, s70, 8832
  s_add_u32 m0, s69, 18432
  s_nop 0
  buffer_load_dwordx4 v12, s[4:7], s60 offen offset:0 lds
  s_add_u32 s60, s70, 17024
  s_add_u32 m0, s69, 19456
  s_nop 0
  buffer_load_dwordx4 v11, s[4:7], s60 offen offset:0 lds
  s_add_u32 s60, s70, 25216
  s_add_u32 m0, s69, 20480
  s_nop 0
  buffer_load_dwordx4 v12, s[4:7], s60 offen offset:0 lds
  s_add_u32 s60, s70, 33408
  s_add_u32 m0, s69, 21504
  s_nop 0
  buffer_load_dwordx4 v11, s[4:7], s60 offen offset:0 lds
  s_add_u32 s60, s70, 41600
  s_add_u32 m0, s69, 22528
  s_nop 0
  buffer_load_dwordx4 v12, s[4:7], s60 offen offset:0 lds
  s_add_u32 s60, s70, 49792
  s_add_u32 m0, s69, 23552
  s_nop 0
  buffer_load_dwordx4 v11, s[4:7], s60 offen offset:0 lds
  s_add_u32 s60, s70, 57984
  s_add_u32 m0, s69, 24576
  s_nop 0
  buffer_load_dwordx4 v12, s[4:7], s60 offen offset:0 lds
  v_add_u32 v108, 34816, v21
  v_xor_b32 v110, 0, v108
  v_xor_b32 v111, 16, v108
  v_xor_b32 v112, 32, v108
  v_xor_b32 v113, 48, v108
  ds_read_b128 v[48:51], v110 offset:0
  ds_read_b128 v[52:55], v111 offset:0
  ds_read_b128 v[56:59], v112 offset:0
  ds_read_b128 v[60:63], v113 offset:0
  s_waitcnt lgkmcnt(3)
  v_dot2c_f32_bf16 v23, v48, v26
  v_dot2c_f32_bf16 v24, v48, v48
  v_dot2c_f32_bf16 v23, v49, v26
  v_dot2c_f32_bf16 v24, v49, v49
  v_dot2c_f32_bf16 v23, v50, v26
  v_dot2c_f32_bf16 v24, v50, v50
  v_dot2c_f32_bf16 v23, v51, v26
  v_dot2c_f32_bf16 v24, v51, v51
  s_waitcnt lgkmcnt(2)
  v_dot2c_f32_bf16 v23, v52, v26
  v_dot2c_f32_bf16 v24, v52, v52
  v_dot2c_f32_bf16 v23, v53, v26
  v_dot2c_f32_bf16 v24, v53, v53
  v_dot2c_f32_bf16 v23, v54, v26
  v_dot2c_f32_bf16 v24, v54, v54
  v_dot2c_f32_bf16 v23, v55, v26
  v_dot2c_f32_bf16 v24, v55, v55
  s_waitcnt lgkmcnt(1)
  v_dot2c_f32_bf16 v23, v56, v26
  v_dot2c_f32_bf16 v24, v56, v56
  v_dot2c_f32_bf16 v23, v57, v26
  v_dot2c_f32_bf16 v24, v57, v57
  v_dot2c_f32_bf16 v23, v58, v26
  v_dot2c_f32_bf16 v24, v58, v58
  v_dot2c_f32_bf16 v23, v59, v26
  v_dot2c_f32_bf16 v24, v59, v59
  s_waitcnt lgkmcnt(0)
  v_dot2c_f32_bf16 v23, v60, v26
  v_dot2c_f32_bf16 v24, v60, v60
  v_dot2c_f32_bf16 v23, v61, v26
  v_dot2c_f32_bf16 v24, v61, v61
  v_dot2c_f32_bf16 v23, v62, v26
  v_dot2c_f32_bf16 v24, v62, v62
  v_dot2c_f32_bf16 v23, v63, v26
  v_dot2c_f32_bf16 v24, v63, v63
  v_add_u32 v109, 86016, v29
  ds_read_b64_tr_b16 v[88:89], v109 offset:0
  ds_read_b64_tr_b16 v[90:91], v109 offset:768
  ds_read_b64_tr_b16 v[92:93], v109 offset:3072
  ds_read_b64_tr_b16 v[94:95], v109 offset:3840
  ds_read_b64_tr_b16 v[96:97], v109 offset:6144
  ds_read_b64_tr_b16 v[98:99], v109 offset:6912
  ds_read_b64_tr_b16 v[100:101], v109 offset:9216
  ds_read_b64_tr_b16 v[102:103], v109 offset:9984
  s_waitcnt lgkmcnt(7)
  v_dot2c_f32_bf16 v25, v88, v26
  v_dot2c_f32_bf16 v25, v89, v26
  s_waitcnt lgkmcnt(6)
  v_dot2c_f32_bf16 v25, v90, v26
  v_dot2c_f32_bf16 v25, v91, v26
  s_waitcnt lgkmcnt(5)
  v_dot2c_f32_bf16 v25, v92, v26
  v_dot2c_f32_bf16 v25, v93, v26
  s_waitcnt lgkmcnt(4)
  v_dot2c_f32_bf16 v25, v94, v26
  v_dot2c_f32_bf16 v25, v95, v26
  s_waitcnt lgkmcnt(3)
  v_dot2c_f32_bf16 v25, v96, v26
  v_dot2c_f32_bf16 v25, v97, v26
  s_waitcnt lgkmcnt(2)
  v_dot2c_f32_bf16 v25, v98, v26
  v_dot2c_f32_bf16 v25, v99, v26
  s_waitcnt lgkmcnt(1)
  v_dot2c_f32_bf16 v25, v100, v26
  v_dot2c_f32_bf16 v25, v101, v26
  s_waitcnt lgkmcnt(0)
  v_dot2c_f32_bf16 v25, v102, v26
  v_dot2c_f32_bf16 v25, v103, v26
  s_waitcnt vmcnt(16)
  s_barrier
  s_add_u32 s60, s70, 768
  s_add_u32 m0, s69, 34816
  s_nop 0
  buffer_load_dwordx4 v11, s[4:7], s60 offen offset:0 lds
  s_add_u32 s60, s70, 8960
  s_add_u32 m0, s69, 35840
  s_nop 0
  buffer_load_dwordx4 v12, s[4:7], s60 offen offset:0 lds
  s_add_u32 s60, s70, 17152
  s_add_u32 m0, s69, 36864
  s_nop 0
  buffer_load_dwordx4 v11, s[4:7], s60 offen offset:0 lds
  s_add_u32 s60, s70, 25344
  s_add_u32 m0, s69, 37888
  s_nop 0
  buffer_load_dwordx4 v12, s[4:7], s60 offen offset:0 lds
  s_add_u32 s60, s70, 33536
  s_add_u32 m0, s69, 38912
  s_nop 0
  buffer_load_dwordx4 v11, s[4:7], s60 offen offset:0 lds
  s_add_u32 s60, s70, 41728
  s_add_u32 m0, s69, 39936
  s_nop 0
  buffer_load_dwordx4 v12, s[4:7], s60 offen offset:0 lds
  s_add_u32 s60, s70, 49920
  s_add_u32 m0, s69, 40960
  s_nop 0
  buffer_load_dwordx4 v11, s[4:7], s60 offen offset:0 lds
  s_add_u32 s60, s70, 58112
  s_add_u32 m0, s69, 41984
  s_nop 0
  buffer_load_dwordx4 v12, s[4:7], s60 offen offset:0 lds
  v_add_u32 v108, 52224, v21
  v_xor_b32 v110, 0, v108
  v_xor_b32 v111, 16, v108
  v_xor_b32 v112, 32, v108
  v_xor_b32 v113, 48, v108
  ds_read_b128 v[48:51], v110 offset:0
  ds_read_b128 v[52:55], v111 offset:0
  ds_read_b128 v[56:59], v112 offset:0
  ds_read_b128 v[60:63], v113 offset:0
  s_waitcnt lgkmcnt(3)
  v_dot2c_f32_bf16 v23, v48, v26
  v_dot2c_f32_bf16 v24, v48, v48
  v_dot2c_f32_bf16 v23, v49, v26
  v_dot2c_f32_bf16 v24, v49, v49
  v_dot2c_f32_bf16 v23, v50, v26
  v_dot2c_f32_bf16 v24, v50, v50
  v_dot2c_f32_bf16 v23, v51, v26
  v_dot2c_f32_bf16 v24, v51, v51
  s_waitcnt lgkmcnt(2)
  v_dot2c_f32_bf16 v23, v52, v26
  v_dot2c_f32_bf16 v24, v52, v52
  v_dot2c_f32_bf16 v23, v53, v26
  v_dot2c_f32_bf16 v24, v53, v53
  v_dot2c_f32_bf16 v23, v54, v26
  v_dot2c_f32_bf16 v24, v54, v54
  v_dot2c_f32_bf16 v23, v55, v26
  v_dot2c_f32_bf16 v24, v55, v55
  s_waitcnt lgkmcnt(1)
  v_dot2c_f32_bf16 v23, v56, v26
  v_dot2c_f32_bf16 v24, v56, v56
  v_dot2c_f32_bf16 v23, v57, v26
  v_dot2c_f32_bf16 v24, v57, v57
  v_dot2c_f32_bf16 v23, v58, v26
  v_dot2c_f32_bf16 v24, v58, v58
  v_dot2c_f32_bf16 v23, v59, v26
  v_dot2c_f32_bf16 v24, v59, v59
  s_waitcnt lgkmcnt(0)
  v_dot2c_f32_bf16 v23, v60, v26
  v_dot2c_f32_bf16 v24, v60, v60
  v_dot2c_f32_bf16 v23, v61, v26
  v_dot2c_f32_bf16 v24, v61, v61
  v_dot2c_f32_bf16 v23, v62, v26
  v_dot2c_f32_bf16 v24, v62, v62
  v_dot2c_f32_bf16 v23, v63, v26
  v_dot2c_f32_bf16 v24, v63, v63
  v_add_u32 v109, 102400, v29
  ds_read_b64_tr_b16 v[88:89], v109 offset:0
  ds_read_b64_tr_b16 v[90:91], v109 offset:768
  ds_read_b64_tr_b16 v[92:93], v109 offset:3072
  ds_read_b64_tr_b16 v[94:95], v109 offset:3840
  ds_read_b64_tr_b16 v[96:97], v109 offset:6144
  ds_read_b64_tr_b16 v[98:99], v109 offset:6912
  ds_read_b64_tr_b16 v[100:101], v109 offset:9216
  ds_read_b64_tr_b16 v[102:103], v109 offset:9984
  s_waitcnt lgkmcnt(7)
  v_dot2c_f32_bf16 v25, v88, v26
  v_dot2c_f32_bf16 v25, v89, v26
  s_waitcnt lgkmcnt(6)
  v_dot2c_f32_bf16 v25, v90, v26
  v_dot2c_f32_bf16 v25, v91, v26
  s_waitcnt lgkmcnt(5)
  v_dot2c_f32_bf16 v25, v92, v26
  v_dot2c_f32_bf16 v25, v93, v26
  s_waitcnt lgkmcnt(4)
  v_dot2c_f32_bf16 v25, v94, v26
  v_dot2c_f32_bf16 v25, v95, v26
  s_waitcnt lgkmcnt(3)
  v_dot2c_f32_bf16 v25, v96, v26
  v_dot2c_f32_bf16 v25, v97, v26
  s_waitcnt lgkmcnt(2)
  v_dot2c_f32_bf16 v25, v98, v26
  v_dot2c_f32_bf16 v25, v99, v26
  s_waitcnt lgkmcnt(1)
  v_dot2c_f32_bf16 v25, v100, v26
  v_dot2c_f32_bf16 v25, v101, v26
  s_waitcnt lgkmcnt(0)
  v_dot2c_f32_bf16 v25, v102, v26
  v_dot2c_f32_bf16 v25, v103, v26
  s_waitcnt vmcnt(16)
  s_barrier
  s_add_u32 s60, s70, 896
  s_add_u32 m0, s69, 52224
  s_nop 0
  buffer_load_dwordx4 v11, s[4:7], s60 offen offset:0 lds
  s_add_u32 s60, s70, 9088
  s_add_u32 m0, s69, 53248
  s_nop 0
  buffer_load_dwordx4 v12, s[4:7], s60 offen offset:0 lds
  s_add_u32 s60, s70, 17280
  s_add_u32 m0, s69, 54272
  s_nop 0
  buffer_load_dwordx4 v11, s[4:7], s60 offen offset:0 lds
  s_add_u32 s60, s70, 25472
  s_add_u32 m0, s69, 55296
  s_nop 0
  buffer_load_dwordx4 v12, s[4:7], s60 offen offset:0 lds
  s_add_u32 s60, s70, 33664
  s_add_u32 m0, s69, 56320
  s_nop 0
  buffer_load_dwordx4 v11, s[4:7], s60 offen offset:0 lds
  s_add_u32 s60, s70, 41856
  s_add_u32 m0, s69, 57344
  s_nop 0
  buffer_load_dwordx4 v12, s[4:7], s60 offen offset:0 lds
  s_add_u32 s60, s70, 50048
  s_add_u32 m0, s69, 58368
  s_nop 0
  buffer_load_dwordx4 v11, s[4:7], s60 offen offset:0 lds
  s_add_u32 s60, s70, 58240
  s_add_u32 m0, s69, 59392
  s_nop 0
  buffer_load_dwordx4 v12, s[4:7], s60 offen offset:0 lds
  v_add_u32 v108, 0, v21
  v_xor_b32 v110, 0, v108
  v_xor_b32 v111, 16, v108
  v_xor_b32 v112, 32, v108
  v_xor_b32 v113, 48, v108
  ds_read_b128 v[48:51], v110 offset:0
  ds_read_b128 v[52:55], v111 offset:0
  ds_read_b128 v[56:59], v112 offset:0
  ds_read_b128 v[60:63], v113 offset:0
  s_waitcnt lgkmcnt(3)
  v_dot2c_f32_bf16 v23, v48, v26
  v_dot2c_f32_bf16 v24, v48, v48
  v_dot2c_f32_bf16 v23, v49, v26
  v_dot2c_f32_bf16 v24, v49, v49
  v_dot2c_f32_bf16 v23, v50, v26
  v_dot2c_f32_bf16 v24, v50, v50
  v_dot2c_f32_bf16 v23, v51, v26
  v_dot2c_f32_bf16 v24, v51, v51
  s_waitcnt lgkmcnt(2)
  v_dot2c_f32_bf16 v23, v52, v26
  v_dot2c_f32_bf16 v24, v52, v52
  v_dot2c_f32_bf16 v23, v53, v26
  v_dot2c_f32_bf16 v24, v53, v53
  v_dot2c_f32_bf16 v23, v54, v26
  v_dot2c_f32_bf16 v24, v54, v54
  v_dot2c_f32_bf16 v23, v55, v26
  v_dot2c_f32_bf16 v24, v55, v55
  s_waitcnt lgkmcnt(1)
  v_dot2c_f32_bf16 v23, v56, v26
  v_dot2c_f32_bf16 v24, v56, v56
  v_dot2c_f32_bf16 v23, v57, v26
  v_dot2c_f32_bf16 v24, v57, v57
  v_dot2c_f32_bf16 v23, v58, v26
  v_dot2c_f32_bf16 v24, v58, v58
  v_dot2c_f32_bf16 v23, v59, v26
  v_dot2c_f32_bf16 v24, v59, v59
  s_waitcnt lgkmcnt(0)
  v_dot2c_f32_bf16 v23, v60, v26
  v_dot2c_f32_bf16 v24, v60, v60
  v_dot2c_f32_bf16 v23, v61, v26
  v_dot2c_f32_bf16 v24, v61, v61
  v_dot2c_f32_bf16 v23, v62, v26
  v_dot2c_f32_bf16 v24, v62, v62
  v_dot2c_f32_bf16 v23, v63, v26
  v_dot2c_f32_bf16 v24, v63, v63
  v_add_u32 v109, 118784, v29
  ds_read_b64_tr_b16 v[88:89], v109 offset:0
  ds_read_b64_tr_b16 v[90:91], v109 offset:768
  ds_read_b64_tr_b16 v[92:93], v109 offset:3072
  ds_read_b64_tr_b16 v[94:95], v109 offset:3840
  ds_read_b64_tr_b16 v[96:97], v109 offset:6144
  ds_read_b64_tr_b16 v[98:99], v109 offset:6912
  ds_read_b64_tr_b16 v[100:101], v109 offset:9216
  ds_read_b64_tr_b16 v[102:103], v109 offset:9984
  s_waitcnt lgkmcnt(7)
  v_dot2c_f32_bf16 v25, v88, v26
  v_dot2c_f32_bf16 v25, v89, v26
  s_waitcnt lgkmcnt(6)
  v_dot2c_f32_bf16 v25, v90, v26
  v_dot2c_f32_bf16 v25, v91, v26
  s_waitcnt lgkmcnt(5)
  v_dot2c_f32_bf16 v25, v92, v26
  v_dot2c_f32_bf16 v25, v93, v26
  s_waitcnt lgkmcnt(4)
  v_dot2c_f32_bf16 v25, v94, v26
  v_dot2c_f32_bf16 v25, v95, v26
  s_waitcnt lgkmcnt(3)
  v_dot2c_f32_bf16 v25, v96, v26
  v_dot2c_f32_bf16 v25, v97, v26
  s_waitcnt lgkmcnt(2)
  v_dot2c_f32_bf16 v25, v98, v26
  v_dot2c_f32_bf16 v25, v99, v26
  s_waitcnt lgkmcnt(1)
  v_dot2c_f32_bf16 v25, v100, v26
  v_dot2c_f32_bf16 v25, v101, v26
  s_waitcnt lgkmcnt(0)
  v_dot2c_f32_bf16 v25, v102, v26
  v_dot2c_f32_bf16 v25, v103, v26
  s_waitcnt vmcnt(16)
  s_barrier
  s_mov_b32 s65, 0x10000
L_poll_9:
  buffer_load_dword v48, v15, s[36:39], 0 offen sc1
  s_waitcnt vmcnt(0)
  v_cmp_ne_u32 vcc, s56, v48
  s_nop 1
  s_cbranch_vccz L_polld_10
  s_sub_u32 s65, s65, 1
  s_cmp_eq_u32 s65, 0
  s_cbranch_scc1 L_polld_10
  s_sleep 1
  s_branch L_poll_9
L_polld_10:
  s_add_u32 s60, s71, 0
  s_add_u32 m0, s69, 0
  s_nop 0
  buffer_load_dwordx4 v13, s[36:39], s60 offen offset:0 sc1 lds
  buffer_load_dwordx4 v13, s[36:39], s60 offen offset:1024 sc1 lds
  buffer_load_dwordx4 v13, s[36:39], s60 offen offset:2048 sc1 lds
  buffer_load_dwordx4 v13, s[36:39], s60 offen offset:3072 sc1 lds
  s_add_u32 s60, s71, 4096
  s_add_u32 m0, s69, 4096
  s_nop 0
  buffer_load_dwordx4 v13, s[36:39], s60 offen offset:0 sc1 lds
  buffer_load_dwordx4 v13, s[36:39], s60 offen offset:1024 sc1 lds
  buffer_load_dwordx4 v13, s[36:39], s60 offen offset:2048 sc1 lds
  buffer_load_dwordx4 v13, s[36:39], s60 offen offset:3072 sc1 lds
  v_add_u32 v108, 17408, v21
  v_xor_b32 v110, 0, v108
  v_xor_b32 v111, 16, v108
  v_xor_b32 v112, 32, v108
  v_xor_b32 v113, 48, v108
  ds_read_b128 v[48:51], v110 offset:0
  ds_read_b128 v[52:55], v111 offset:0
  ds_read_b128 v[56:59], v112 offset:0
  ds_read_b128 v[60:63], v113 offset:0
  s_waitcnt lgkmcnt(3)
  v_dot2c_f32_bf16 v23, v48, v26
  v_dot2c_f32_bf16 v24, v48, v48
  v_dot2c_f32_bf16 v23, v49, v26
  v_dot2c_f32_bf16 v24, v49, v49
  v_dot2c_f32_bf16 v23, v50, v26
  v_dot2c_f32_bf16 v24, v50, v50
  v_dot2c_f32_bf16 v23, v51, v26
  v_dot2c_f32_bf16 v24, v51, v51
  s_waitcnt lgkmcnt(2)
  v_dot2c_f32_bf16 v23, v52, v26
  v_dot2c_f32_bf16 v24, v52, v52
  v_dot2c_f32_bf16 v23, v53, v26
  v_dot2c_f32_bf16 v24, v53, v53
  v_dot2c_f32_bf16 v23, v54, v26
  v_dot2c_f32_bf16 v24, v54, v54
  v_dot2c_f32_bf16 v23, v55, v26
  v_dot2c_f32_bf16 v24, v55, v55
  s_waitcnt lgkmcnt(1)
  v_dot2c_f32_bf16 v23, v56, v26
  v_dot2c_f32_bf16 v24, v56, v56
  v_dot2c_f32_bf16 v23, v57, v26
  v_dot2c_f32_bf16 v24, v57, v57
  v_dot2c_f32_bf16 v23, v58, v26
  v_dot2c_f32_bf16 v24, v58, v58
  v_dot2c_f32_bf16 v23, v59, v26
  v_dot2c_f32_bf16 v24, v59, v59
  s_waitcnt lgkmcnt(0)
  v_dot2c_f32_bf16 v23, v60, v26
  v_dot2c_f32_bf16 v24, v60, v60
  v_dot2c_f32_bf16 v23, v61, v26
  v_dot2c_f32_bf16 v24, v61, v61
  v_dot2c_f32_bf16 v23, v62, v26
  v_dot2c_f32_bf16 v24, v62, v62
  v_dot2c_f32_bf16 v23, v63, v26
  v_dot2c_f32_bf16 v24, v63, v63
  v_add_u32 v109, 135168, v29
  ds_read_b64_tr_b16 v[88:89], v109 offset:0
  ds_read_b64_tr_b16 v[90:91], v109 offset:768
  ds_read_b64_tr_b16 v[92:93], v109 offset:3072
  ds_read_b64_tr_b16 v[94:95], v109 offset:3840
  ds_read_b64_tr_b16 v[96:97], v109 offset:6144
  ds_read_b64_tr_b16 v[98:99], v109 offset:6912
  ds_read_b64_tr_b16 v[100:101], v109 offset:9216
  ds_read_b64_tr_b16 v[102:103], v109 offset:9984
  s_waitcnt lgkmcnt(7)
  v_dot2c_f32_bf16 v25, v88, v26
  v_dot2c_f32_bf16 v25, v89, v26
  s_waitcnt lgkmcnt(6)
  v_dot2c_f32_bf16 v25, v90, v26
  v_dot2c_f32_bf16 v25, v91, v26
  s_waitcnt lgkmcnt(5)
  v_dot2c_f32_bf16 v25, v92, v26
  v_dot2c_f32_bf16 v25, v93, v26
  s_waitcnt lgkmcnt(4)
  v_dot2c_f32_bf16 v25, v94, v26
  v_dot2c_f32_bf16 v25, v95, v26
  s_waitcnt lgkmcnt(3)
  v_dot2c_f32_bf16 v25, v96, v26
  v_dot2c_f32_bf16 v25, v97, v26
  s_waitcnt lgkmcnt(2)
  v_dot2c_f32_bf16 v25, v98, v26
  v_dot2c_f32_bf16 v25, v99, v26
  s_waitcnt lgkmcnt(1)
  v_dot2c_f32_bf16 v25, v100, v26
  v_dot2c_f32_bf16 v25, v101, v26
  s_waitcnt lgkmcnt(0)
  v_dot2c_f32_bf16 v25, v102, v26
  v_dot2c_f32_bf16 v25, v103, v26
  s_barrier
  s_add_u32 s60, s71, 8192
  s_add_u32 m0, s69, 17408
  s_nop 0
  buffer_load_dwordx4 v13, s[36:39], s60 offen offset:0 sc1 lds
  buffer_load_dwordx4 v13, s[36:39], s60 offen offset:1024 sc1 lds
  buffer_load_dwordx4 v13, s[36:39], s60 offen offset:2048 sc1 lds
  buffer_load_dwordx4 v13, s[36:39], s60 offen offset:3072 sc1 lds
  s_add_u32 s60, s71, 12288
  s_add_u32 m0, s69, 21504
  s_nop 0
  buffer_load_dwordx4 v13, s[36:39], s60 offen offset:0 sc1 lds
  buffer_load_dwordx4 v13, s[36:39], s60 offen offset:1024 sc1 lds
  buffer_load_dwordx4 v13, s[36:39], s60 offen offset:2048 sc1 lds
  buffer_load_dwordx4 v13, s[36:39], s60 offen offset:3072 sc1 lds
  v_add_u32 v108, 34816, v21
  v_xor_b32 v110, 0, v108
  v_xor_b32 v111, 16, v108
  v_xor_b32 v112, 32, v108
  v_xor_b32 v113, 48, v108
  ds_read_b128 v[48:51], v110 offset:0
  ds_read_b128 v[52:55], v111 offset:0
  ds_read_b128 v[56:59], v112 offset:0
  ds_read_b128 v[60:63], v113 offset:0
  s_waitcnt lgkmcnt(3)
  v_dot2c_f32_bf16 v23, v48, v26
  v_dot2c_f32_bf16 v24, v48, v48
  v_dot2c_f32_bf16 v23, v49, v26
  v_dot2c_f32_bf16 v24, v49, v49
  v_dot2c_f32_bf16 v23, v50, v26
  v_dot2c_f32_bf16 v24, v50, v50
  v_dot2c_f32_bf16 v23, v51, v26
  v_dot2c_f32_bf16 v24, v51, v51
  s_waitcnt lgkmcnt(2)
  v_dot2c_f32_bf16 v23, v52, v26
  v_dot2c_f32_bf16 v24, v52, v52
  v_dot2c_f32_bf16 v23, v53, v26
  v_dot2c_f32_bf16 v24, v53, v53
  v_dot2c_f32_bf16 v23, v54, v26
  v_dot2c_f32_bf16 v24, v54, v54
  v_dot2c_f32_bf16 v23, v55, v26
  v_dot2c_f32_bf16 v24, v55, v55
  s_waitcnt lgkmcnt(1)
  v_dot2c_f32_bf16 v23, v56, v26
  v_dot2c_f32_bf16 v24, v56, v56
  v_dot2c_f32_bf16 v23, v57, v26
  v_dot2c_f32_bf16 v24, v57, v57
  v_dot2c_f32_bf16 v23, v58, v26
  v_dot2c_f32_bf16 v24, v58, v58
  v_dot2c_f32_bf16 v23, v59, v26
  v_dot2c_f32_bf16 v24, v59, v59
  s_waitcnt lgkmcnt(0)
  v_dot2c_f32_bf16 v23, v60, v26
  v_dot2c_f32_bf16 v24, v60, v60
  v_dot2c_f32_bf16 v23, v61, v26
  v_dot2c_f32_bf16 v24, v61, v61
  v_dot2c_f32_bf16 v23, v62, v26
  v_dot2c_f32_bf16 v24, v62, v62
  v_dot2c_f32_bf16 v23, v63, v26
  v_dot2c_f32_bf16 v24, v63, v63
  v_add_u32 v109, 69632, v29
  ds_read_b64_tr_b16 v[88:89], v109 offset:0
  ds_read_b64_tr_b16 v[90:91], v109 offset:768
  ds_read_b64_tr_b16 v[92:93], v109 offset:3072
  ds_read_b64_tr_b16 v[94:95], v109 offset:3840
  ds_read_b64_tr_b16 v[96:97], v109 offset:6144
  ds_read_b64_tr_b16 v[98:99], v109 offset:6912
  ds_read_b64_tr_b16 v[100:101], v109 offset:9216
  ds_read_b64_tr_b16 v[102:103], v109 offset:9984
  s_waitcnt lgkmcnt(7)
  v_dot2c_f32_bf16 v25, v88, v26
  v_dot2c_f32_bf16 v25, v89, v26
  s_waitcnt lgkmcnt(6)
  v_dot2c_f32_bf16 v25, v90, v26
  v_dot2c_f32_bf16 v25, v91, v26
  s_waitcnt lgkmcnt(5)
  v_dot2c_f32_bf16 v25, v92, v26
  v_dot2c_f32_bf16 v25, v93, v26
  s_waitcnt lgkmcnt(4)
  v_dot2c_f32_bf16 v25, v94, v26
  v_dot2c_f32_bf16 v25, v95, v26
  s_waitcnt lgkmcnt(3)
  v_dot2c_f32_bf16 v25, v96, v26
  v_dot2c_f32_bf16 v25, v97, v26
  s_waitcnt lgkmcnt(2)
  v_dot2c_f32_bf16 v25, v98, v26
  v_dot2c_f32_bf16 v25, v99, v26
  s_waitcnt lgkmcnt(1)
  v_dot2c_f32_bf16 v25, v100, v26
  v_dot2c_f32_bf16 v25, v101, v26
  s_waitcnt lgkmcnt(0)
  v_dot2c_f32_bf16 v25, v102, v26
  v_dot2c_f32_bf16 v25, v103, v26
  s_barrier
  s_add_u32 s60, s71, 16384
  s_add_u32 m0, s69, 34816
  s_nop 0
  buffer_load_dwordx4 v13, s[36:39], s60 offen offset:0 sc1 lds
  buffer_load_dwordx4 v13, s[36:39], s60 offen offset:1024 sc1 lds
  buffer_load_dwordx4 v13, s[36:39], s60 offen offset:2048 sc1 lds
  buffer_load_dwordx4 v13, s[36:39], s60 offen offset:3072 sc1 lds
  s_add_u32 s60, s71, 20480
  s_add_u32 m0, s69, 38912
  s_nop 0
  buffer_load_dwordx4 v13, s[36:39], s60 offen offset:0 sc1 lds
  buffer_load_dwordx4 v13, s[36:39], s60 offen offset:1024 sc1 lds
  buffer_load_dwordx4 v13, s[36:39], s60 offen offset:2048 sc1 lds
  buffer_load_dwordx4 v13, s[36:39], s60 offen offset:3072 sc1 lds
  v_add_u32 v108, 52224, v21
  v_xor_b32 v110, 0, v108
  v_xor_b32 v111, 16, v108
  v_xor_b32 v112, 32, v108
  v_xor_b32 v113, 48, v108
  ds_read_b128 v[48:51], v110 offset:0
  ds_read_b128 v[52:55], v111 offset:0
  ds_read_b128 v[56:59], v112 offset:0
  ds_read_b128 v[60:63], v113 offset:0
  s_waitcnt lgkmcnt(3)
  v_dot2c_f32_bf16 v23, v48, v26
  v_dot2c_f32_bf16 v24, v48, v48
  v_dot2c_f32_bf16 v23, v49, v26
  v_dot2c_f32_bf16 v24, v49, v49
  v_dot2c_f32_bf16 v23, v50, v26
  v_dot2c_f32_bf16 v24, v50, v50
  v_dot2c_f32_bf16 v23, v51, v26
  v_dot2c_f32_bf16 v24, v51, v51
  s_waitcnt lgkmcnt(2)
  v_dot2c_f32_bf16 v23, v52, v26
  v_dot2c_f32_bf16 v24, v52, v52
  v_dot2c_f32_bf16 v23, v53, v26
  v_dot2c_f32_bf16 v24, v53, v53
  v_dot2c_f32_bf16 v23, v54, v26
  v_dot2c_f32_bf16 v24, v54, v54
  v_dot2c_f32_bf16 v23, v55, v26
  v_dot2c_f32_bf16 v24, v55, v55
  s_waitcnt lgkmcnt(1)
  v_dot2c_f32_bf16 v23, v56, v26
  v_dot2c_f32_bf16 v24, v56, v56
  v_dot2c_f32_bf16 v23, v57, v26
  v_dot2c_f32_bf16 v24, v57, v57
  v_dot2c_f32_bf16 v23, v58, v26
  v_dot2c_f32_bf16 v24, v58, v58
  v_dot2c_f32_bf16 v23, v59, v26
  v_dot2c_f32_bf16 v24, v59, v59
  s_waitcnt lgkmcnt(0)
  v_dot2c_f32_bf16 v23, v60, v26
  v_dot2c_f32_bf16 v24, v60, v60
  v_dot2c_f32_bf16 v23, v61, v26
  v_dot2c_f32_bf16 v24, v61, v61
  v_dot2c_f32_bf16 v23, v62, v26
  v_dot2c_f32_bf16 v24, v62, v62
  v_dot2c_f32_bf16 v23, v63, v26
  v_dot2c_f32_bf16 v24, v63, v63
  v_add_u32 v109, 86016, v29
  ds_read_b64_tr_b16 v[88:89], v109 offset:0
  ds_read_b64_tr_b16 v[90:91], v109 offset:768
  ds_read_b64_tr_b16 v[92:93], v109 offset:3072
  ds_read_b64_tr_b16 v[94:95], v109 offset:3840
  ds_read_b64_tr_b16 v[96:97], v109 offset:6144
  ds_read_b64_tr_b16 v[98:99], v109 offset:6912
  ds_read_b64_tr_b16 v[100:101], v109 offset:9216
  ds_read_b64_tr_b16 v[102:103], v109 offset:9984
  s_waitcnt lgkmcnt(7)
  v_dot2c_f32_bf16 v25, v88, v26
  v_dot2c_f32_bf16 v25, v89, v26
  s_waitcnt lgkmcnt(6)
  v_dot2c_f32_bf16 v25, v90, v26
  v_dot2c_f32_bf16 v25, v91, v26
  s_waitcnt lgkmcnt(5)
  v_dot2c_f32_bf16 v25, v92, v26
  v_dot2c_f32_bf16 v25, v93, v26
  s_waitcnt lgkmcnt(4)
  v_dot2c_f32_bf16 v25, v94, v26
  v_dot2c_f32_bf16 v25, v95, v26
  s_waitcnt lgkmcnt(3)
  v_dot2c_f32_bf16 v25, v96, v26
  v_dot2c_f32_bf16 v25, v97, v26
  s_waitcnt lgkmcnt(2)
  v_dot2c_f32_bf16 v25, v98, v26
  v_dot2c_f32_bf16 v25, v99, v26
  s_waitcnt lgkmcnt(1)
  v_dot2c_f32_bf16 v25, v100, v26
  v_dot2c_f32_bf16 v25, v101, v26
  s_waitcnt lgkmcnt(0)
  v_dot2c_f32_bf16 v25, v102, v26
  v_dot2c_f32_bf16 v25, v103, v26
  v_mov_b32 v48, v23
  s_nop 1
  v_permlane32_swap_b32 v23, v48
  v_add_f32 v23, v23, v48
  v_mov_b32 v49, v24
  s_nop 1
  v_permlane32_swap_b32 v24, v49
  v_add_f32 v24, v24, v49
  v_mul_f32 v23, 0x3b000000, v23
  v_mul_f32 v24, 0x3b000000, v24
  v_fma_f32 v48, -v23, v23, v24
  v_max_f32 v48, 0, v48
  v_add_f32 v49, 0x3727c5ac, v48
  v_rsq_f32 v50, v49
  s_nop 0
  v_mul_f32 v51, v23, v50
  ds_write_b32 v32, v50 offset:0
  ds_write_b32 v32, v51 offset:512
  s_cmp_eq_u32 s67, 3
  s_cbranch_scc1 L_a1cs_11
  v_mov_b32 v56, v25
  s_nop 1
  v_permlane32_swap_b32 v25, v56
  v_add_f32 v25, v25, v56
  ds_write_b32 v34, v25
L_a1cs_11:
  s_waitcnt lgkmcnt(0)
  s_waitcnt vmcnt(16)
  s_barrier
  s_add_u32 s60, s71, 24576
  s_add_u32 m0, s69, 52224
  s_nop 0
  buffer_load_dwordx4 v13, s[36:39], s60 offen offset:0 sc1 lds
  buffer_load_dwordx4 v13, s[36:39], s60 offen offset:1024 sc1 lds
  buffer_load_dwordx4 v13, s[36:39], s60 offen offset:2048 sc1 lds
  buffer_load_dwordx4 v13, s[36:39], s60 offen offset:3072 sc1 lds
  s_add_u32 s60, s71, 28672
  s_add_u32 m0, s69, 56320
  s_nop 0
  buffer_load_dwordx4 v13, s[36:39], s60 offen offset:0 sc1 lds
  buffer_load_dwordx4 v13, s[36:39], s60 offen offset:1024 sc1 lds
  buffer_load_dwordx4 v13, s[36:39], s60 offen offset:2048 sc1 lds
  buffer_load_dwordx4 v13, s[36:39], s60 offen offset:3072 sc1 lds
  s_waitcnt vmcnt(16)
  s_barrier
  s_waitcnt vmcnt(8)
  s_barrier
  s_mov_b32 s65, 0x10000
L_poll_12:
  buffer_load_dword v48, v16, s[36:39], 0 offen sc1
  s_waitcnt vmcnt(0)
  v_cmp_ne_u32 vcc, s56, v48
  s_nop 1
  s_cbranch_vccz L_polld_13
  s_sub_u32 s65, s65, 1
  s_cmp_eq_u32 s65, 0
  s_cbranch_scc1 L_polld_13
  s_sleep 1
  s_branch L_poll_12
L_polld_13:
  s_add_u32 s60, s75, 0
  s_add_u32 m0, s69, 0
  s_nop 0
  buffer_load_dwordx4 v14, s[36:39], s60 offen offset:0 sc1 lds
  buffer_load_dwordx4 v14, s[36:39], s60 offen offset:1024 sc1 lds
  buffer_load_dwordx4 v14, s[36:39], s60 offen offset:2048 sc1 lds
  buffer_load_dwordx4 v14, s[36:39], s60 offen offset:3072 sc1 lds
  s_add_u32 s60, s75, 4096
  s_add_u32 m0, s69, 4096
  s_nop 0
  buffer_load_dwordx4 v14, s[36:39], s60 offen offset:0 sc1 lds
  buffer_load_dwordx4 v14, s[36:39], s60 offen offset:1024 sc1 lds
  buffer_load_dwordx4 v14, s[36:39], s60 offen offset:2048 sc1 lds
  buffer_load_dwordx4 v14, s[36:39], s60 offen offset:3072 sc1 lds
  s_lshr_b32 s61, s69, 1
  s_add_u32 m0, s61, 151552
  s_nop 0
  buffer_load_dwordx4 v13, s[36:39], s76 offen offset:0 sc1 lds
  buffer_load_dwordx4 v13, s[36:39], s76 offen offset:1024 sc1 lds
  buffer_load_dwordx4 v13, s[36:39], s76 offen offset:2048 sc1 lds
  buffer_load_dwordx4 v13, s[36:39], s76 offen offset:3072 sc1 lds
  s_barrier
  s_waitcnt vmcnt(0)
  s_barrier
  s_branch L_ATT
L_ATT_RET_A:
  s_cmp_eq_u32 s57, 1
  s_cbranch_scc1 L_IDLE_A
  s_mov_b32 s65, 0x10000
L_poll_14:
  buffer_load_dword v48, v17, s[36:39], 0 offen sc1
  s_waitcnt vmcnt(0)
  v_cmp_ne_u32 vcc, s56, v48
  s_nop 1
  s_cbranch_vccz L_polld_15
  s_sub_u32 s65, s65, 1
  s_cmp_eq_u32 s65, 0
  s_cbranch_scc1 L_polld_15
  s_sleep 1
  s_branch L_poll_14
L_polld_15:
  s_add_u32 s60, s74, 0
  s_add_u32 m0, s69, 17408
  s_nop 0
  buffer_load_dwordx4 v13, s[36:39], s60 offen offset:0 sc1 lds
  buffer_load_dwordx4 v13, s[36:39], s60 offen offset:1024 sc1 lds
  buffer_load_dwordx4 v13, s[36:39], s60 offen offset:2048 sc1 lds
  buffer_load_dwordx4 v13, s[36:39], s60 offen offset:3072 sc1 lds
  s_add_u32 s60, s74, 32768
  s_add_u32 m0, s69, 21504
  s_nop 0
  buffer_load_dwordx4 v13, s[36:39], s60 offen offset:0 sc1 lds
  buffer_load_dwordx4 v13, s[36:39], s60 offen offset:1024 sc1 lds
  buffer_load_dwordx4 v13, s[36:39], s60 offen offset:2048 sc1 lds
  buffer_load_dwordx4 v13, s[36:39], s60 offen offset:3072 sc1 lds
  s_add_u32 s60, s74, 4096
  s_add_u32 m0, s69, 34816
  s_nop 0
  buffer_load_dwordx4 v13, s[36:39], s60 offen offset:0 sc1 lds
  buffer_load_dwordx4 v13, s[36:39], s60 offen offset:1024 sc1 lds
  buffer_load_dwordx4 v13, s[36:39], s60 offen offset:2048 sc1 lds
  buffer_load_dwordx4 v13, s[36:39], s60 offen offset:3072 sc1 lds
  s_add_u32 s60, s74, 36864
  s_add_u32 m0, s69, 38912
  s_nop 0
  buffer_load_dwordx4 v13, s[36:39], s60 offen offset:0 sc1 lds
  buffer_load_dwordx4 v13, s[36:39], s60 offen offset:1024 sc1 lds
  buffer_load_dwordx4 v13, s[36:39], s60 offen offset:2048 sc1 lds
  buffer_load_dwordx4 v13, s[36:39], s60 offen offset:3072 sc1 lds
  s_add_u32 s60, s74, 8192
  s_add_u32 m0, s69, 52224
  s_nop 0
  buffer_load_dwordx4 v13, s[36:39], s60 offen offset:0 sc1 lds
  buffer_load_dwordx4 v13, s[36:39], s60 offen offset:1024 sc1 lds
  buffer_load_dwordx4 v13, s[36:39], s60 offen offset:2048 sc1 lds
  buffer_load_dwordx4 v13, s[36:39], s60 offen offset:3072 sc1 lds
  s_add_u32 s60, s74, 40960
  s_add_u32 m0, s69, 56320
  s_nop 0
  buffer_load_dwordx4 v13, s[36:39], s60 offen offset:0 sc1 lds
  buffer_load_dwordx4 v13, s[36:39], s60 offen offset:1024 sc1 lds
  buffer_load_dwordx4 v13, s[36:39], s60 offen offset:2048 sc1 lds
  buffer_load_dwordx4 v13, s[36:39], s60 offen offset:3072 sc1 lds
  s_waitcnt vmcnt(16)
  s_lshl_b32 s64, s52, 3
  s_add_u32 s64, s64, s44
  s_lshl_b32 s64, s64, 5
  s_add_u32 s64, s64, s51
  s_lshl_b32 s64, s64, 2
  s_add_u32 s64, s64, 20996096
  s_mov_b64 exec, 1
  buffer_store_dword v27, off, s[36:39], s64 sc1
  s_mov_b64 exec, -1
  s_barrier
  s_add_u32 s60, s74, 12288
  s_add_u32 m0, s69, 0
  s_nop 0
  buffer_load_dwordx4 v13, s[36:39], s60 offen offset:0 sc1 lds
  buffer_load_dwordx4 v13, s[36:39], s60 offen offset:1024 sc1 lds
  buffer_load_dwordx4 v13, s[36:39], s60 offen offset:2048 sc1 lds
  buffer_load_dwordx4 v13, s[36:39], s60 offen offset:3072 sc1 lds
  s_add_u32 s60, s74, 45056
  s_add_u32 m0, s69, 4096
  s_nop 0
  buffer_load_dwordx4 v13, s[36:39], s60 offen offset:0 sc1 lds
  buffer_load_dwordx4 v13, s[36:39], s60 offen offset:1024 sc1 lds
  buffer_load_dwordx4 v13, s[36:39], s60 offen offset:2048 sc1 lds
  buffer_load_dwordx4 v13, s[36:39], s60 offen offset:3072 sc1 lds
  v_mov_b32 v23, 0
  v_mov_b32 v24, 0
  v_mov_b32 v25, 0
  v_add_u32 v108, 17408, v22
  ds_read_b128 v[48:51], v108 offset:0
  ds_read_b128 v[52:55], v108 offset:1024
  ds_read_b128 v[56:59], v108 offset:2048
  ds_read_b128 v[60:63], v108 offset:3072
  s_waitcnt lgkmcnt(3)
  v_dot2c_f32_bf16 v23, v48, v26
  v_dot2c_f32_bf16 v24, v48, v48
  v_dot2c_f32_bf16 v23, v49, v26
  v_dot2c_f32_bf16 v24, v49, v49
  v_dot2c_f32_bf16 v23, v50, v26
  v_dot2c_f32_bf16 v24, v50, v50
  v_dot2c_f32_bf16 v23, v51, v26
  v_dot2c_f32_bf16 v24, v51, v51
  s_waitcnt lgkmcnt(2)
  v_dot2c_f32_bf16 v23, v52, v26
  v_dot2c_f32_bf16 v24, v52, v52
  v_dot2c_f32_bf16 v23, v53, v26
  v_dot2c_f32_bf16 v24, v53, v53
  v_dot2c_f32_bf16 v23, v54, v26
  v_dot2c_f32_bf16 v24, v54, v54
  v_dot2c_f32_bf16 v23, v55, v26
  v_dot2c_f32_bf16 v24, v55, v55
  s_waitcnt lgkmcnt(1)
  v_dot2c_f32_bf16 v23, v56, v26
  v_dot2c_f32_bf16 v24, v56, v56
  v_dot2c_f32_bf16 v23, v57, v26
  v_dot2c_f32_bf16 v24, v57, v57
  v_dot2c_f32_bf16 v23, v58, v26
  v_dot2c_f32_bf16 v24, v58, v58
  v_dot2c_f32_bf16 v23, v59, v26
  v_dot2c_f32_bf16 v24, v59, v59
  s_waitcnt lgkmcnt(0)
  v_dot2c_f32_bf16 v23, v60, v26
  v_dot2c_f32_bf16 v24, v60, v60
  v_dot2c_f32_bf16 v23, v61, v26
  v_dot2c_f32_bf16 v24, v61, v61
  v_dot2c_f32_bf16 v23, v62, v26
  v_dot2c_f32_bf16 v24, v62, v62
  v_dot2c_f32_bf16 v23, v63, v26
  v_dot2c_f32_bf16 v24, v63, v63
  v_add_u32 v109, 102400, v30
  ds_read_b64_tr_b16 v[88:89], v109 offset:0
  ds_read_b64_tr_b16 v[90:91], v109 offset:1024
  ds_read_b64_tr_b16 v[92:93], v109 offset:4096
  ds_read_b64_tr_b16 v[94:95], v109 offset:5120
  ds_read_b64_tr_b16 v[96:97], v109 offset:8192
  ds_read_b64_tr_b16 v[98:99], v109 offset:9216
  ds_read_b64_tr_b16 v[100:101], v109 offset:12288
  ds_read_b64_tr_b16 v[102:103], v109 offset:13312
  s_waitcnt lgkmcnt(7)
  v_dot2c_f32_bf16 v25, v88, v26
  v_dot2c_f32_bf16 v25, v89, v26
  s_waitcnt lgkmcnt(6)
  v_dot2c_f32_bf16 v25, v90, v26
  v_dot2c_f32_bf16 v25, v91, v26
  s_waitcnt lgkmcnt(5)
  v_dot2c_f32_bf16 v25, v92, v26
  v_dot2c_f32_bf16 v25, v93, v26
  s_waitcnt lgkmcnt(4)
  v_dot2c_f32_bf16 v25, v94, v26
  v_dot2c_f32_bf16 v25, v95, v26
  s_waitcnt lgkmcnt(3)
  v_dot2c_f32_bf16 v25, v96, v26
  v_dot2c_f32_bf16 v25, v97, v26
  s_waitcnt lgkmcnt(2)
  v_dot2c_f32_bf16 v25, v98, v26
  v_dot2c_f32_bf16 v25, v99, v26
  s_waitcnt lgkmcnt(1)
  v_dot2c_f32_bf16 v25, v100, v26
  v_dot2c_f32_bf16 v25, v101, v26
  s_waitcnt lgkmcnt(0)
  v_dot2c_f32_bf16 v25, v102, v26
  v_dot2c_f32_bf16 v25, v103, v26
  s_waitcnt vmcnt(16)
  s_barrier
  s_add_u32 s60, s74, 16384
  s_add_u32 m0, s69, 17408
  s_nop 0
  buffer_load_dwordx4 v13, s[36:39], s60 offen offset:0 sc1 lds
  buffer_load_dwordx4 v13, s[36:39], s60 offen offset:1024 sc1 lds
  buffer_load_dwordx4 v13, s[36:39], s60 offen offset:2048 sc1 lds
  buffer_load_dwordx4 v13, s[36:39], s60 offen offset:3072 sc1 lds
  s_add_u32 s60, s74, 49152
  s_add_u32 m0, s69, 21504
  s_nop 0
  buffer_load_dwordx4 v13, s[36:39], s60 offen offset:0 sc1 lds
  buffer_load_dwordx4 v13, s[36:39], s60 offen offset:1024 sc1 lds
  buffer_load_dwordx4 v13, s[36:39], s60 offen offset:2048 sc1 lds
  buffer_load_dwordx4 v13, s[36:39], s60 offen offset:3072 sc1 lds
  v_add_u32 v108, 34816, v22
  ds_read_b128 v[48:51], v108 offset:0
  ds_read_b128 v[52:55], v108 offset:1024
  ds_read_b128 v[56:59], v108 offset:2048
  ds_read_b128 v[60:63], v108 offset:3072
  s_waitcnt lgkmcnt(3)
  v_dot2c_f32_bf16 v23, v48, v26
  v_dot2c_f32_bf16 v24, v48, v48
  v_dot2c_f32_bf16 v23, v49, v26
  v_dot2c_f32_bf16 v24, v49, v49
  v_dot2c_f32_bf16 v23, v50, v26
  v_dot2c_f32_bf16 v24, v50, v50
  v_dot2c_f32_bf16 v23, v51, v26
  v_dot2c_f32_bf16 v24, v51, v51
  s_waitcnt lgkmcnt(2)
  v_dot2c_f32_bf16 v23, v52, v26
  v_dot2c_f32_bf16 v24, v52, v52
  v_dot2c_f32_bf16 v23, v53, v26
  v_dot2c_f32_bf16 v24, v53, v53
  v_dot2c_f32_bf16 v23, v54, v26
  v_dot2c_f32_bf16 v24, v54, v54
  v_dot2c_f32_bf16 v23, v55, v26
  v_dot2c_f32_bf16 v24, v55, v55
  s_waitcnt lgkmcnt(1)
  v_dot2c_f32_bf16 v23, v56, v26
  v_dot2c_f32_bf16 v24, v56, v56
  v_dot2c_f32_bf16 v23, v57, v26
  v_dot2c_f32_bf16 v24, v57, v57
  v_dot2c_f32_bf16 v23, v58, v26
  v_dot2c_f32_bf16 v24, v58, v58
  v_dot2c_f32_bf16 v23, v59, v26
  v_dot2c_f32_bf16 v24, v59, v59
  s_waitcnt lgkmcnt(0)
  v_dot2c_f32_bf16 v23, v60, v26
  v_dot2c_f32_bf16 v24, v60, v60
  v_dot2c_f32_bf16 v23, v61, v26
  v_dot2c_f32_bf16 v24, v61, v61
  v_dot2c_f32_bf16 v23, v62, v26
  v_dot2c_f32_bf16 v24, v62, v62
  v_dot2c_f32_bf16 v23, v63, v26
  v_dot2c_f32_bf16 v24, v63, v63
  v_add_u32 v109, 118784, v30
  ds_read_b64_tr_b16 v[88:89], v109 offset:0
  ds_read_b64_tr_b16 v[90:91], v109 offset:1024
  ds_read_b64_tr_b16 v[92:93], v109 offset:4096
  ds_read_b64_tr_b16 v[94:95], v109 offset:5120
  ds_read_b64_tr_b16 v[96:97], v109 offset:8192
  ds_read_b64_tr_b16 v[98:99], v109 offset:9216
  ds_read_b64_tr_b16 v[100:101], v109 offset:12288
  ds_read_b64_tr_b16 v[102:103], v109 offset:13312
  s_waitcnt lgkmcnt(7)
  v_dot2c_f32_bf16 v25, v88, v26
  v_dot2c_f32_bf16 v25, v89, v26
  s_waitcnt lgkmcnt(6)
  v_dot2c_f32_bf16 v25, v90, v26
  v_dot2c_f32_bf16 v25, v91, v26
  s_waitcnt lgkmcnt(5)
  v_dot2c_f32_bf16 v25, v92, v26
  v_dot2c_f32_bf16 v25, v93, v26
  s_waitcnt lgkmcnt(4)
  v_dot2c_f32_bf16 v25, v94, v26
  v_dot2c_f32_bf16 v25, v95, v26
  s_waitcnt lgkmcnt(3)
  v_dot2c_f32_bf16 v25, v96, v26
  v_dot2c_f32_bf16 v25, v97, v26
  s_waitcnt lgkmcnt(2)
  v_dot2c_f32_bf16 v25, v98, v26
  v_dot2c_f32_bf16 v25, v99, v26
  s_waitcnt lgkmcnt(1)
  v_dot2c_f32_bf16 v25, v100, v26
  v_dot2c_f32_bf16 v25, v101, v26
  s_waitcnt lgkmcnt(0)
  v_dot2c_f32_bf16 v25, v102, v26
  v_dot2c_f32_bf16 v25, v103, v26
  s_waitcnt vmcnt(16)
  s_barrier
  s_add_u32 s60, s74, 20480
  s_add_u32 m0, s69, 34816
  s_nop 0
  buffer_load_dwordx4 v13, s[36:39], s60 offen offset:0 sc1 lds
  buffer_load_dwordx4 v13, s[36:39], s60 offen offset:1024 sc1 lds
  buffer_load_dwordx4 v13, s[36:39], s60 offen offset:2048 sc1 lds
  buffer_load_dwordx4 v13, s[36:39], s60 offen offset:3072 sc1 lds
  s_add_u32 s60, s74, 53248
  s_add_u32 m0, s69, 38912
  s_nop 0
  buffer_load_dwordx4 v13, s[36:39], s60 offen offset:0 sc1 lds
  buffer_load_dwordx4 v13, s[36:39], s60 offen offset:1024 sc1 lds
  buffer_load_dwordx4 v13, s[36:39], s60 offen offset:2048 sc1 lds
  buffer_load_dwordx4 v13, s[36:39], s60 offen offset:3072 sc1 lds
  v_add_u32 v108, 52224, v22
  ds_read_b128 v[48:51], v108 offset:0
  ds_read_b128 v[52:55], v108 offset:1024
  ds_read_b128 v[56:59], v108 offset:2048
  ds_read_b128 v[60:63], v108 offset:3072
  s_waitcnt lgkmcnt(3)
  v_dot2c_f32_bf16 v23, v48, v26
  v_dot2c_f32_bf16 v24, v48, v48
  v_dot2c_f32_bf16 v23, v49, v26
  v_dot2c_f32_bf16 v24, v49, v49
  v_dot2c_f32_bf16 v23, v50, v26
  v_dot2c_f32_bf16 v24, v50, v50
  v_dot2c_f32_bf16 v23, v51, v26
  v_dot2c_f32_bf16 v24, v51, v51
  s_waitcnt lgkmcnt(2)
  v_dot2c_f32_bf16 v23, v52, v26
  v_dot2c_f32_bf16 v24, v52, v52
  v_dot2c_f32_bf16 v23, v53, v26
  v_dot2c_f32_bf16 v24, v53, v53
  v_dot2c_f32_bf16 v23, v54, v26
  v_dot2c_f32_bf16 v24, v54, v54
  v_dot2c_f32_bf16 v23, v55, v26
  v_dot2c_f32_bf16 v24, v55, v55
  s_waitcnt lgkmcnt(1)
  v_dot2c_f32_bf16 v23, v56, v26
  v_dot2c_f32_bf16 v24, v56, v56
  v_dot2c_f32_bf16 v23, v57, v26
  v_dot2c_f32_bf16 v24, v57, v57
  v_dot2c_f32_bf16 v23, v58, v26
  v_dot2c_f32_bf16 v24, v58, v58
  v_dot2c_f32_bf16 v23, v59, v26
  v_dot2c_f32_bf16 v24, v59, v59
  s_waitcnt lgkmcnt(0)
  v_dot2c_f32_bf16 v23, v60, v26
  v_dot2c_f32_bf16 v24, v60, v60
  v_dot2c_f32_bf16 v23, v61, v26
  v_dot2c_f32_bf16 v24, v61, v61
  v_dot2c_f32_bf16 v23, v62, v26
  v_dot2c_f32_bf16 v24, v62, v62
  v_dot2c_f32_bf16 v23, v63, v26
  v_dot2c_f32_bf16 v24, v63, v63
  v_add_u32 v109, 135168, v30
  ds_read_b64_tr_b16 v[88:89], v109 offset:0
  ds_read_b64_tr_b16 v[90:91], v109 offset:1024
  ds_read_b64_tr_b16 v[92:93], v109 offset:4096
  ds_read_b64_tr_b16 v[94:95], v109 offset:5120
  ds_read_b64_tr_b16 v[96:97], v109 offset:8192
  ds_read_b64_tr_b16 v[98:99], v109 offset:9216
  ds_read_b64_tr_b16 v[100:101], v109 offset:12288
  ds_read_b64_tr_b16 v[102:103], v109 offset:13312
  s_waitcnt lgkmcnt(7)
  v_dot2c_f32_bf16 v25, v88, v26
  v_dot2c_f32_bf16 v25, v89, v26
  s_waitcnt lgkmcnt(6)
  v_dot2c_f32_bf16 v25, v90, v26
  v_dot2c_f32_bf16 v25, v91, v26
  s_waitcnt lgkmcnt(5)
  v_dot2c_f32_bf16 v25, v92, v26
  v_dot2c_f32_bf16 v25, v93, v26
  s_waitcnt lgkmcnt(4)
  v_dot2c_f32_bf16 v25, v94, v26
  v_dot2c_f32_bf16 v25, v95, v26
  s_waitcnt lgkmcnt(3)
  v_dot2c_f32_bf16 v25, v96, v26
  v_dot2c_f32_bf16 v25, v97, v26
  s_waitcnt lgkmcnt(2)
  v_dot2c_f32_bf16 v25, v98, v26
  v_dot2c_f32_bf16 v25, v99, v26
  s_waitcnt lgkmcnt(1)
  v_dot2c_f32_bf16 v25, v100, v26
  v_dot2c_f32_bf16 v25, v101, v26
  s_waitcnt lgkmcnt(0)
  v_dot2c_f32_bf16 v25, v102, v26
  v_dot2c_f32_bf16 v25, v103, v26
  s_waitcnt vmcnt(16)
  s_barrier
  s_add_u32 s60, s74, 24576
  s_add_u32 m0, s69, 52224
  s_nop 0
  buffer_load_dwordx4 v13, s[36:39], s60 offen offset:0 sc1 lds
  buffer_load_dwordx4 v13, s[36:39], s60 offen offset:1024 sc1 lds
  buffer_load_dwordx4 v13, s[36:39], s60 offen offset:2048 sc1 lds
  buffer_load_dwordx4 v13, s[36:39], s60 offen offset:3072 sc1 lds
  s_add_u32 s60, s74, 57344
  s_add_u32 m0, s69, 56320
  s_nop 0
  buffer_load_dwordx4 v13, s[36:39], s60 offen offset:0 sc1 lds
  buffer_load_dwordx4 v13, s[36:39], s60 offen offset:1024 sc1 lds
  buffer_load_dwordx4 v13, s[36:39], s60 offen offset:2048 sc1 lds
  buffer_load_dwordx4 v13, s[36:39], s60 offen offset:3072 sc1 lds
  v_add_u32 v108, 0, v22
  ds_read_b128 v[48:51], v108 offset:0
  ds_read_b128 v[52:55], v108 offset:1024
  ds_read_b128 v[56:59], v108 offset:2048
  ds_read_b128 v[60:63], v108 offset:3072
  s_waitcnt lgkmcnt(3)
  v_dot2c_f32_bf16 v23, v48, v26
  v_dot2c_f32_bf16 v24, v48, v48
  v_dot2c_f32_bf16 v23, v49, v26
  v_dot2c_f32_bf16 v24, v49, v49
  v_dot2c_f32_bf16 v23, v50, v26
  v_dot2c_f32_bf16 v24, v50, v50
  v_dot2c_f32_bf16 v23, v51, v26
  v_dot2c_f32_bf16 v24, v51, v51
  s_waitcnt lgkmcnt(2)
  v_dot2c_f32_bf16 v23, v52, v26
  v_dot2c_f32_bf16 v24, v52, v52
  v_dot2c_f32_bf16 v23, v53, v26
  v_dot2c_f32_bf16 v24, v53, v53
  v_dot2c_f32_bf16 v23, v54, v26
  v_dot2c_f32_bf16 v24, v54, v54
  v_dot2c_f32_bf16 v23, v55, v26
  v_dot2c_f32_bf16 v24, v55, v55
  s_waitcnt lgkmcnt(1)
  v_dot2c_f32_bf16 v23, v56, v26
  v_dot2c_f32_bf16 v24, v56, v56
  v_dot2c_f32_bf16 v23, v57, v26
  v_dot2c_f32_bf16 v24, v57, v57
  v_dot2c_f32_bf16 v23, v58, v26
  v_dot2c_f32_bf16 v24, v58, v58
  v_dot2c_f32_bf16 v23, v59, v26
  v_dot2c_f32_bf16 v24, v59, v59
  s_waitcnt lgkmcnt(0)
  v_dot2c_f32_bf16 v23, v60, v26
  v_dot2c_f32_bf16 v24, v60, v60
  v_dot2c_f32_bf16 v23, v61, v26
  v_dot2c_f32_bf16 v24, v61, v61
  v_dot2c_f32_bf16 v23, v62, v26
  v_dot2c_f32_bf16 v24, v62, v62
  v_dot2c_f32_bf16 v23, v63, v26
  v_dot2c_f32_bf16 v24, v63, v63
  v_add_u32 v109, 69632, v30
  ds_read_b64_tr_b16 v[88:89], v109 offset:0
  ds_read_b64_tr_b16 v[90:91], v109 offset:1024
  ds_read_b64_tr_b16 v[92:93], v109 offset:4096
  ds_read_b64_tr_b16 v[94:95], v109 offset:5120
  ds_read_b64_tr_b16 v[96:97], v109 offset:8192
  ds_read_b64_tr_b16 v[98:99], v109 offset:9216
  ds_read_b64_tr_b16 v[100:101], v109 offset:12288
  ds_read_b64_tr_b16 v[102:103], v109 offset:13312
  s_waitcnt lgkmcnt(7)
  v_dot2c_f32_bf16 v25, v88, v26
  v_dot2c_f32_bf16 v25, v89, v26
  s_waitcnt lgkmcnt(6)
  v_dot2c_f32_bf16 v25, v90, v26
  v_dot2c_f32_bf16 v25, v91, v26
  s_waitcnt lgkmcnt(5)
  v_dot2c_f32_bf16 v25, v92, v26
  v_dot2c_f32_bf16 v25, v93, v26
  s_waitcnt lgkmcnt(4)
  v_dot2c_f32_bf16 v25, v94, v26
  v_dot2c_f32_bf16 v25, v95, v26
  s_waitcnt lgkmcnt(3)
  v_dot2c_f32_bf16 v25, v96, v26
  v_dot2c_f32_bf16 v25, v97, v26
  s_waitcnt lgkmcnt(2)
  v_dot2c_f32_bf16 v25, v98, v26
  v_dot2c_f32_bf16 v25, v99, v26
  s_waitcnt lgkmcnt(1)
  v_dot2c_f32_bf16 v25, v100, v26
  v_dot2c_f32_bf16 v25, v101, v26
  s_waitcnt lgkmcnt(0)
  v_dot2c_f32_bf16 v25, v102, v26
  v_dot2c_f32_bf16 v25, v103, v26
  s_waitcnt vmcnt(16)
  s_barrier
  s_add_u32 s60, s74, 28672
  s_add_u32 m0, s69, 0
  s_nop 0
  buffer_load_dwordx4 v13, s[36:39], s60 offen offset:0 sc1 lds
  buffer_load_dwordx4 v13, s[36:39], s60 offen offset:1024 sc1 lds
  buffer_load_dwordx4 v13, s[36:39], s60 offen offset:2048 sc1 lds
  buffer_load_dwordx4 v13, s[36:39], s60 offen offset:3072 sc1 lds
  s_add_u32 s60, s74, 61440
  s_add_u32 m0, s69, 4096
  s_nop 0
  buffer_load_dwordx4 v13, s[36:39], s60 offen offset:0 sc1 lds
  buffer_load_dwordx4 v13, s[36:39], s60 offen offset:1024 sc1 lds
  buffer_load_dwordx4 v13, s[36:39], s60 offen offset:2048 sc1 lds
  buffer_load_dwordx4 v13, s[36:39], s60 offen offset:3072 sc1 lds
  v_add_u32 v108, 17408, v22
  ds_read_b128 v[48:51], v108 offset:0
  ds_read_b128 v[52:55], v108 offset:1024
  ds_read_b128 v[56:59], v108 offset:2048
  ds_read_b128 v[60:63], v108 offset:3072
  s_waitcnt lgkmcnt(3)
  v_dot2c_f32_bf16 v23, v48, v26
  v_dot2c_f32_bf16 v24, v48, v48
  v_dot2c_f32_bf16 v23, v49, v26
  v_dot2c_f32_bf16 v24, v49, v49
  v_dot2c_f32_bf16 v23, v50, v26
  v_dot2c_f32_bf16 v24, v50, v50
  v_dot2c_f32_bf16 v23, v51, v26
  v_dot2c_f32_bf16 v24, v51, v51
  s_waitcnt lgkmcnt(2)
  v_dot2c_f32_bf16 v23, v52, v26
  v_dot2c_f32_bf16 v24, v52, v52
  v_dot2c_f32_bf16 v23, v53, v26
  v_dot2c_f32_bf16 v24, v53, v53
  v_dot2c_f32_bf16 v23, v54, v26
  v_dot2c_f32_bf16 v24, v54, v54
  v_dot2c_f32_bf16 v23, v55, v26
  v_dot2c_f32_bf16 v24, v55, v55
  s_waitcnt lgkmcnt(1)
  v_dot2c_f32_bf16 v23, v56, v26
  v_dot2c_f32_bf16 v24, v56, v56
  v_dot2c_f32_bf16 v23, v57, v26
  v_dot2c_f32_bf16 v24, v57, v57
  v_dot2c_f32_bf16 v23, v58, v26
  v_dot2c_f32_bf16 v24, v58, v58
  v_dot2c_f32_bf16 v23, v59, v26
  v_dot2c_f32_bf16 v24, v59, v59
  s_waitcnt lgkmcnt(0)
  v_dot2c_f32_bf16 v23, v60, v26
  v_dot2c_f32_bf16 v24, v60, v60
  v_dot2c_f32_bf16 v23, v61, v26
  v_dot2c_f32_bf16 v24, v61, v61
  v_dot2c_f32_bf16 v23, v62, v26
  v_dot2c_f32_bf16 v24, v62, v62
  v_dot2c_f32_bf16 v23, v63, v26
  v_dot2c_f32_bf16 v24, v63, v63
  v_add_u32 v109, 86016, v30
  ds_read_b64_tr_b16 v[88:89], v109 offset:0
  ds_read_b64_tr_b16 v[90:91], v109 offset:1024
  ds_read_b64_tr_b16 v[92:93], v109 offset:4096
  ds_read_b64_tr_b16 v[94:95], v109 offset:5120
  ds_read_b64_tr_b16 v[96:97], v109 offset:8192
  ds_read_b64_tr_b16 v[98:99], v109 offset:9216
  ds_read_b64_tr_b16 v[100:101], v109 offset:12288
  ds_read_b64_tr_b16 v[102:103], v109 offset:13312
  s_waitcnt lgkmcnt(7)
  v_dot2c_f32_bf16 v25, v88, v26
  v_dot2c_f32_bf16 v25, v89, v26
  s_waitcnt lgkmcnt(6)
  v_dot2c_f32_bf16 v25, v90, v26
  v_dot2c_f32_bf16 v25, v91, v26
  s_waitcnt lgkmcnt(5)
  v_dot2c_f32_bf16 v25, v92, v26
  v_dot2c_f32_bf16 v25, v93, v26
  s_waitcnt lgkmcnt(4)
  v_dot2c_f32_bf16 v25, v94, v26
  v_dot2c_f32_bf16 v25, v95, v26
  s_waitcnt lgkmcnt(3)
  v_dot2c_f32_bf16 v25, v96, v26
  v_dot2c_f32_bf16 v25, v97, v26
  s_waitcnt lgkmcnt(2)
  v_dot2c_f32_bf16 v25, v98, v26
  v_dot2c_f32_bf16 v25, v99, v26
  s_waitcnt lgkmcnt(1)
  v_dot2c_f32_bf16 v25, v100, v26
  v_dot2c_f32_bf16 v25, v101, v26
  s_waitcnt lgkmcnt(0)
  v_dot2c_f32_bf16 v25, v102, v26
  v_dot2c_f32_bf16 v25, v103, v26
  s_waitcnt vmcnt(16)
  s_barrier
  s_mov_b32 s65, 0x10000
L_poll_16:
  buffer_load_dword v48, v18, s[36:39], 0 offen sc1
  s_waitcnt vmcnt(0)
  v_cmp_ne_u32 vcc, s56, v48
  s_nop 1
  s_cbranch_vccz L_polld_17
  s_sub_u32 s65, s65, 1
  s_cmp_eq_u32 s65, 0
  s_cbranch_scc1 L_polld_17
  s_sleep 1
  s_branch L_poll_16
L_polld_17:
  s_add_u32 s60, s72, 0
  s_add_u32 m0, s69, 17408
  s_nop 0
  buffer_load_dwordx4 v13, s[36:39], s60 offen offset:0 sc1 lds
  buffer_load_dwordx4 v13, s[36:39], s60 offen offset:1024 sc1 lds
  buffer_load_dwordx4 v13, s[36:39], s60 offen offset:2048 sc1 lds
  buffer_load_dwordx4 v13, s[36:39], s60 offen offset:3072 sc1 lds
  s_add_u32 s60, s72, 4096
  s_add_u32 m0, s69, 21504
  s_nop 0
  buffer_load_dwordx4 v13, s[36:39], s60 offen offset:0 sc1 lds
  buffer_load_dwordx4 v13, s[36:39], s60 offen offset:1024 sc1 lds
  buffer_load_dwordx4 v13, s[36:39], s60 offen offset:2048 sc1 lds
  buffer_load_dwordx4 v13, s[36:39], s60 offen offset:3072 sc1 lds
  v_add_u32 v108, 34816, v22
  ds_read_b128 v[48:51], v108 offset:0
  ds_read_b128 v[52:55], v108 offset:1024
  ds_read_b128 v[56:59], v108 offset:2048
  ds_read_b128 v[60:63], v108 offset:3072
  s_waitcnt lgkmcnt(3)
  v_dot2c_f32_bf16 v23, v48, v26
  v_dot2c_f32_bf16 v24, v48, v48
  v_dot2c_f32_bf16 v23, v49, v26
  v_dot2c_f32_bf16 v24, v49, v49
  v_dot2c_f32_bf16 v23, v50, v26
  v_dot2c_f32_bf16 v24, v50, v50
  v_dot2c_f32_bf16 v23, v51, v26
  v_dot2c_f32_bf16 v24, v51, v51
  s_waitcnt lgkmcnt(2)
  v_dot2c_f32_bf16 v23, v52, v26
  v_dot2c_f32_bf16 v24, v52, v52
  v_dot2c_f32_bf16 v23, v53, v26
  v_dot2c_f32_bf16 v24, v53, v53
  v_dot2c_f32_bf16 v23, v54, v26
  v_dot2c_f32_bf16 v24, v54, v54
  v_dot2c_f32_bf16 v23, v55, v26
  v_dot2c_f32_bf16 v24, v55, v55
  s_waitcnt lgkmcnt(1)
  v_dot2c_f32_bf16 v23, v56, v26
  v_dot2c_f32_bf16 v24, v56, v56
  v_dot2c_f32_bf16 v23, v57, v26
  v_dot2c_f32_bf16 v24, v57, v57
  v_dot2c_f32_bf16 v23, v58, v26
  v_dot2c_f32_bf16 v24, v58, v58
  v_dot2c_f32_bf16 v23, v59, v26
  v_dot2c_f32_bf16 v24, v59, v59
  s_waitcnt lgkmcnt(0)
  v_dot2c_f32_bf16 v23, v60, v26
  v_dot2c_f32_bf16 v24, v60, v60
  v_dot2c_f32_bf16 v23, v61, v26
  v_dot2c_f32_bf16 v24, v61, v61
  v_dot2c_f32_bf16 v23, v62, v26
  v_dot2c_f32_bf16 v24, v62, v62
  v_dot2c_f32_bf16 v23, v63, v26
  v_dot2c_f32_bf16 v24, v63, v63
  v_add_u32 v109, 102400, v30
  ds_read_b64_tr_b16 v[88:89], v109 offset:0
  ds_read_b64_tr_b16 v[90:91], v109 offset:1024
  ds_read_b64_tr_b16 v[92:93], v109 offset:4096
  ds_read_b64_tr_b16 v[94:95], v109 offset:5120
  ds_read_b64_tr_b16 v[96:97], v109 offset:8192
  ds_read_b64_tr_b16 v[98:99], v109 offset:9216
  ds_read_b64_tr_b16 v[100:101], v109 offset:12288
  ds_read_b64_tr_b16 v[102:103], v109 offset:13312
  s_waitcnt lgkmcnt(7)
  v_dot2c_f32_bf16 v25, v88, v26
  v_dot2c_f32_bf16 v25, v89, v26
  s_waitcnt lgkmcnt(6)
  v_dot2c_f32_bf16 v25, v90, v26
  v_dot2c_f32_bf16 v25, v91, v26
  s_waitcnt lgkmcnt(5)
  v_dot2c_f32_bf16 v25, v92, v26
  v_dot2c_f32_bf16 v25, v93, v26
  s_waitcnt lgkmcnt(4)
  v_dot2c_f32_bf16 v25, v94, v26
  v_dot2c_f32_bf16 v25, v95, v26
  s_waitcnt lgkmcnt(3)
  v_dot2c_f32_bf16 v25, v96, v26
  v_dot2c_f32_bf16 v25, v97, v26
  s_waitcnt lgkmcnt(2)
  v_dot2c_f32_bf16 v25, v98, v26
  v_dot2c_f32_bf16 v25, v99, v26
  s_waitcnt lgkmcnt(1)
  v_dot2c_f32_bf16 v25, v100, v26
  v_dot2c_f32_bf16 v25, v101, v26
  s_waitcnt lgkmcnt(0)
  v_dot2c_f32_bf16 v25, v102, v26
  v_dot2c_f32_bf16 v25, v103, v26
  s_barrier
  s_add_u32 s60, s72, 8192
  s_add_u32 m0, s69, 34816
  s_nop 0
  buffer_load_dwordx4 v13, s[36:39], s60 offen offset:0 sc1 lds
  buffer_load_dwordx4 v13, s[36:39], s60 offen offset:1024 sc1 lds
  buffer_load_dwordx4 v13, s[36:39], s60 offen offset:2048 sc1 lds
  buffer_load_dwordx4 v13, s[36:39], s60 offen offset:3072 sc1 lds
  s_add_u32 s60, s72, 12288
  s_add_u32 m0, s69, 38912
  s_nop 0
  buffer_load_dwordx4 v13, s[36:39], s60 offen offset:0 sc1 lds
  buffer_load_dwordx4 v13, s[36:39], s60 offen offset:1024 sc1 lds
  buffer_load_dwordx4 v13, s[36:39], s60 offen offset:2048 sc1 lds
  buffer_load_dwordx4 v13, s[36:39], s60 offen offset:3072 sc1 lds
  v_add_u32 v108, 52224, v22
  ds_read_b128 v[48:51], v108 offset:0
  ds_read_b128 v[52:55], v108 offset:1024
  ds_read_b128 v[56:59], v108 offset:2048
  ds_read_b128 v[60:63], v108 offset:3072
  s_waitcnt lgkmcnt(3)
  v_dot2c_f32_bf16 v23, v48, v26
  v_dot2c_f32_bf16 v24, v48, v48
  v_dot2c_f32_bf16 v23, v49, v26
  v_dot2c_f32_bf16 v24, v49, v49
  v_dot2c_f32_bf16 v23, v50, v26
  v_dot2c_f32_bf16 v24, v50, v50
  v_dot2c_f32_bf16 v23, v51, v26
  v_dot2c_f32_bf16 v24, v51, v51
  s_waitcnt lgkmcnt(2)
  v_dot2c_f32_bf16 v23, v52, v26
  v_dot2c_f32_bf16 v24, v52, v52
  v_dot2c_f32_bf16 v23, v53, v26
  v_dot2c_f32_bf16 v24, v53, v53
  v_dot2c_f32_bf16 v23, v54, v26
  v_dot2c_f32_bf16 v24, v54, v54
  v_dot2c_f32_bf16 v23, v55, v26
  v_dot2c_f32_bf16 v24, v55, v55
  s_waitcnt lgkmcnt(1)
  v_dot2c_f32_bf16 v23, v56, v26
  v_dot2c_f32_bf16 v24, v56, v56
  v_dot2c_f32_bf16 v23, v57, v26
  v_dot2c_f32_bf16 v24, v57, v57
  v_dot2c_f32_bf16 v23, v58, v26
  v_dot2c_f32_bf16 v24, v58, v58
  v_dot2c_f32_bf16 v23, v59, v26
  v_dot2c_f32_bf16 v24, v59, v59
  s_waitcnt lgkmcnt(0)
  v_dot2c_f32_bf16 v23, v60, v26
  v_dot2c_f32_bf16 v24, v60, v60
  v_dot2c_f32_bf16 v23, v61, v26
  v_dot2c_f32_bf16 v24, v61, v61
  v_dot2c_f32_bf16 v23, v62, v26
  v_dot2c_f32_bf16 v24, v62, v62
  v_dot2c_f32_bf16 v23, v63, v26
  v_dot2c_f32_bf16 v24, v63, v63
  v_add_u32 v109, 118784, v30
  ds_read_b64_tr_b16 v[88:89], v109 offset:0
  ds_read_b64_tr_b16 v[90:91], v109 offset:1024
  ds_read_b64_tr_b16 v[92:93], v109 offset:4096
  ds_read_b64_tr_b16 v[94:95], v109 offset:5120
  ds_read_b64_tr_b16 v[96:97], v109 offset:8192
  ds_read_b64_tr_b16 v[98:99], v109 offset:9216
  ds_read_b64_tr_b16 v[100:101], v109 offset:12288
  ds_read_b64_tr_b16 v[102:103], v109 offset:13312
  s_waitcnt lgkmcnt(7)
  v_dot2c_f32_bf16 v25, v88, v26
  v_dot2c_f32_bf16 v25, v89, v26
  s_waitcnt lgkmcnt(6)
  v_dot2c_f32_bf16 v25, v90, v26
  v_dot2c_f32_bf16 v25, v91, v26
  s_waitcnt lgkmcnt(5)
  v_dot2c_f32_bf16 v25, v92, v26
  v_dot2c_f32_bf16 v25, v93, v26
  s_waitcnt lgkmcnt(4)
  v_dot2c_f32_bf16 v25, v94, v26
  v_dot2c_f32_bf16 v25, v95, v26
  s_waitcnt lgkmcnt(3)
  v_dot2c_f32_bf16 v25, v96, v26
  v_dot2c_f32_bf16 v25, v97, v26
  s_waitcnt lgkmcnt(2)
  v_dot2c_f32_bf16 v25, v98, v26
  v_dot2c_f32_bf16 v25, v99, v26
  s_waitcnt lgkmcnt(1)
  v_dot2c_f32_bf16 v25, v100, v26
  v_dot2c_f32_bf16 v25, v101, v26
  s_waitcnt lgkmcnt(0)
  v_dot2c_f32_bf16 v25, v102, v26
  v_dot2c_f32_bf16 v25, v103, v26
  s_barrier
  s_add_u32 s60, s72, 16384
  s_add_u32 m0, s69, 52224
  s_nop 0
  buffer_load_dwordx4 v13, s[36:39], s60 offen offset:0 sc1 lds
  buffer_load_dwordx4 v13, s[36:39], s60 offen offset:1024 sc1 lds
  buffer_load_dwordx4 v13, s[36:39], s60 offen offset:2048 sc1 lds
  buffer_load_dwordx4 v13, s[36:39], s60 offen offset:3072 sc1 lds
  s_add_u32 s60, s72, 20480
  s_add_u32 m0, s69, 56320
  s_nop 0
  buffer_load_dwordx4 v13, s[36:39], s60 offen offset:0 sc1 lds
  buffer_load_dwordx4 v13, s[36:39], s60 offen offset:1024 sc1 lds
  buffer_load_dwordx4 v13, s[36:39], s60 offen offset:2048 sc1 lds
  buffer_load_dwordx4 v13, s[36:39], s60 offen offset:3072 sc1 lds
  v_add_u32 v108, 0, v22
  ds_read_b128 v[48:51], v108 offset:0
  ds_read_b128 v[52:55], v108 offset:1024
  ds_read_b128 v[56:59], v108 offset:2048
  ds_read_b128 v[60:63], v108 offset:3072
  s_waitcnt lgkmcnt(3)
  v_dot2c_f32_bf16 v23, v48, v26
  v_dot2c_f32_bf16 v24, v48, v48
  v_dot2c_f32_bf16 v23, v49, v26
  v_dot2c_f32_bf16 v24, v49, v49
  v_dot2c_f32_bf16 v23, v50, v26
  v_dot2c_f32_bf16 v24, v50, v50
  v_dot2c_f32_bf16 v23, v51, v26
  v_dot2c_f32_bf16 v24, v51, v51
  s_waitcnt lgkmcnt(2)
  v_dot2c_f32_bf16 v23, v52, v26
  v_dot2c_f32_bf16 v24, v52, v52
  v_dot2c_f32_bf16 v23, v53, v26
  v_dot2c_f32_bf16 v24, v53, v53
  v_dot2c_f32_bf16 v23, v54, v26
  v_dot2c_f32_bf16 v24, v54, v54
  v_dot2c_f32_bf16 v23, v55, v26
  v_dot2c_f32_bf16 v24, v55, v55
  s_waitcnt lgkmcnt(1)
  v_dot2c_f32_bf16 v23, v56, v26
  v_dot2c_f32_bf16 v24, v56, v56
  v_dot2c_f32_bf16 v23, v57, v26
  v_dot2c_f32_bf16 v24, v57, v57
  v_dot2c_f32_bf16 v23, v58, v26
  v_dot2c_f32_bf16 v24, v58, v58
  v_dot2c_f32_bf16 v23, v59, v26
  v_dot2c_f32_bf16 v24, v59, v59
  s_waitcnt lgkmcnt(0)
  v_dot2c_f32_bf16 v23, v60, v26
  v_dot2c_f32_bf16 v24, v60, v60
  v_dot2c_f32_bf16 v23, v61, v26
  v_dot2c_f32_bf16 v24, v61, v61
  v_dot2c_f32_bf16 v23, v62, v26
  v_dot2c_f32_bf16 v24, v62, v62
  v_dot2c_f32_bf16 v23, v63, v26
  v_dot2c_f32_bf16 v24, v63, v63
  v_add_u32 v109, 135168, v30
  ds_read_b64_tr_b16 v[88:89], v109 offset:0
  ds_read_b64_tr_b16 v[90:91], v109 offset:1024
  ds_read_b64_tr_b16 v[92:93], v109 offset:4096
  ds_read_b64_tr_b16 v[94:95], v109 offset:5120
  ds_read_b64_tr_b16 v[96:97], v109 offset:8192
  ds_read_b64_tr_b16 v[98:99], v109 offset:9216
  ds_read_b64_tr_b16 v[100:101], v109 offset:12288
  ds_read_b64_tr_b16 v[102:103], v109 offset:13312
  s_waitcnt lgkmcnt(7)
  v_dot2c_f32_bf16 v25, v88, v26
  v_dot2c_f32_bf16 v25, v89, v26
  s_waitcnt lgkmcnt(6)
  v_dot2c_f32_bf16 v25, v90, v26
  v_dot2c_f32_bf16 v25, v91, v26
  s_waitcnt lgkmcnt(5)
  v_dot2c_f32_bf16 v25, v92, v26
  v_dot2c_f32_bf16 v25, v93, v26
  s_waitcnt lgkmcnt(4)
  v_dot2c_f32_bf16 v25, v94, v26
  v_dot2c_f32_bf16 v25, v95, v26
  s_waitcnt lgkmcnt(3)
  v_dot2c_f32_bf16 v25, v96, v26
  v_dot2c_f32_bf16 v25, v97, v26
  s_waitcnt lgkmcnt(2)
  v_dot2c_f32_bf16 v25, v98, v26
  v_dot2c_f32_bf16 v25, v99, v26
  s_waitcnt lgkmcnt(1)
  v_dot2c_f32_bf16 v25, v100, v26
  v_dot2c_f32_bf16 v25, v101, v26
  s_waitcnt lgkmcnt(0)
  v_dot2c_f32_bf16 v25, v102, v26
  v_dot2c_f32_bf16 v25, v103, v26
  v_mov_b32 v48, v23
  s_nop 1
  v_permlane32_swap_b32 v23, v48
  v_add_f32 v23, v23, v48
  v_mov_b32 v49, v24
  s_nop 1
  v_permlane32_swap_b32 v24, v49
  v_add_f32 v24, v24, v49
  v_mul_f32 v23, 0x3b000000, v23
  v_mul_f32 v24, 0x3b000000, v24
  v_fma_f32 v48, -v23, v23, v24
  v_max_f32 v48, 0, v48
  v_add_f32 v49, 0x3727c5ac, v48
  v_rsq_f32 v50, v49
  s_nop 0
  v_mul_f32 v51, v23, v50
  ds_write_b32 v32, v50 offset:0
  ds_write_b32 v32, v51 offset:512
  v_mov_b32 v56, v25
  s_nop 1
  v_permlane32_swap_b32 v25, v56
  v_add_f32 v25, v25, v56
  ds_write_b32 v34, v25
  s_waitcnt lgkmcnt(0)
  s_waitcnt vmcnt(16)
  s_barrier
L_A3_ENTRY_A:
  s_add_u32 s60, s72, 24576
  s_add_u32 m0, s69, 0
  s_nop 0
  buffer_load_dwordx4 v13, s[36:39], s60 offen offset:0 sc1 lds
  buffer_load_dwordx4 v13, s[36:39], s60 offen offset:1024 sc1 lds
  buffer_load_dwordx4 v13, s[36:39], s60 offen offset:2048 sc1 lds
  buffer_load_dwordx4 v13, s[36:39], s60 offen offset:3072 sc1 lds
  s_add_u32 s60, s72, 28672
  s_add_u32 m0, s69, 4096
  s_nop 0
  buffer_load_dwordx4 v13, s[36:39], s60 offen offset:0 sc1 lds
  buffer_load_dwordx4 v13, s[36:39], s60 offen offset:1024 sc1 lds
  buffer_load_dwordx4 v13, s[36:39], s60 offen offset:2048 sc1 lds
  buffer_load_dwordx4 v13, s[36:39], s60 offen offset:3072 sc1 lds
  s_waitcnt vmcnt(16)
  s_barrier
  s_mov_b32 s65, 0x10000
L_poll_18:
  buffer_load_dword v48, v19, s[36:39], 0 offen sc1
  s_waitcnt vmcnt(0)
  v_cmp_ne_u32 vcc, s56, v48
  s_nop 1
  s_cbranch_vccz L_polld_19
  s_sub_u32 s65, s65, 1
  s_cmp_eq_u32 s65, 0
  s_cbranch_scc1 L_polld_19
  s_sleep 1
  s_branch L_poll_18
L_polld_19:
  s_add_u32 s60, s73, 0
  s_add_u32 m0, s69, 17408
  s_nop 0
  buffer_load_dwordx4 v13, s[36:39], s60 offen offset:0 sc1 lds
  buffer_load_dwordx4 v13, s[36:39], s60 offen offset:1024 sc1 lds
  buffer_load_dwordx4 v13, s[36:39], s60 offen offset:2048 sc1 lds
  buffer_load_dwordx4 v13, s[36:39], s60 offen offset:3072 sc1 lds
  s_add_u32 s60, s73, 4096
  s_add_u32 m0, s69, 21504
  s_nop 0
  buffer_load_dwordx4 v13, s[36:39], s60 offen offset:0 sc1 lds
  buffer_load_dwordx4 v13, s[36:39], s60 offen offset:1024 sc1 lds
  buffer_load_dwordx4 v13, s[36:39], s60 offen offset:2048 sc1 lds
  buffer_load_dwordx4 v13, s[36:39], s60 offen offset:3072 sc1 lds
  s_barrier
  s_add_u32 s60, s73, 8192
  s_add_u32 m0, s69, 34816
  s_nop 0
  buffer_load_dwordx4 v13, s[36:39], s60 offen offset:0 sc1 lds
  buffer_load_dwordx4 v13, s[36:39], s60 offen offset:1024 sc1 lds
  buffer_load_dwordx4 v13, s[36:39], s60 offen offset:2048 sc1 lds
  buffer_load_dwordx4 v13, s[36:39], s60 offen offset:3072 sc1 lds
  s_add_u32 s60, s73, 12288
  s_add_u32 m0, s69, 38912
  s_nop 0
  buffer_load_dwordx4 v13, s[36:39], s60 offen offset:0 sc1 lds
  buffer_load_dwordx4 v13, s[36:39], s60 offen offset:1024 sc1 lds
  buffer_load_dwordx4 v13, s[36:39], s60 offen offset:2048 sc1 lds
  buffer_load_dwordx4 v13, s[36:39], s60 offen offset:3072 sc1 lds
  s_barrier
  s_add_u32 s60, s73, 16384
  s_add_u32 m0, s69, 52224
  s_nop 0
  buffer_load_dwordx4 v13, s[36:39], s60 offen offset:0 sc1 lds
  buffer_load_dwordx4 v13, s[36:39], s60 offen offset:1024 sc1 lds
  buffer_load_dwordx4 v13, s[36:39], s60 offen offset:2048 sc1 lds
  buffer_load_dwordx4 v13, s[36:39], s60 offen offset:3072 sc1 lds
  s_add_u32 s60, s73, 20480
  s_add_u32 m0, s69, 56320
  s_nop 0
  buffer_load_dwordx4 v13, s[36:39], s60 offen offset:0 sc1 lds
  buffer_load_dwordx4 v13, s[36:39], s60 offen offset:1024 sc1 lds
  buffer_load_dwordx4 v13, s[36:39], s60 offen offset:2048 sc1 lds
  buffer_load_dwordx4 v13, s[36:39], s60 offen offset:3072 sc1 lds
  s_waitcnt vmcnt(16)
  s_barrier
  s_add_u32 s60, s73, 24576
  s_add_u32 m0, s69, 0
  s_nop 0
  buffer_load_dwordx4 v13, s[36:39], s60 offen offset:0 sc1 lds
  buffer_load_dwordx4 v13, s[36:39], s60 offen offset:1024 sc1 lds
  buffer_load_dwordx4 v13, s[36:39], s60 offen offset:2048 sc1 lds
  buffer_load_dwordx4 v13, s[36:39], s60 offen offset:3072 sc1 lds
  s_add_u32 s60, s73, 28672
  s_add_u32 m0, s69, 4096
  s_nop 0
  buffer_load_dwordx4 v13, s[36:39], s60 offen offset:0 sc1 lds
  buffer_load_dwordx4 v13, s[36:39], s60 offen offset:1024 sc1 lds
  buffer_load_dwordx4 v13, s[36:39], s60 offen offset:2048 sc1 lds
  buffer_load_dwordx4 v13, s[36:39], s60 offen offset:3072 sc1 lds
  s_waitcnt vmcnt(16)
  s_barrier
  s_add_u32 s60, s73, 32768
  s_add_u32 m0, s69, 17408
  s_nop 0
  buffer_load_dwordx4 v13, s[36:39], s60 offen offset:0 sc1 lds
  buffer_load_dwordx4 v13, s[36:39], s60 offen offset:1024 sc1 lds
  buffer_load_dwordx4 v13, s[36:39], s60 offen offset:2048 sc1 lds
  buffer_load_dwordx4 v13, s[36:39], s60 offen offset:3072 sc1 lds
  s_add_u32 s60, s73, 36864
  s_add_u32 m0, s69, 21504
  s_nop 0
  buffer_load_dwordx4 v13, s[36:39], s60 offen offset:0 sc1 lds
  buffer_load_dwordx4 v13, s[36:39], s60 offen offset:1024 sc1 lds
  buffer_load_dwordx4 v13, s[36:39], s60 offen offset:2048 sc1 lds
  buffer_load_dwordx4 v13, s[36:39], s60 offen offset:3072 sc1 lds
  s_waitcnt vmcnt(16)
  s_barrier
  s_add_u32 s60, s73, 40960
  s_add_u32 m0, s69, 34816
  s_nop 0
  buffer_load_dwordx4 v13, s[36:39], s60 offen offset:0 sc1 lds
  buffer_load_dwordx4 v13, s[36:39], s60 offen offset:1024 sc1 lds
  buffer_load_dwordx4 v13, s[36:39], s60 offen offset:2048 sc1 lds
  buffer_load_dwordx4 v13, s[36:39], s60 offen offset:3072 sc1 lds
  s_add_u32 s60, s73, 45056
  s_add_u32 m0, s69, 38912
  s_nop 0
  buffer_load_dwordx4 v13, s[36:39], s60 offen offset:0 sc1 lds
  buffer_load_dwordx4 v13, s[36:39], s60 offen offset:1024 sc1 lds
  buffer_load_dwordx4 v13, s[36:39], s60 offen offset:2048 sc1 lds
  buffer_load_dwordx4 v13, s[36:39], s60 offen offset:3072 sc1 lds
  s_waitcnt vmcnt(16)
  s_barrier
  s_add_u32 s60, s73, 49152
  s_add_u32 m0, s69, 52224
  s_nop 0
  buffer_load_dwordx4 v13, s[36:39], s60 offen offset:0 sc1 lds
  buffer_load_dwordx4 v13, s[36:39], s60 offen offset:1024 sc1 lds
  buffer_load_dwordx4 v13, s[36:39], s60 offen offset:2048 sc1 lds
  buffer_load_dwordx4 v13, s[36:39], s60 offen offset:3072 sc1 lds
  s_add_u32 s60, s73, 53248
  s_add_u32 m0, s69, 56320
  s_nop 0
  buffer_load_dwordx4 v13, s[36:39], s60 offen offset:0 sc1 lds
  buffer_load_dwordx4 v13, s[36:39], s60 offen offset:1024 sc1 lds
  buffer_load_dwordx4 v13, s[36:39], s60 offen offset:2048 sc1 lds
  buffer_load_dwordx4 v13, s[36:39], s60 offen offset:3072 sc1 lds
  s_waitcnt vmcnt(16)
  s_barrier
  s_add_u32 s60, s73, 57344
  s_add_u32 m0, s69, 0
  s_nop 0
  buffer_load_dwordx4 v13, s[36:39], s60 offen offset:0 sc1 lds
  buffer_load_dwordx4 v13, s[36:39], s60 offen offset:1024 sc1 lds
  buffer_load_dwordx4 v13, s[36:39], s60 offen offset:2048 sc1 lds
  buffer_load_dwordx4 v13, s[36:39], s60 offen offset:3072 sc1 lds
  s_add_u32 s60, s73, 61440
  s_add_u32 m0, s69, 4096
  s_nop 0
  buffer_load_dwordx4 v13, s[36:39], s60 offen offset:0 sc1 lds
  buffer_load_dwordx4 v13, s[36:39], s60 offen offset:1024 sc1 lds
  buffer_load_dwordx4 v13, s[36:39], s60 offen offset:2048 sc1 lds
  buffer_load_dwordx4 v13, s[36:39], s60 offen offset:3072 sc1 lds
  s_waitcnt vmcnt(16)
  s_barrier
  s_add_u32 s60, s73, 65536
  s_add_u32 m0, s69, 17408
  s_nop 0
  buffer_load_dwordx4 v13, s[36:39], s60 offen offset:0 sc1 lds
  buffer_load_dwordx4 v13, s[36:39], s60 offen offset:1024 sc1 lds
  buffer_load_dwordx4 v13, s[36:39], s60 offen offset:2048 sc1 lds
  buffer_load_dwordx4 v13, s[36:39], s60 offen offset:3072 sc1 lds
  s_add_u32 s60, s73, 69632
  s_add_u32 m0, s69, 21504
  s_nop 0
  buffer_load_dwordx4 v13, s[36:39], s60 offen offset:0 sc1 lds
  buffer_load_dwordx4 v13, s[36:39], s60 offen offset:1024 sc1 lds
  buffer_load_dwordx4 v13, s[36:39], s60 offen offset:2048 sc1 lds
  buffer_load_dwordx4 v13, s[36:39], s60 offen offset:3072 sc1 lds
  s_waitcnt vmcnt(16)
  s_barrier
  s_add_u32 s60, s73, 73728
  s_add_u32 m0, s69, 34816
  s_nop 0
  buffer_load_dwordx4 v13, s[36:39], s60 offen offset:0 sc1 lds
  buffer_load_dwordx4 v13, s[36:39], s60 offen offset:1024 sc1 lds
  buffer_load_dwordx4 v13, s[36:39], s60 offen offset:2048 sc1 lds
  buffer_load_dwordx4 v13, s[36:39], s60 offen offset:3072 sc1 lds
  s_add_u32 s60, s73, 77824
  s_add_u32 m0, s69, 38912
  s_nop 0
  buffer_load_dwordx4 v13, s[36:39], s60 offen offset:0 sc1 lds
  buffer_load_dwordx4 v13, s[36:39], s60 offen offset:1024 sc1 lds
  buffer_load_dwordx4 v13, s[36:39], s60 offen offset:2048 sc1 lds
  buffer_load_dwordx4 v13, s[36:39], s60 offen offset:3072 sc1 lds
  s_waitcnt vmcnt(16)
  s_barrier
  s_add_u32 s60, s73, 81920
  s_add_u32 m0, s69, 52224
  s_nop 0
  buffer_load_dwordx4 v13, s[36:39], s60 offen offset:0 sc1 lds
  buffer_load_dwordx4 v13, s[36:39], s60 offen offset:1024 sc1 lds
  buffer_load_dwordx4 v13, s[36:39], s60 offen offset:2048 sc1 lds
  buffer_load_dwordx4 v13, s[36:39], s60 offen offset:3072 sc1 lds
  s_add_u32 s60, s73, 86016
  s_add_u32 m0, s69, 56320
  s_nop 0
  buffer_load_dwordx4 v13, s[36:39], s60 offen offset:0 sc1 lds
  buffer_load_dwordx4 v13, s[36:39], s60 offen offset:1024 sc1 lds
  buffer_load_dwordx4 v13, s[36:39], s60 offen offset:2048 sc1 lds
  buffer_load_dwordx4 v13, s[36:39], s60 offen offset:3072 sc1 lds
  s_waitcnt vmcnt(16)
  s_barrier
  s_add_u32 s60, s73, 90112
  s_add_u32 m0, s69, 0
  s_nop 0
  buffer_load_dwordx4 v13, s[36:39], s60 offen offset:0 sc1 lds
  buffer_load_dwordx4 v13, s[36:39], s60 offen offset:1024 sc1 lds
  buffer_load_dwordx4 v13, s[36:39], s60 offen offset:2048 sc1 lds
  buffer_load_dwordx4 v13, s[36:39], s60 offen offset:3072 sc1 lds
  s_add_u32 s60, s73, 94208
  s_add_u32 m0, s69, 4096
  s_nop 0
  buffer_load_dwordx4 v13, s[36:39], s60 offen offset:0 sc1 lds
  buffer_load_dwordx4 v13, s[36:39], s60 offen offset:1024 sc1 lds
  buffer_load_dwordx4 v13, s[36:39], s60 offen offset:2048 sc1 lds
  buffer_load_dwordx4 v13, s[36:39], s60 offen offset:3072 sc1 lds
  s_waitcnt vmcnt(16)
  s_barrier
  s_add_u32 s60, s73, 98304
  s_add_u32 m0, s69, 17408
  s_nop 0
  buffer_load_dwordx4 v13, s[36:39], s60 offen offset:0 sc1 lds
  buffer_load_dwordx4 v13, s[36:39], s60 offen offset:1024 sc1 lds
  buffer_load_dwordx4 v13, s[36:39], s60 offen offset:2048 sc1 lds
  buffer_load_dwordx4 v13, s[36:39], s60 offen offset:3072 sc1 lds
  s_add_u32 s60, s73, 102400
  s_add_u32 m0, s69, 21504
  s_nop 0
  buffer_load_dwordx4 v13, s[36:39], s60 offen offset:0 sc1 lds
  buffer_load_dwordx4 v13, s[36:39], s60 offen offset:1024 sc1 lds
  buffer_load_dwordx4 v13, s[36:39], s60 offen offset:2048 sc1 lds
  buffer_load_dwordx4 v13, s[36:39], s60 offen offset:3072 sc1 lds
  s_waitcnt vmcnt(16)
  s_barrier
  s_add_u32 s60, s73, 106496
  s_add_u32 m0, s69, 34816
  s_nop 0
  buffer_load_dwordx4 v13, s[36:39], s60 offen offset:0 sc1 lds
  buffer_load_dwordx4 v13, s[36:39], s60 offen offset:1024 sc1 lds
  buffer_load_dwordx4 v13, s[36:39], s60 offen offset:2048 sc1 lds
  buffer_load_dwordx4 v13, s[36:39], s60 offen offset:3072 sc1 lds
  s_add_u32 s60, s73, 110592
  s_add_u32 m0, s69, 38912
  s_nop 0
  buffer_load_dwordx4 v13, s[36:39], s60 offen offset:0 sc1 lds
  buffer_load_dwordx4 v13, s[36:39], s60 offen offset:1024 sc1 lds
  buffer_load_dwordx4 v13, s[36:39], s60 offen offset:2048 sc1 lds
  buffer_load_dwordx4 v13, s[36:39], s60 offen offset:3072 sc1 lds
  s_waitcnt vmcnt(16)
  s_barrier
  s_waitcnt vmcnt(8)
  s_barrier
  s_waitcnt vmcnt(0)
  s_barrier
  s_barrier
  s_branch L_END
L_IDLE_A:
  s_waitcnt vmcnt(0)
  s_lshl_b32 s64, s52, 3
  s_add_u32 s64, s64, s44
  s_lshl_b32 s64, s64, 5
  s_add_u32 s64, s64, s51
  s_lshl_b32 s64, s64, 2
  s_add_u32 s64, s64, 20996096
  s_mov_b64 exec, 1
  buffer_store_dword v27, off, s[36:39], s64 sc1
  s_mov_b64 exec, -1
  s_barrier
  s_mov_b32 s65, 0x10000
L_poll_20:
  buffer_load_dword v48, v18, s[36:39], 0 offen sc1
  s_waitcnt vmcnt(0)
  v_cmp_ne_u32 vcc, s56, v48
  s_nop 1
  s_cbranch_vccz L_polld_21
  s_sub_u32 s65, s65, 1
  s_cmp_eq_u32 s65, 0
  s_cbranch_scc1 L_polld_21
  s_sleep 1
  s_branch L_poll_20
L_polld_21:
  s_add_u32 s60, s72, 0
  s_add_u32 m0, s69, 17408
  s_nop 0
  buffer_load_dwordx4 v13, s[36:39], s60 offen offset:0 sc1 lds
  buffer_load_dwordx4 v13, s[36:39], s60 offen offset:1024 sc1 lds
  buffer_load_dwordx4 v13, s[36:39], s60 offen offset:2048 sc1 lds
  buffer_load_dwordx4 v13, s[36:39], s60 offen offset:3072 sc1 lds
  s_add_u32 s60, s72, 4096
  s_add_u32 m0, s69, 21504
  s_nop 0
  buffer_load_dwordx4 v13, s[36:39], s60 offen offset:0 sc1 lds
  buffer_load_dwordx4 v13, s[36:39], s60 offen offset:1024 sc1 lds
  buffer_load_dwordx4 v13, s[36:39], s60 offen offset:2048 sc1 lds
  buffer_load_dwordx4 v13, s[36:39], s60 offen offset:3072 sc1 lds
  s_add_u32 s60, s72, 8192
  s_add_u32 m0, s69, 34816
  s_nop 0
  buffer_load_dwordx4 v13, s[36:39], s60 offen offset:0 sc1 lds
  buffer_load_dwordx4 v13, s[36:39], s60 offen offset:1024 sc1 lds
  buffer_load_dwordx4 v13, s[36:39], s60 offen offset:2048 sc1 lds
  buffer_load_dwordx4 v13, s[36:39], s60 offen offset:3072 sc1 lds
  s_add_u32 s60, s72, 12288
  s_add_u32 m0, s69, 38912
  s_nop 0
  buffer_load_dwordx4 v13, s[36:39], s60 offen offset:0 sc1 lds
  buffer_load_dwordx4 v13, s[36:39], s60 offen offset:1024 sc1 lds
  buffer_load_dwordx4 v13, s[36:39], s60 offen offset:2048 sc1 lds
  buffer_load_dwordx4 v13, s[36:39], s60 offen offset:3072 sc1 lds
  s_add_u32 s60, s72, 16384
  s_add_u32 m0, s69, 52224
  s_nop 0
  buffer_load_dwordx4 v13, s[36:39], s60 offen offset:0 sc1 lds
  buffer_load_dwordx4 v13, s[36:39], s60 offen offset:1024 sc1 lds
  buffer_load_dwordx4 v13, s[36:39], s60 offen offset:2048 sc1 lds
  buffer_load_dwordx4 v13, s[36:39], s60 offen offset:3072 sc1 lds
  s_add_u32 s60, s72, 20480
  s_add_u32 m0, s69, 56320
  s_nop 0
  buffer_load_dwordx4 v13, s[36:39], s60 offen offset:0 sc1 lds
  buffer_load_dwordx4 v13, s[36:39], s60 offen offset:1024 sc1 lds
  buffer_load_dwordx4 v13, s[36:39], s60 offen offset:2048 sc1 lds
  buffer_load_dwordx4 v13, s[36:39], s60 offen offset:3072 sc1 lds
  s_waitcnt vmcnt(16)
  s_barrier
  s_branch L_A3_ENTRY_A
L_LOADB:
  s_mov_b32 s59, 2
  s_lshl_b32 s69, s58, 13
  s_lshl_b32 s70, s58, 16
  v_lshrrev_b32 v52, 3, v1
  v_lshlrev_b32 v2, 10, v52
  v_lshrrev_b32 v52, 4, v1
  v_and_b32 v52, 1, v52
  v_lshlrev_b32 v52, 2, v52
  v_and_b32 v53, 7, v1
  v_xor_b32 v52, v52, v53
  v_lshl_add_u32 v2, v52, 4, v2
  s_lshl_b32 s60, s48, 7
  v_add_u32 v2, s60, v2
  s_add_u32 s60, s70, 0
  s_add_u32 m0, s69, 69632
  s_nop 0
  buffer_load_dwordx4 v2, s[16:19], s60 offen offset:0 lds
  s_add_u32 s60, s70, 8192
  s_add_u32 m0, s69, 70656
  s_nop 0
  buffer_load_dwordx4 v2, s[16:19], s60 offen offset:0 lds
  s_add_u32 s60, s70, 16384
  s_add_u32 m0, s69, 71680
  s_nop 0
  buffer_load_dwordx4 v2, s[16:19], s60 offen offset:0 lds
  s_add_u32 s60, s70, 24576
  s_add_u32 m0, s69, 72704
  s_nop 0
  buffer_load_dwordx4 v2, s[16:19], s60 offen offset:0 lds
  s_add_u32 s60, s70, 32768
  s_add_u32 m0, s69, 73728
  s_nop 0
  buffer_load_dwordx4 v2, s[16:19], s60 offen offset:0 lds
  s_add_u32 s60, s70, 40960
  s_add_u32 m0, s69, 74752
  s_nop 0
  buffer_load_dwordx4 v2, s[16:19], s60 offen offset:0 lds
  s_add_u32 s60, s70, 49152
  s_add_u32 m0, s69, 75776
  s_nop 0
  buffer_load_dwordx4 v2, s[16:19], s60 offen offset:0 lds
  s_add_u32 s60, s70, 57344
  s_add_u32 m0, s69, 76800
  s_nop 0
  buffer_load_dwordx4 v2, s[16:19], s60 offen offset:0 lds
  s_add_u32 s60, s70, 131072
  s_add_u32 m0, s69, 86016
  s_nop 0
  buffer_load_dwordx4 v2, s[16:19], s60 offen offset:0 lds
  s_add_u32 s60, s70, 139264
  s_add_u32 m0, s69, 87040
  s_nop 0
  buffer_load_dwordx4 v2, s[16:19], s60 offen offset:0 lds
  s_add_u32 s60, s70, 147456
  s_add_u32 m0, s69, 88064
  s_nop 0
  buffer_load_dwordx4 v2, s[16:19], s60 offen offset:0 lds
  s_add_u32 s60, s70, 155648
  s_add_u32 m0, s69, 89088
  s_nop 0
  buffer_load_dwordx4 v2, s[16:19], s60 offen offset:0 lds
  s_add_u32 s60, s70, 163840
  s_add_u32 m0, s69, 90112
  s_nop 0
  buffer_load_dwordx4 v2, s[16:19], s60 offen offset:0 lds
  s_add_u32 s60, s70, 172032
  s_add_u32 m0, s69, 91136
  s_nop 0
  buffer_load_dwordx4 v2, s[16:19], s60 offen offset:0 lds
  s_add_u32 s60, s70, 180224
  s_add_u32 m0, s69, 92160
  s_nop 0
  buffer_load_dwordx4 v2, s[16:19], s60 offen offset:0 lds
  s_add_u32 s60, s70, 188416
  s_add_u32 m0, s69, 93184
  s_nop 0
  buffer_load_dwordx4 v2, s[16:19], s60 offen offset:0 lds
  s_add_u32 s60, s70, 262144
  s_add_u32 m0, s69, 102400
  s_nop 0
  buffer_load_dwordx4 v2, s[16:19], s60 offen offset:0 lds
  s_add_u32 s60, s70, 270336
  s_add_u32 m0, s69, 103424
  s_nop 0
  buffer_load_dwordx4 v2, s[16:19], s60 offen offset:0 lds
  s_add_u32 s60, s70, 278528
  s_add_u32 m0, s69, 104448
  s_nop 0
  buffer_load_dwordx4 v2, s[16:19], s60 offen offset:0 lds
  s_add_u32 s60, s70, 286720
  s_add_u32 m0, s69, 105472
  s_nop 0
  buffer_load_dwordx4 v2, s[16:19], s60 offen offset:0 lds
  s_add_u32 s60, s70, 294912
  s_add_u32 m0, s69, 106496
  s_nop 0
  buffer_load_dwordx4 v2, s[16:19], s60 offen offset:0 lds
  s_add_u32 s60, s70, 303104
  s_add_u32 m0, s69, 107520
  s_nop 0
  buffer_load_dwordx4 v2, s[16:19], s60 offen offset:0 lds
  s_add_u32 s60, s70, 311296
  s_add_u32 m0, s69, 108544
  s_nop 0
  buffer_load_dwordx4 v2, s[16:19], s60 offen offset:0 lds
  s_add_u32 s60, s70, 319488
  s_add_u32 m0, s69, 109568
  s_nop 0
  buffer_load_dwordx4 v2, s[16:19], s60 offen offset:0 lds
  s_add_u32 s60, s70, 393216
  s_add_u32 m0, s69, 118784
  s_nop 0
  buffer_load_dwordx4 v2, s[16:19], s60 offen offset:0 lds
  s_add_u32 s60, s70, 401408
  s_add_u32 m0, s69, 119808
  s_nop 0
  buffer_load_dwordx4 v2, s[16:19], s60 offen offset:0 lds
  s_add_u32 s60, s70, 409600
  s_add_u32 m0, s69, 120832
  s_nop 0
  buffer_load_dwordx4 v2, s[16:19], s60 offen offset:0 lds
  s_add_u32 s60, s70, 417792
  s_add_u32 m0, s69, 121856
  s_nop 0
  buffer_load_dwordx4 v2, s[16:19], s60 offen offset:0 lds
  s_add_u32 s60, s70, 425984
  s_add_u32 m0, s69, 122880
  s_nop 0
  buffer_load_dwordx4 v2, s[16:19], s60 offen offset:0 lds
  s_add_u32 s60, s70, 434176
  s_add_u32 m0, s69, 123904
  s_nop 0
  buffer_load_dwordx4 v2, s[16:19], s60 offen offset:0 lds
  s_add_u32 s60, s70, 442368
  s_add_u32 m0, s69, 124928
  s_nop 0
  buffer_load_dwordx4 v2, s[16:19], s60 offen offset:0 lds
  s_add_u32 s60, s70, 450560
  s_add_u32 m0, s69, 125952
  s_nop 0
  buffer_load_dwordx4 v2, s[16:19], s60 offen offset:0 lds
  v_add_u32 v52, 0, v1
  v_mul_u32_u24 v53, 43691, v52
  v_lshrrev_b32 v53, 19, v53
  v_mul_u32_u24 v54, 12, v53
  v_sub_u32 v54, v52, v54
  v_mul_u32_u24 v3, 3072, v53
  v_lshrrev_b32 v55, 2, v54
  v_lshl_add_u32 v3, v55, 10, v3
  v_and_b32 v55, 3, v54
  v_lshl_add_u32 v3, v55, 4, v3
  s_lshl_b32 s60, s49, 6
  v_add_u32 v3, s60, v3
  v_add_u32 v52, 64, v1
  v_mul_u32_u24 v53, 43691, v52
  v_lshrrev_b32 v53, 19, v53
  v_mul_u32_u24 v54, 12, v53
  v_sub_u32 v54, v52, v54
  v_mul_u32_u24 v4, 3072, v53
  v_lshrrev_b32 v55, 2, v54
  v_lshl_add_u32 v4, v55, 10, v4
  v_and_b32 v55, 3, v54
  v_lshl_add_u32 v4, v55, 4, v4
  s_lshl_b32 s60, s49, 6
  v_add_u32 v4, s60, v4
  v_add_u32 v52, 128, v1
  v_mul_u32_u24 v53, 43691, v52
  v_lshrrev_b32 v53, 19, v53
  v_mul_u32_u24 v54, 12, v53
  v_sub_u32 v54, v52, v54
  v_mul_u32_u24 v5, 3072, v53
  v_lshrrev_b32 v55, 2, v54
  v_lshl_add_u32 v5, v55, 10, v5
  v_and_b32 v55, 3, v54
  v_lshl_add_u32 v5, v55, 4, v5
  s_lshl_b32 s60, s49, 6
  v_add_u32 v5, s60, v5
  s_mul_i32 s71, s58, 98304
  s_mul_i32 s72, s58, 6144
  s_mul_i32 s73, s58, 114688
  v_lshrrev_b32 v52, 4, v1
  v_mul_u32_u24 v6, 3584, v52
  v_lshlrev_b32 v52, 2, v52
  v_and_b32 v53, 15, v1
  v_xor_b32 v52, v52, v53
  v_lshl_add_u32 v6, v52, 4, v6
  s_lshl_b32 s60, s54, 8
  s_lshl_b32 s61, s57, 30
  s_add_u32 s60, s60, s61
  v_add_u32 v6, s60, v6
  s_lshl_b32 s60, s51, 3
  s_add_u32 s60, s60, s52
  s_lshl_b32 s60, s60, 13
  s_add_u32 s61, s60, s69
  s_add_u32 s75, s61, 6283264
  v_and_b32 v48, 31, v1
  v_lshrrev_b32 v49, 5, v1
  v_and_b32 v50, 15, v1
  v_lshrrev_b32 v51, 4, v1
  s_sub_u32 s67, s44, 4
  v_mov_b32 v26, 0x3f803f80
  v_lshlrev_b32 v13, 4, v1
  v_and_b32 v52, 3, v48
  v_add_u32 v52, 64, v52
  v_lshlrev_b32 v31, 2, v52
  v_add_u32 v31, 159744, v31
  v_and_b32 v53, 15, v52
  v_lshlrev_b32 v54, 3, v49
  v_xor_b32 v53, v53, v54
  v_lshlrev_b32 v53, 4, v53
  v_lshl_add_u32 v20, v52, 8, v53
  s_lshl_b32 s60, s67, 5
  v_add_u32 v52, s60, v48
  v_lshlrev_b32 v32, 2, v52
  v_add_u32 v32, 159744, v32
  v_lshrrev_b32 v53, 1, v52
  v_and_b32 v53, 7, v53
  v_lshlrev_b32 v54, 2, v49
  v_xor_b32 v53, v53, v54
  v_lshlrev_b32 v53, 4, v53
  v_lshl_add_u32 v21, v52, 7, v53
  s_lshl_b32 s60, s67, 12
  v_add_u32 v22, s60, v13
  v_lshrrev_b32 v52, 2, v50
  v_mul_u32_u24 v53, 8, v49
  v_add_u32 v53, v53, v52
  v_mul_u32_u24 v28, 128, v53
  v_lshrrev_b32 v53, 3, v50
  v_xor_b32 v53, s58, v53
  v_lshl_add_u32 v28, v53, 6, v28
  v_and_b32 v53, 1, v51
  v_lshl_add_u32 v28, v53, 5, v28
  v_and_b32 v53, 3, v50
  v_lshl_add_u32 v28, v53, 3, v28
  s_min_u32 s61, s67, 2
  v_lshrrev_b32 v52, 2, v50
  v_mul_u32_u24 v53, 8, v49
  v_add_u32 v53, v53, v52
  v_mul_u32_u24 v29, 192, v53
  v_mov_b32 v53, s61
  v_lshl_add_u32 v29, v53, 6, v29
  v_and_b32 v53, 1, v51
  v_lshl_add_u32 v29, v53, 5, v29
  v_and_b32 v53, 3, v50
  v_lshl_add_u32 v29, v53, 3, v29
  v_lshrrev_b32 v52, 2, v50
  v_mul_u32_u24 v53, 8, v49
  v_add_u32 v53, v53, v52
  v_mul_u32_u24 v30, 256, v53
  v_xor_b32 v53, s67, v52
  v_lshl_add_u32 v30, v53, 6, v30
  v_and_b32 v53, 1, v51
  v_lshl_add_u32 v30, v53, 5, v30
  v_and_b32 v53, 3, v50
  v_lshl_add_u32 v30, v53, 3, v30
  s_lshl_b32 s60, s58, 5
  v_add_u32 v33, s60, v48
  v_lshlrev_b32 v33, 2, v33
  v_add_u32 v33, 161792, v33
  s_lshl_b32 s60, s67, 5
  v_add_u32 v34, s60, v48
  v_lshlrev_b32 v34, 2, v34
  v_add_u32 v34, 161792, v34
  s_or_b32 s60, s52, s58
  s_cmp_eq_u32 s60, 0
  s_cselect_b32 s60, 0x40000000, 0
  v_add_u32 v14, s60, v13
  v_lshrrev_b32 v52, 2, v50
  s_lshl_b32 s60, s52, 1
  s_sub_u32 s60, s60, 2
  v_add_u32 v52, s60, v52
  v_max_i32 v52, 0, v52
  s_lshr_b32 s60, s51, 1
  s_lshl_b32 s60, s60, 4
  v_add_u32 v52, s60, v52
  v_and_b32 v53, 3, v50
  v_lshl_add_u32 v52, v52, 2, v53
  v_lshlrev_b32 v16, 2, v52
  v_add_u32 v16, 20979712, v16
  s_waitcnt vmcnt(24)
  s_barrier
  s_add_u32 s60, s71, 0
  s_add_u32 m0, s72, 135168
  s_nop 0
  buffer_load_dwordx4 v3, s[8:11], s60 offen offset:0 lds
  s_add_u32 s60, s71, 0
  s_add_u32 m0, s72, 136192
  s_nop 0
  buffer_load_dwordx4 v4, s[8:11], s60 offen offset:0 lds
  s_add_u32 s60, s71, 0
  s_add_u32 m0, s72, 137216
  s_nop 0
  buffer_load_dwordx4 v5, s[8:11], s60 offen offset:0 lds
  s_add_u32 s60, s71, 49152
  s_add_u32 m0, s72, 138240
  s_nop 0
  buffer_load_dwordx4 v3, s[8:11], s60 offen offset:0 lds
  s_add_u32 s60, s71, 49152
  s_add_u32 m0, s72, 139264
  s_nop 0
  buffer_load_dwordx4 v4, s[8:11], s60 offen offset:0 lds
  s_add_u32 s60, s71, 49152
  s_add_u32 m0, s72, 140288
  s_nop 0
  buffer_load_dwordx4 v5, s[8:11], s60 offen offset:0 lds
  v_mov_b32 v23, 0
  v_mov_b32 v24, 0
  v_mov_b32 v25, 0
  v_add_u32 v108, 0, v20
  v_xor_b32 v110, 0, v108
  v_xor_b32 v111, 16, v108
  v_xor_b32 v112, 32, v108
  v_xor_b32 v113, 48, v108
  v_xor_b32 v114, 64, v108
  v_xor_b32 v115, 80, v108
  v_xor_b32 v116, 96, v108
  v_xor_b32 v117, 112, v108
  ds_read_b128 v[48:51], v110 offset:0
  ds_read_b128 v[52:55], v111 offset:0
  ds_read_b128 v[56:59], v112 offset:0
  ds_read_b128 v[60:63], v113 offset:0
  ds_read_b128 v[64:67], v114 offset:0
  ds_read_b128 v[68:71], v115 offset:0
  ds_read_b128 v[72:75], v116 offset:0
  ds_read_b128 v[76:79], v117 offset:0
  s_waitcnt lgkmcnt(7)
  v_dot2c_f32_bf16 v23, v48, v26
  v_dot2c_f32_bf16 v24, v48, v48
  v_dot2c_f32_bf16 v23, v49, v26
  v_dot2c_f32_bf16 v24, v49, v49
  v_dot2c_f32_bf16 v23, v50, v26
  v_dot2c_f32_bf16 v24, v50, v50
  v_dot2c_f32_bf16 v23, v51, v26
  v_dot2c_f32_bf16 v24, v51, v51
  s_waitcnt lgkmcnt(6)
  v_dot2c_f32_bf16 v23, v52, v26
  v_dot2c_f32_bf16 v24, v52, v52
  v_dot2c_f32_bf16 v23, v53, v26
  v_dot2c_f32_bf16 v24, v53, v53
  v_dot2c_f32_bf16 v23, v54, v26
  v_dot2c_f32_bf16 v24, v54, v54
  v_dot2c_f32_bf16 v23, v55, v26
  v_dot2c_f32_bf16 v24, v55, v55
  s_waitcnt lgkmcnt(5)
  v_dot2c_f32_bf16 v23, v56, v26
  v_dot2c_f32_bf16 v24, v56, v56
  v_dot2c_f32_bf16 v23, v57, v26
  v_dot2c_f32_bf16 v24, v57, v57
  v_dot2c_f32_bf16 v23, v58, v26
  v_dot2c_f32_bf16 v24, v58, v58
  v_dot2c_f32_bf16 v23, v59, v26
  v_dot2c_f32_bf16 v24, v59, v59
  s_waitcnt lgkmcnt(4)
  v_dot2c_f32_bf16 v23, v60, v26
  v_dot2c_f32_bf16 v24, v60, v60
  v_dot2c_f32_bf16 v23, v61, v26
  v_dot2c_f32_bf16 v24, v61, v61
  v_dot2c_f32_bf16 v23, v62, v26
  v_dot2c_f32_bf16 v24, v62, v62
  v_dot2c_f32_bf16 v23, v63, v26
  v_dot2c_f32_bf16 v24, v63, v63
  s_waitcnt lgkmcnt(3)
  v_dot2c_f32_bf16 v23, v64, v26
  v_dot2c_f32_bf16 v24, v64, v64
  v_dot2c_f32_bf16 v23, v65, v26
  v_dot2c_f32_bf16 v24, v65, v65
  v_dot2c_f32_bf16 v23, v66, v26
  v_dot2c_f32_bf16 v24, v66, v66
  v_dot2c_f32_bf16 v23, v67, v26
  v_dot2c_f32_bf16 v24, v67, v67
  s_waitcnt lgkmcnt(2)
  v_dot2c_f32_bf16 v23, v68, v26
  v_dot2c_f32_bf16 v24, v68, v68
  v_dot2c_f32_bf16 v23, v69, v26
  v_dot2c_f32_bf16 v24, v69, v69
  v_dot2c_f32_bf16 v23, v70, v26
  v_dot2c_f32_bf16 v24, v70, v70
  v_dot2c_f32_bf16 v23, v71, v26
  v_dot2c_f32_bf16 v24, v71, v71
  s_waitcnt lgkmcnt(1)
  v_dot2c_f32_bf16 v23, v72, v26
  v_dot2c_f32_bf16 v24, v72, v72
  v_dot2c_f32_bf16 v23, v73, v26
  v_dot2c_f32_bf16 v24, v73, v73
  v_dot2c_f32_bf16 v23, v74, v26
  v_dot2c_f32_bf16 v24, v74, v74
  v_dot2c_f32_bf16 v23, v75, v26
  v_dot2c_f32_bf16 v24, v75, v75
  s_waitcnt lgkmcnt(0)
  v_dot2c_f32_bf16 v23, v76, v26
  v_dot2c_f32_bf16 v24, v76, v76
  v_dot2c_f32_bf16 v23, v77, v26
  v_dot2c_f32_bf16 v24, v77, v77
  v_dot2c_f32_bf16 v23, v78, v26
  v_dot2c_f32_bf16 v24, v78, v78
  v_dot2c_f32_bf16 v23, v79, v26
  v_dot2c_f32_bf16 v24, v79, v79
  v_add_u32 v109, 69632, v28
  ds_read_b64_tr_b16 v[88:89], v109 offset:0
  ds_read_b64_tr_b16 v[90:91], v109 offset:512
  ds_read_b64_tr_b16 v[92:93], v109 offset:2048
  ds_read_b64_tr_b16 v[94:95], v109 offset:2560
  ds_read_b64_tr_b16 v[96:97], v109 offset:4096
  ds_read_b64_tr_b16 v[98:99], v109 offset:4608
  ds_read_b64_tr_b16 v[100:101], v109 offset:6144
  ds_read_b64_tr_b16 v[102:103], v109 offset:6656
  s_waitcnt lgkmcnt(7)
  v_dot2c_f32_bf16 v25, v88, v26
  v_dot2c_f32_bf16 v25, v89, v26
  s_waitcnt lgkmcnt(6)
  v_dot2c_f32_bf16 v25, v90, v26
  v_dot2c_f32_bf16 v25, v91, v26
  s_waitcnt lgkmcnt(5)
  v_dot2c_f32_bf16 v25, v92, v26
  v_dot2c_f32_bf16 v25, v93, v26
  s_waitcnt lgkmcnt(4)
  v_dot2c_f32_bf16 v25, v94, v26
  v_dot2c_f32_bf16 v25, v95, v26
  s_waitcnt lgkmcnt(3)
  v_dot2c_f32_bf16 v25, v96, v26
  v_dot2c_f32_bf16 v25, v97, v26
  s_waitcnt lgkmcnt(2)
  v_dot2c_f32_bf16 v25, v98, v26
  v_dot2c_f32_bf16 v25, v99, v26
  s_waitcnt lgkmcnt(1)
  v_dot2c_f32_bf16 v25, v100, v26
  v_dot2c_f32_bf16 v25, v101, v26
  s_waitcnt lgkmcnt(0)
  v_dot2c_f32_bf16 v25, v102, v26
  v_dot2c_f32_bf16 v25, v103, v26
  ds_read_b64_tr_b16 v[88:89], v109 offset:8192
  ds_read_b64_tr_b16 v[90:91], v109 offset:8704
  ds_read_b64_tr_b16 v[92:93], v109 offset:10240
  ds_read_b64_tr_b16 v[94:95], v109 offset:10752
  ds_read_b64_tr_b16 v[96:97], v109 offset:12288
  ds_read_b64_tr_b16 v[98:99], v109 offset:12800
  ds_read_b64_tr_b16 v[100:101], v109 offset:14336
  ds_read_b64_tr_b16 v[102:103], v109 offset:14848
  s_waitcnt lgkmcnt(7)
  v_dot2c_f32_bf16 v25, v88, v26
  v_dot2c_f32_bf16 v25, v89, v26
  s_waitcnt lgkmcnt(6)
  v_dot2c_f32_bf16 v25, v90, v26
  v_dot2c_f32_bf16 v25, v91, v26
  s_waitcnt lgkmcnt(5)
  v_dot2c_f32_bf16 v25, v92, v26
  v_dot2c_f32_bf16 v25, v93, v26
  s_waitcnt lgkmcnt(4)
  v_dot2c_f32_bf16 v25, v94, v26
  v_dot2c_f32_bf16 v25, v95, v26
  s_waitcnt lgkmcnt(3)
  v_dot2c_f32_bf16 v25, v96, v26
  v_dot2c_f32_bf16 v25, v97, v26
  s_waitcnt lgkmcnt(2)
  v_dot2c_f32_bf16 v25, v98, v26
  v_dot2c_f32_bf16 v25, v99, v26
  s_waitcnt lgkmcnt(1)
  v_dot2c_f32_bf16 v25, v100, v26
  v_dot2c_f32_bf16 v25, v101, v26
  s_waitcnt lgkmcnt(0)
  v_dot2c_f32_bf16 v25, v102, v26
  v_dot2c_f32_bf16 v25, v103, v26
  s_waitcnt vmcnt(22)
  s_barrier
  s_add_u32 s60, s71, 196608
  s_add_u32 m0, s72, 69632
  s_nop 0
  buffer_load_dwordx4 v3, s[8:11], s60 offen offset:0 lds
  s_add_u32 s60, s71, 196608
  s_add_u32 m0, s72, 70656
  s_nop 0
  buffer_load_dwordx4 v4, s[8:11], s60 offen offset:0 lds
  s_add_u32 s60, s71, 196608
  s_add_u32 m0, s72, 71680
  s_nop 0
  buffer_load_dwordx4 v5, s[8:11], s60 offen offset:0 lds
  s_add_u32 s60, s71, 245760
  s_add_u32 m0, s72, 72704
  s_nop 0
  buffer_load_dwordx4 v3, s[8:11], s60 offen offset:0 lds
  s_add_u32 s60, s71, 245760
  s_add_u32 m0, s72, 73728
  s_nop 0
  buffer_load_dwordx4 v4, s[8:11], s60 offen offset:0 lds
  s_add_u32 s60, s71, 245760
  s_add_u32 m0, s72, 74752
  s_nop 0
  buffer_load_dwordx4 v5, s[8:11], s60 offen offset:0 lds
  v_add_u32 v108, 17408, v20
  v_xor_b32 v110, 0, v108
  v_xor_b32 v111, 16, v108
  v_xor_b32 v112, 32, v108
  v_xor_b32 v113, 48, v108
  v_xor_b32 v114, 64, v108
  v_xor_b32 v115, 80, v108
  v_xor_b32 v116, 96, v108
  v_xor_b32 v117, 112, v108
  ds_read_b128 v[48:51], v110 offset:0
  ds_read_b128 v[52:55], v111 offset:0
  ds_read_b128 v[56:59], v112 offset:0
  ds_read_b128 v[60:63], v113 offset:0
  ds_read_b128 v[64:67], v114 offset:0
  ds_read_b128 v[68:71], v115 offset:0
  ds_read_b128 v[72:75], v116 offset:0
  ds_read_b128 v[76:79], v117 offset:0
  s_waitcnt lgkmcnt(7)
  v_dot2c_f32_bf16 v23, v48, v26
  v_dot2c_f32_bf16 v24, v48, v48
  v_dot2c_f32_bf16 v23, v49, v26
  v_dot2c_f32_bf16 v24, v49, v49
  v_dot2c_f32_bf16 v23, v50, v26
  v_dot2c_f32_bf16 v24, v50, v50
  v_dot2c_f32_bf16 v23, v51, v26
  v_dot2c_f32_bf16 v24, v51, v51
  s_waitcnt lgkmcnt(6)
  v_dot2c_f32_bf16 v23, v52, v26
  v_dot2c_f32_bf16 v24, v52, v52
  v_dot2c_f32_bf16 v23, v53, v26
  v_dot2c_f32_bf16 v24, v53, v53
  v_dot2c_f32_bf16 v23, v54, v26
  v_dot2c_f32_bf16 v24, v54, v54
  v_dot2c_f32_bf16 v23, v55, v26
  v_dot2c_f32_bf16 v24, v55, v55
  s_waitcnt lgkmcnt(5)
  v_dot2c_f32_bf16 v23, v56, v26
  v_dot2c_f32_bf16 v24, v56, v56
  v_dot2c_f32_bf16 v23, v57, v26
  v_dot2c_f32_bf16 v24, v57, v57
  v_dot2c_f32_bf16 v23, v58, v26
  v_dot2c_f32_bf16 v24, v58, v58
  v_dot2c_f32_bf16 v23, v59, v26
  v_dot2c_f32_bf16 v24, v59, v59
  s_waitcnt lgkmcnt(4)
  v_dot2c_f32_bf16 v23, v60, v26
  v_dot2c_f32_bf16 v24, v60, v60
  v_dot2c_f32_bf16 v23, v61, v26
  v_dot2c_f32_bf16 v24, v61, v61
  v_dot2c_f32_bf16 v23, v62, v26
  v_dot2c_f32_bf16 v24, v62, v62
  v_dot2c_f32_bf16 v23, v63, v26
  v_dot2c_f32_bf16 v24, v63, v63
  s_waitcnt lgkmcnt(3)
  v_dot2c_f32_bf16 v23, v64, v26
  v_dot2c_f32_bf16 v24, v64, v64
  v_dot2c_f32_bf16 v23, v65, v26
  v_dot2c_f32_bf16 v24, v65, v65
  v_dot2c_f32_bf16 v23, v66, v26
  v_dot2c_f32_bf16 v24, v66, v66
  v_dot2c_f32_bf16 v23, v67, v26
  v_dot2c_f32_bf16 v24, v67, v67
  s_waitcnt lgkmcnt(2)
  v_dot2c_f32_bf16 v23, v68, v26
  v_dot2c_f32_bf16 v24, v68, v68
  v_dot2c_f32_bf16 v23, v69, v26
  v_dot2c_f32_bf16 v24, v69, v69
  v_dot2c_f32_bf16 v23, v70, v26
  v_dot2c_f32_bf16 v24, v70, v70
  v_dot2c_f32_bf16 v23, v71, v26
  v_dot2c_f32_bf16 v24, v71, v71
  s_waitcnt lgkmcnt(1)
  v_dot2c_f32_bf16 v23, v72, v26
  v_dot2c_f32_bf16 v24, v72, v72
  v_dot2c_f32_bf16 v23, v73, v26
  v_dot2c_f32_bf16 v24, v73, v73
  v_dot2c_f32_bf16 v23, v74, v26
  v_dot2c_f32_bf16 v24, v74, v74
  v_dot2c_f32_bf16 v23, v75, v26
  v_dot2c_f32_bf16 v24, v75, v75
  s_waitcnt lgkmcnt(0)
  v_dot2c_f32_bf16 v23, v76, v26
  v_dot2c_f32_bf16 v24, v76, v76
  v_dot2c_f32_bf16 v23, v77, v26
  v_dot2c_f32_bf16 v24, v77, v77
  v_dot2c_f32_bf16 v23, v78, v26
  v_dot2c_f32_bf16 v24, v78, v78
  v_dot2c_f32_bf16 v23, v79, v26
  v_dot2c_f32_bf16 v24, v79, v79
  v_add_u32 v109, 86016, v28
  ds_read_b64_tr_b16 v[88:89], v109 offset:0
  ds_read_b64_tr_b16 v[90:91], v109 offset:512
  ds_read_b64_tr_b16 v[92:93], v109 offset:2048
  ds_read_b64_tr_b16 v[94:95], v109 offset:2560
  ds_read_b64_tr_b16 v[96:97], v109 offset:4096
  ds_read_b64_tr_b16 v[98:99], v109 offset:4608
  ds_read_b64_tr_b16 v[100:101], v109 offset:6144
  ds_read_b64_tr_b16 v[102:103], v109 offset:6656
  s_waitcnt lgkmcnt(7)
  v_dot2c_f32_bf16 v25, v88, v26
  v_dot2c_f32_bf16 v25, v89, v26
  s_waitcnt lgkmcnt(6)
  v_dot2c_f32_bf16 v25, v90, v26
  v_dot2c_f32_bf16 v25, v91, v26
  s_waitcnt lgkmcnt(5)
  v_dot2c_f32_bf16 v25, v92, v26
  v_dot2c_f32_bf16 v25, v93, v26
  s_waitcnt lgkmcnt(4)
  v_dot2c_f32_bf16 v25, v94, v26
  v_dot2c_f32_bf16 v25, v95, v26
  s_waitcnt lgkmcnt(3)
  v_dot2c_f32_bf16 v25, v96, v26
  v_dot2c_f32_bf16 v25, v97, v26
  s_waitcnt lgkmcnt(2)
  v_dot2c_f32_bf16 v25, v98, v26
  v_dot2c_f32_bf16 v25, v99, v26
  s_waitcnt lgkmcnt(1)
  v_dot2c_f32_bf16 v25, v100, v26
  v_dot2c_f32_bf16 v25, v101, v26
  s_waitcnt lgkmcnt(0)
  v_dot2c_f32_bf16 v25, v102, v26
  v_dot2c_f32_bf16 v25, v103, v26
  ds_read_b64_tr_b16 v[88:89], v109 offset:8192
  ds_read_b64_tr_b16 v[90:91], v109 offset:8704
  ds_read_b64_tr_b16 v[92:93], v109 offset:10240
  ds_read_b64_tr_b16 v[94:95], v109 offset:10752
  ds_read_b64_tr_b16 v[96:97], v109 offset:12288
  ds_read_b64_tr_b16 v[98:99], v109 offset:12800
  ds_read_b64_tr_b16 v[100:101], v109 offset:14336
  ds_read_b64_tr_b16 v[102:103], v109 offset:14848
  s_waitcnt lgkmcnt(7)
  v_dot2c_f32_bf16 v25, v88, v26
  v_dot2c_f32_bf16 v25, v89, v26
  s_waitcnt lgkmcnt(6)
  v_dot2c_f32_bf16 v25, v90, v26
  v_dot2c_f32_bf16 v25, v91, v26
  s_waitcnt lgkmcnt(5)
  v_dot2c_f32_bf16 v25, v92, v26
  v_dot2c_f32_bf16 v25, v93, v26
  s_waitcnt lgkmcnt(4)
  v_dot2c_f32_bf16 v25, v94, v26
  v_dot2c_f32_bf16 v25, v95, v26
  s_waitcnt lgkmcnt(3)
  v_dot2c_f32_bf16 v25, v96, v26
  v_dot2c_f32_bf16 v25, v97, v26
  s_waitcnt lgkmcnt(2)
  v_dot2c_f32_bf16 v25, v98, v26
  v_dot2c_f32_bf16 v25, v99, v26
  s_waitcnt lgkmcnt(1)
  v_dot2c_f32_bf16 v25, v100, v26
  v_dot2c_f32_bf16 v25, v101, v26
  s_waitcnt lgkmcnt(0)
  v_dot2c_f32_bf16 v25, v102, v26
  v_dot2c_f32_bf16 v25, v103, v26
  s_waitcnt vmcnt(20)
  s_barrier
  s_add_u32 s60, s71, 393216
  s_add_u32 m0, s72, 86016
  s_nop 0
  buffer_load_dwordx4 v3, s[8:11], s60 offen offset:0 lds
  s_add_u32 s60, s71, 393216
  s_add_u32 m0, s72, 87040
  s_nop 0
  buffer_load_dwordx4 v4, s[8:11], s60 offen offset:0 lds
  s_add_u32 s60, s71, 393216
  s_add_u32 m0, s72, 88064
  s_nop 0
  buffer_load_dwordx4 v5, s[8:11], s60 offen offset:0 lds
  s_add_u32 s60, s71, 442368
  s_add_u32 m0, s72, 89088
  s_nop 0
  buffer_load_dwordx4 v3, s[8:11], s60 offen offset:0 lds
  s_add_u32 s60, s71, 442368
  s_add_u32 m0, s72, 90112
  s_nop 0
  buffer_load_dwordx4 v4, s[8:11], s60 offen offset:0 lds
  s_add_u32 s60, s71, 442368
  s_add_u32 m0, s72, 91136
  s_nop 0
  buffer_load_dwordx4 v5, s[8:11], s60 offen offset:0 lds
  v_add_u32 v108, 34816, v20
  v_xor_b32 v110, 0, v108
  v_xor_b32 v111, 16, v108
  v_xor_b32 v112, 32, v108
  v_xor_b32 v113, 48, v108
  v_xor_b32 v114, 64, v108
  v_xor_b32 v115, 80, v108
  v_xor_b32 v116, 96, v108
  v_xor_b32 v117, 112, v108
  ds_read_b128 v[48:51], v110 offset:0
  ds_read_b128 v[52:55], v111 offset:0
  ds_read_b128 v[56:59], v112 offset:0
  ds_read_b128 v[60:63], v113 offset:0
  ds_read_b128 v[64:67], v114 offset:0
  ds_read_b128 v[68:71], v115 offset:0
  ds_read_b128 v[72:75], v116 offset:0
  ds_read_b128 v[76:79], v117 offset:0
  s_waitcnt lgkmcnt(7)
  v_dot2c_f32_bf16 v23, v48, v26
  v_dot2c_f32_bf16 v24, v48, v48
  v_dot2c_f32_bf16 v23, v49, v26
  v_dot2c_f32_bf16 v24, v49, v49
  v_dot2c_f32_bf16 v23, v50, v26
  v_dot2c_f32_bf16 v24, v50, v50
  v_dot2c_f32_bf16 v23, v51, v26
  v_dot2c_f32_bf16 v24, v51, v51
  s_waitcnt lgkmcnt(6)
  v_dot2c_f32_bf16 v23, v52, v26
  v_dot2c_f32_bf16 v24, v52, v52
  v_dot2c_f32_bf16 v23, v53, v26
  v_dot2c_f32_bf16 v24, v53, v53
  v_dot2c_f32_bf16 v23, v54, v26
  v_dot2c_f32_bf16 v24, v54, v54
  v_dot2c_f32_bf16 v23, v55, v26
  v_dot2c_f32_bf16 v24, v55, v55
  s_waitcnt lgkmcnt(5)
  v_dot2c_f32_bf16 v23, v56, v26
  v_dot2c_f32_bf16 v24, v56, v56
  v_dot2c_f32_bf16 v23, v57, v26
  v_dot2c_f32_bf16 v24, v57, v57
  v_dot2c_f32_bf16 v23, v58, v26
  v_dot2c_f32_bf16 v24, v58, v58
  v_dot2c_f32_bf16 v23, v59, v26
  v_dot2c_f32_bf16 v24, v59, v59
  s_waitcnt lgkmcnt(4)
  v_dot2c_f32_bf16 v23, v60, v26
  v_dot2c_f32_bf16 v24, v60, v60
  v_dot2c_f32_bf16 v23, v61, v26
  v_dot2c_f32_bf16 v24, v61, v61
  v_dot2c_f32_bf16 v23, v62, v26
  v_dot2c_f32_bf16 v24, v62, v62
  v_dot2c_f32_bf16 v23, v63, v26
  v_dot2c_f32_bf16 v24, v63, v63
  s_waitcnt lgkmcnt(3)
  v_dot2c_f32_bf16 v23, v64, v26
  v_dot2c_f32_bf16 v24, v64, v64
  v_dot2c_f32_bf16 v23, v65, v26
  v_dot2c_f32_bf16 v24, v65, v65
  v_dot2c_f32_bf16 v23, v66, v26
  v_dot2c_f32_bf16 v24, v66, v66
  v_dot2c_f32_bf16 v23, v67, v26
  v_dot2c_f32_bf16 v24, v67, v67
  s_waitcnt lgkmcnt(2)
  v_dot2c_f32_bf16 v23, v68, v26
  v_dot2c_f32_bf16 v24, v68, v68
  v_dot2c_f32_bf16 v23, v69, v26
  v_dot2c_f32_bf16 v24, v69, v69
  v_dot2c_f32_bf16 v23, v70, v26
  v_dot2c_f32_bf16 v24, v70, v70
  v_dot2c_f32_bf16 v23, v71, v26
  v_dot2c_f32_bf16 v24, v71, v71
  s_waitcnt lgkmcnt(1)
  v_dot2c_f32_bf16 v23, v72, v26
  v_dot2c_f32_bf16 v24, v72, v72
  v_dot2c_f32_bf16 v23, v73, v26
  v_dot2c_f32_bf16 v24, v73, v73
  v_dot2c_f32_bf16 v23, v74, v26
  v_dot2c_f32_bf16 v24, v74, v74
  v_dot2c_f32_bf16 v23, v75, v26
  v_dot2c_f32_bf16 v24, v75, v75
  s_waitcnt lgkmcnt(0)
  v_dot2c_f32_bf16 v23, v76, v26
  v_dot2c_f32_bf16 v24, v76, v76
  v_dot2c_f32_bf16 v23, v77, v26
  v_dot2c_f32_bf16 v24, v77, v77
  v_dot2c_f32_bf16 v23, v78, v26
  v_dot2c_f32_bf16 v24, v78, v78
  v_dot2c_f32_bf16 v23, v79, v26
  v_dot2c_f32_bf16 v24, v79, v79
  v_add_u32 v109, 102400, v28
  ds_read_b64_tr_b16 v[88:89], v109 offset:0
  ds_read_b64_tr_b16 v[90:91], v109 offset:512
  ds_read_b64_tr_b16 v[92:93], v109 offset:2048
  ds_read_b64_tr_b16 v[94:95], v109 offset:2560
  ds_read_b64_tr_b16 v[96:97], v109 offset:4096
  ds_read_b64_tr_b16 v[98:99], v109 offset:4608
  ds_read_b64_tr_b16 v[100:101], v109 offset:6144
  ds_read_b64_tr_b16 v[102:103], v109 offset:6656
  s_waitcnt lgkmcnt(7)
  v_dot2c_f32_bf16 v25, v88, v26
  v_dot2c_f32_bf16 v25, v89, v26
  s_waitcnt lgkmcnt(6)
  v_dot2c_f32_bf16 v25, v90, v26
  v_dot2c_f32_bf16 v25, v91, v26
  s_waitcnt lgkmcnt(5)
  v_dot2c_f32_bf16 v25, v92, v26
  v_dot2c_f32_bf16 v25, v93, v26
  s_waitcnt lgkmcnt(4)
  v_dot2c_f32_bf16 v25, v94, v26
  v_dot2c_f32_bf16 v25, v95, v26
  s_waitcnt lgkmcnt(3)
  v_dot2c_f32_bf16 v25, v96, v26
  v_dot2c_f32_bf16 v25, v97, v26
  s_waitcnt lgkmcnt(2)
  v_dot2c_f32_bf16 v25, v98, v26
  v_dot2c_f32_bf16 v25, v99, v26
  s_waitcnt lgkmcnt(1)
  v_dot2c_f32_bf16 v25, v100, v26
  v_dot2c_f32_bf16 v25, v101, v26
  s_waitcnt lgkmcnt(0)
  v_dot2c_f32_bf16 v25, v102, v26
  v_dot2c_f32_bf16 v25, v103, v26
  ds_read_b64_tr_b16 v[88:89], v109 offset:8192
  ds_read_b64_tr_b16 v[90:91], v109 offset:8704
  ds_read_b64_tr_b16 v[92:93], v109 offset:10240
  ds_read_b64_tr_b16 v[94:95], v109 offset:10752
  ds_read_b64_tr_b16 v[96:97], v109 offset:12288
  ds_read_b64_tr_b16 v[98:99], v109 offset:12800
  ds_read_b64_tr_b16 v[100:101], v109 offset:14336
  ds_read_b64_tr_b16 v[102:103], v109 offset:14848
  s_waitcnt lgkmcnt(7)
  v_dot2c_f32_bf16 v25, v88, v26
  v_dot2c_f32_bf16 v25, v89, v26
  s_waitcnt lgkmcnt(6)
  v_dot2c_f32_bf16 v25, v90, v26
  v_dot2c_f32_bf16 v25, v91, v26
  s_waitcnt lgkmcnt(5)
  v_dot2c_f32_bf16 v25, v92, v26
  v_dot2c_f32_bf16 v25, v93, v26
  s_waitcnt lgkmcnt(4)
  v_dot2c_f32_bf16 v25, v94, v26
  v_dot2c_f32_bf16 v25, v95, v26
  s_waitcnt lgkmcnt(3)
  v_dot2c_f32_bf16 v25, v96, v26
  v_dot2c_f32_bf16 v25, v97, v26
  s_waitcnt lgkmcnt(2)
  v_dot2c_f32_bf16 v25, v98, v26
  v_dot2c_f32_bf16 v25, v99, v26
  s_waitcnt lgkmcnt(1)
  v_dot2c_f32_bf16 v25, v100, v26
  v_dot2c_f32_bf16 v25, v101, v26
  s_waitcnt lgkmcnt(0)
  v_dot2c_f32_bf16 v25, v102, v26
  v_dot2c_f32_bf16 v25, v103, v26
  s_waitcnt vmcnt(18)
  s_barrier
  s_add_u32 s60, s71, 589824
  s_add_u32 m0, s72, 102400
  s_nop 0
  buffer_load_dwordx4 v3, s[8:11], s60 offen offset:0 lds
  s_add_u32 s60, s71, 589824
  s_add_u32 m0, s72, 103424
  s_nop 0
  buffer_load_dwordx4 v4, s[8:11], s60 offen offset:0 lds
  s_add_u32 s60, s71, 589824
  s_add_u32 m0, s72, 104448
  s_nop 0
  buffer_load_dwordx4 v5, s[8:11], s60 offen offset:0 lds
  s_add_u32 s60, s71, 638976
  s_add_u32 m0, s72, 105472
  s_nop 0
  buffer_load_dwordx4 v3, s[8:11], s60 offen offset:0 lds
  s_add_u32 s60, s71, 638976
  s_add_u32 m0, s72, 106496
  s_nop 0
  buffer_load_dwordx4 v4, s[8:11], s60 offen offset:0 lds
  s_add_u32 s60, s71, 638976
  s_add_u32 m0, s72, 107520
  s_nop 0
  buffer_load_dwordx4 v5, s[8:11], s60 offen offset:0 lds
  v_add_u32 v108, 52224, v20
  v_xor_b32 v110, 0, v108
  v_xor_b32 v111, 16, v108
  v_xor_b32 v112, 32, v108
  v_xor_b32 v113, 48, v108
  v_xor_b32 v114, 64, v108
  v_xor_b32 v115, 80, v108
  v_xor_b32 v116, 96, v108
  v_xor_b32 v117, 112, v108
  ds_read_b128 v[48:51], v110 offset:0
  ds_read_b128 v[52:55], v111 offset:0
  ds_read_b128 v[56:59], v112 offset:0
  ds_read_b128 v[60:63], v113 offset:0
  ds_read_b128 v[64:67], v114 offset:0
  ds_read_b128 v[68:71], v115 offset:0
  ds_read_b128 v[72:75], v116 offset:0
  ds_read_b128 v[76:79], v117 offset:0
  s_waitcnt lgkmcnt(7)
  v_dot2c_f32_bf16 v23, v48, v26
  v_dot2c_f32_bf16 v24, v48, v48
  v_dot2c_f32_bf16 v23, v49, v26
  v_dot2c_f32_bf16 v24, v49, v49
  v_dot2c_f32_bf16 v23, v50, v26
  v_dot2c_f32_bf16 v24, v50, v50
  v_dot2c_f32_bf16 v23, v51, v26
  v_dot2c_f32_bf16 v24, v51, v51
  s_waitcnt lgkmcnt(6)
  v_dot2c_f32_bf16 v23, v52, v26
  v_dot2c_f32_bf16 v24, v52, v52
  v_dot2c_f32_bf16 v23, v53, v26
  v_dot2c_f32_bf16 v24, v53, v53
  v_dot2c_f32_bf16 v23, v54, v26
  v_dot2c_f32_bf16 v24, v54, v54
  v_dot2c_f32_bf16 v23, v55, v26
  v_dot2c_f32_bf16 v24, v55, v55
  s_waitcnt lgkmcnt(5)
  v_dot2c_f32_bf16 v23, v56, v26
  v_dot2c_f32_bf16 v24, v56, v56
  v_dot2c_f32_bf16 v23, v57, v26
  v_dot2c_f32_bf16 v24, v57, v57
  v_dot2c_f32_bf16 v23, v58, v26
  v_dot2c_f32_bf16 v24, v58, v58
  v_dot2c_f32_bf16 v23, v59, v26
  v_dot2c_f32_bf16 v24, v59, v59
  s_waitcnt lgkmcnt(4)
  v_dot2c_f32_bf16 v23, v60, v26
  v_dot2c_f32_bf16 v24, v60, v60
  v_dot2c_f32_bf16 v23, v61, v26
  v_dot2c_f32_bf16 v24, v61, v61
  v_dot2c_f32_bf16 v23, v62, v26
  v_dot2c_f32_bf16 v24, v62, v62
  v_dot2c_f32_bf16 v23, v63, v26
  v_dot2c_f32_bf16 v24, v63, v63
  s_waitcnt lgkmcnt(3)
  v_dot2c_f32_bf16 v23, v64, v26
  v_dot2c_f32_bf16 v24, v64, v64
  v_dot2c_f32_bf16 v23, v65, v26
  v_dot2c_f32_bf16 v24, v65, v65
  v_dot2c_f32_bf16 v23, v66, v26
  v_dot2c_f32_bf16 v24, v66, v66
  v_dot2c_f32_bf16 v23, v67, v26
  v_dot2c_f32_bf16 v24, v67, v67
  s_waitcnt lgkmcnt(2)
  v_dot2c_f32_bf16 v23, v68, v26
  v_dot2c_f32_bf16 v24, v68, v68
  v_dot2c_f32_bf16 v23, v69, v26
  v_dot2c_f32_bf16 v24, v69, v69
  v_dot2c_f32_bf16 v23, v70, v26
  v_dot2c_f32_bf16 v24, v70, v70
  v_dot2c_f32_bf16 v23, v71, v26
  v_dot2c_f32_bf16 v24, v71, v71
  s_waitcnt lgkmcnt(1)
  v_dot2c_f32_bf16 v23, v72, v26
  v_dot2c_f32_bf16 v24, v72, v72
  v_dot2c_f32_bf16 v23, v73, v26
  v_dot2c_f32_bf16 v24, v73, v73
  v_dot2c_f32_bf16 v23, v74, v26
  v_dot2c_f32_bf16 v24, v74, v74
  v_dot2c_f32_bf16 v23, v75, v26
  v_dot2c_f32_bf16 v24, v75, v75
  s_waitcnt lgkmcnt(0)
  v_dot2c_f32_bf16 v23, v76, v26
  v_dot2c_f32_bf16 v24, v76, v76
  v_dot2c_f32_bf16 v23, v77, v26
  v_dot2c_f32_bf16 v24, v77, v77
  v_dot2c_f32_bf16 v23, v78, v26
  v_dot2c_f32_bf16 v24, v78, v78
  v_dot2c_f32_bf16 v23, v79, v26
  v_dot2c_f32_bf16 v24, v79, v79
  v_add_u32 v109, 118784, v28
  ds_read_b64_tr_b16 v[88:89], v109 offset:0
  ds_read_b64_tr_b16 v[90:91], v109 offset:512
  ds_read_b64_tr_b16 v[92:93], v109 offset:2048
  ds_read_b64_tr_b16 v[94:95], v109 offset:2560
  ds_read_b64_tr_b16 v[96:97], v109 offset:4096
  ds_read_b64_tr_b16 v[98:99], v109 offset:4608
  ds_read_b64_tr_b16 v[100:101], v109 offset:6144
  ds_read_b64_tr_b16 v[102:103], v109 offset:6656
  s_waitcnt lgkmcnt(7)
  v_dot2c_f32_bf16 v25, v88, v26
  v_dot2c_f32_bf16 v25, v89, v26
  s_waitcnt lgkmcnt(6)
  v_dot2c_f32_bf16 v25, v90, v26
  v_dot2c_f32_bf16 v25, v91, v26
  s_waitcnt lgkmcnt(5)
  v_dot2c_f32_bf16 v25, v92, v26
  v_dot2c_f32_bf16 v25, v93, v26
  s_waitcnt lgkmcnt(4)
  v_dot2c_f32_bf16 v25, v94, v26
  v_dot2c_f32_bf16 v25, v95, v26
  s_waitcnt lgkmcnt(3)
  v_dot2c_f32_bf16 v25, v96, v26
  v_dot2c_f32_bf16 v25, v97, v26
  s_waitcnt lgkmcnt(2)
  v_dot2c_f32_bf16 v25, v98, v26
  v_dot2c_f32_bf16 v25, v99, v26
  s_waitcnt lgkmcnt(1)
  v_dot2c_f32_bf16 v25, v100, v26
  v_dot2c_f32_bf16 v25, v101, v26
  s_waitcnt lgkmcnt(0)
  v_dot2c_f32_bf16 v25, v102, v26
  v_dot2c_f32_bf16 v25, v103, v26
  ds_read_b64_tr_b16 v[88:89], v109 offset:8192
  ds_read_b64_tr_b16 v[90:91], v109 offset:8704
  ds_read_b64_tr_b16 v[92:93], v109 offset:10240
  ds_read_b64_tr_b16 v[94:95], v109 offset:10752
  ds_read_b64_tr_b16 v[96:97], v109 offset:12288
  ds_read_b64_tr_b16 v[98:99], v109 offset:12800
  ds_read_b64_tr_b16 v[100:101], v109 offset:14336
  ds_read_b64_tr_b16 v[102:103], v109 offset:14848
  s_waitcnt lgkmcnt(7)
  v_dot2c_f32_bf16 v25, v88, v26
  v_dot2c_f32_bf16 v25, v89, v26
  s_waitcnt lgkmcnt(6)
  v_dot2c_f32_bf16 v25, v90, v26
  v_dot2c_f32_bf16 v25, v91, v26
  s_waitcnt lgkmcnt(5)
  v_dot2c_f32_bf16 v25, v92, v26
  v_dot2c_f32_bf16 v25, v93, v26
  s_waitcnt lgkmcnt(4)
  v_dot2c_f32_bf16 v25, v94, v26
  v_dot2c_f32_bf16 v25, v95, v26
  s_waitcnt lgkmcnt(3)
  v_dot2c_f32_bf16 v25, v96, v26
  v_dot2c_f32_bf16 v25, v97, v26
  s_waitcnt lgkmcnt(2)
  v_dot2c_f32_bf16 v25, v98, v26
  v_dot2c_f32_bf16 v25, v99, v26
  s_waitcnt lgkmcnt(1)
  v_dot2c_f32_bf16 v25, v100, v26
  v_dot2c_f32_bf16 v25, v101, v26
  s_waitcnt lgkmcnt(0)
  v_dot2c_f32_bf16 v25, v102, v26
  v_dot2c_f32_bf16 v25, v103, v26
  v_mov_b32 v48, v23
  s_nop 1
  v_permlane32_swap_b32 v23, v48
  v_add_f32 v23, v23, v48
  v_mov_b32 v49, v24
  s_nop 1
  v_permlane32_swap_b32 v24, v49
  v_add_f32 v24, v24, v49
  v_mul_f32 v23, 0x3b000000, v23
  v_mul_f32 v24, 0x3b000000, v24
  v_fma_f32 v48, -v23, v23, v24
  v_max_f32 v48, 0, v48
  v_add_f32 v49, 0x3727c5ac, v48
  v_rsq_f32 v50, v49
  s_nop 0
  v_mul_f32 v51, v23, v50
  ds_write_b32 v31, v50 offset:0
  ds_write_b32 v31, v51 offset:512
  v_mul_f32 v52, v50, v50
  v_mul_f32 v52, v52, v48
  v_add_f32 v52, 0x3727c5ac, v52
  v_rsq_f32 v53, v52
  s_nop 0
  v_mul_f32 v53, v53, v50
  v_mul_f32 v54, v23, v53
  ds_write_b32 v31, v53 offset:1024
  ds_write_b32 v31, v54 offset:1536
  v_mov_b32 v56, v25
  s_nop 1
  v_permlane32_swap_b32 v25, v56
  v_add_f32 v25, v25, v56
  ds_write_b32 v33, v25
  s_waitcnt lgkmcnt(0)
  s_waitcnt vmcnt(18)
  s_barrier
  s_add_u32 s60, s71, 786432
  s_add_u32 m0, s72, 118784
  s_nop 0
  buffer_load_dwordx4 v3, s[8:11], s60 offen offset:0 lds
  s_add_u32 s60, s71, 786432
  s_add_u32 m0, s72, 119808
  s_nop 0
  buffer_load_dwordx4 v4, s[8:11], s60 offen offset:0 lds
  s_add_u32 s60, s71, 786432
  s_add_u32 m0, s72, 120832
  s_nop 0
  buffer_load_dwordx4 v5, s[8:11], s60 offen offset:0 lds
  s_add_u32 s60, s71, 835584
  s_add_u32 m0, s72, 121856
  s_nop 0
  buffer_load_dwordx4 v3, s[8:11], s60 offen offset:0 lds
  s_add_u32 s60, s71, 835584
  s_add_u32 m0, s72, 122880
  s_nop 0
  buffer_load_dwordx4 v4, s[8:11], s60 offen offset:0 lds
  s_add_u32 s60, s71, 835584
  s_add_u32 m0, s72, 123904
  s_nop 0
  buffer_load_dwordx4 v5, s[8:11], s60 offen offset:0 lds
  v_mov_b32 v23, 0
  v_mov_b32 v24, 0
  v_mov_b32 v25, 0
  v_add_u32 v108, 0, v21
  v_xor_b32 v110, 0, v108
  v_xor_b32 v111, 16, v108
  v_xor_b32 v112, 32, v108
  v_xor_b32 v113, 48, v108
  ds_read_b128 v[48:51], v110 offset:0
  ds_read_b128 v[52:55], v111 offset:0
  ds_read_b128 v[56:59], v112 offset:0
  ds_read_b128 v[60:63], v113 offset:0
  s_waitcnt lgkmcnt(3)
  v_dot2c_f32_bf16 v23, v48, v26
  v_dot2c_f32_bf16 v24, v48, v48
  v_dot2c_f32_bf16 v23, v49, v26
  v_dot2c_f32_bf16 v24, v49, v49
  v_dot2c_f32_bf16 v23, v50, v26
  v_dot2c_f32_bf16 v24, v50, v50
  v_dot2c_f32_bf16 v23, v51, v26
  v_dot2c_f32_bf16 v24, v51, v51
  s_waitcnt lgkmcnt(2)
  v_dot2c_f32_bf16 v23, v52, v26
  v_dot2c_f32_bf16 v24, v52, v52
  v_dot2c_f32_bf16 v23, v53, v26
  v_dot2c_f32_bf16 v24, v53, v53
  v_dot2c_f32_bf16 v23, v54, v26
  v_dot2c_f32_bf16 v24, v54, v54
  v_dot2c_f32_bf16 v23, v55, v26
  v_dot2c_f32_bf16 v24, v55, v55
  s_waitcnt lgkmcnt(1)
  v_dot2c_f32_bf16 v23, v56, v26
  v_dot2c_f32_bf16 v24, v56, v56
  v_dot2c_f32_bf16 v23, v57, v26
  v_dot2c_f32_bf16 v24, v57, v57
  v_dot2c_f32_bf16 v23, v58, v26
  v_dot2c_f32_bf16 v24, v58, v58
  v_dot2c_f32_bf16 v23, v59, v26
  v_dot2c_f32_bf16 v24, v59, v59
  s_waitcnt lgkmcnt(0)
  v_dot2c_f32_bf16 v23, v60, v26
  v_dot2c_f32_bf16 v24, v60, v60
  v_dot2c_f32_bf16 v23, v61, v26
  v_dot2c_f32_bf16 v24, v61, v61
  v_dot2c_f32_bf16 v23, v62, v26
  v_dot2c_f32_bf16 v24, v62, v62
  v_dot2c_f32_bf16 v23, v63, v26
  v_dot2c_f32_bf16 v24, v63, v63
  v_add_u32 v109, 135168, v29
  ds_read_b64_tr_b16 v[88:89], v109 offset:0
  ds_read_b64_tr_b16 v[90:91], v109 offset:768
  ds_read_b64_tr_b16 v[92:93], v109 offset:3072
  ds_read_b64_tr_b16 v[94:95], v109 offset:3840
  ds_read_b64_tr_b16 v[96:97], v109 offset:6144
  ds_read_b64_tr_b16 v[98:99], v109 offset:6912
  ds_read_b64_tr_b16 v[100:101], v109 offset:9216
  ds_read_b64_tr_b16 v[102:103], v109 offset:9984
  s_waitcnt lgkmcnt(7)
  v_dot2c_f32_bf16 v25, v88, v26
  v_dot2c_f32_bf16 v25, v89, v26
  s_waitcnt lgkmcnt(6)
  v_dot2c_f32_bf16 v25, v90, v26
  v_dot2c_f32_bf16 v25, v91, v26
  s_waitcnt lgkmcnt(5)
  v_dot2c_f32_bf16 v25, v92, v26
  v_dot2c_f32_bf16 v25, v93, v26
  s_waitcnt lgkmcnt(4)
  v_dot2c_f32_bf16 v25, v94, v26
  v_dot2c_f32_bf16 v25, v95, v26
  s_waitcnt lgkmcnt(3)
  v_dot2c_f32_bf16 v25, v96, v26
  v_dot2c_f32_bf16 v25, v97, v26
  s_waitcnt lgkmcnt(2)
  v_dot2c_f32_bf16 v25, v98, v26
  v_dot2c_f32_bf16 v25, v99, v26
  s_waitcnt lgkmcnt(1)
  v_dot2c_f32_bf16 v25, v100, v26
  v_dot2c_f32_bf16 v25, v101, v26
  s_waitcnt lgkmcnt(0)
  v_dot2c_f32_bf16 v25, v102, v26
  v_dot2c_f32_bf16 v25, v103, v26
  s_waitcnt vmcnt(18)
  s_barrier
  s_add_u32 s60, s71, 983040
  s_add_u32 m0, s72, 135168
  s_nop 0
  buffer_load_dwordx4 v3, s[8:11], s60 offen offset:0 lds
  s_add_u32 s60, s71, 983040
  s_add_u32 m0, s72, 136192
  s_nop 0
  buffer_load_dwordx4 v4, s[8:11], s60 offen offset:0 lds
  s_add_u32 s60, s71, 983040
  s_add_u32 m0, s72, 137216
  s_nop 0
  buffer_load_dwordx4 v5, s[8:11], s60 offen offset:0 lds
  s_add_u32 s60, s71, 1032192
  s_add_u32 m0, s72, 138240
  s_nop 0
  buffer_load_dwordx4 v3, s[8:11], s60 offen offset:0 lds
  s_add_u32 s60, s71, 1032192
  s_add_u32 m0, s72, 139264
  s_nop 0
  buffer_load_dwordx4 v4, s[8:11], s60 offen offset:0 lds
  s_add_u32 s60, s71, 1032192
  s_add_u32 m0, s72, 140288
  s_nop 0
  buffer_load_dwordx4 v5, s[8:11], s60 offen offset:0 lds
  v_add_u32 v108, 17408, v21
  v_xor_b32 v110, 0, v108
  v_xor_b32 v111, 16, v108
  v_xor_b32 v112, 32, v108
  v_xor_b32 v113, 48, v108
  ds_read_b128 v[48:51], v110 offset:0
  ds_read_b128 v[52:55], v111 offset:0
  ds_read_b128 v[56:59], v112 offset:0
  ds_read_b128 v[60:63], v113 offset:0
  s_waitcnt lgkmcnt(3)
  v_dot2c_f32_bf16 v23, v48, v26
  v_dot2c_f32_bf16 v24, v48, v48
  v_dot2c_f32_bf16 v23, v49, v26
  v_dot2c_f32_bf16 v24, v49, v49
  v_dot2c_f32_bf16 v23, v50, v26
  v_dot2c_f32_bf16 v24, v50, v50
  v_dot2c_f32_bf16 v23, v51, v26
  v_dot2c_f32_bf16 v24, v51, v51
  s_waitcnt lgkmcnt(2)
  v_dot2c_f32_bf16 v23, v52, v26
  v_dot2c_f32_bf16 v24, v52, v52
  v_dot2c_f32_bf16 v23, v53, v26
  v_dot2c_f32_bf16 v24, v53, v53
  v_dot2c_f32_bf16 v23, v54, v26
  v_dot2c_f32_bf16 v24, v54, v54
  v_dot2c_f32_bf16 v23, v55, v26
  v_dot2c_f32_bf16 v24, v55, v55
  s_waitcnt lgkmcnt(1)
  v_dot2c_f32_bf16 v23, v56, v26
  v_dot2c_f32_bf16 v24, v56, v56
  v_dot2c_f32_bf16 v23, v57, v26
  v_dot2c_f32_bf16 v24, v57, v57
  v_dot2c_f32_bf16 v23, v58, v26
  v_dot2c_f32_bf16 v24, v58, v58
  v_dot2c_f32_bf16 v23, v59, v26
  v_dot2c_f32_bf16 v24, v59, v59
  s_waitcnt lgkmcnt(0)
  v_dot2c_f32_bf16 v23, v60, v26
  v_dot2c_f32_bf16 v24, v60, v60
  v_dot2c_f32_bf16 v23, v61, v26
  v_dot2c_f32_bf16 v24, v61, v61
  v_dot2c_f32_bf16 v23, v62, v26
  v_dot2c_f32_bf16 v24, v62, v62
  v_dot2c_f32_bf16 v23, v63, v26
  v_dot2c_f32_bf16 v24, v63, v63
  v_add_u32 v109, 69632, v29
  ds_read_b64_tr_b16 v[88:89], v109 offset:0
  ds_read_b64_tr_b16 v[90:91], v109 offset:768
  ds_read_b64_tr_b16 v[92:93], v109 offset:3072
  ds_read_b64_tr_b16 v[94:95], v109 offset:3840
  ds_read_b64_tr_b16 v[96:97], v109 offset:6144
  ds_read_b64_tr_b16 v[98:99], v109 offset:6912
  ds_read_b64_tr_b16 v[100:101], v109 offset:9216
  ds_read_b64_tr_b16 v[102:103], v109 offset:9984
  s_waitcnt lgkmcnt(7)
  v_dot2c_f32_bf16 v25, v88, v26
  v_dot2c_f32_bf16 v25, v89, v26
  s_waitcnt lgkmcnt(6)
  v_dot2c_f32_bf16 v25, v90, v26
  v_dot2c_f32_bf16 v25, v91, v26
  s_waitcnt lgkmcnt(5)
  v_dot2c_f32_bf16 v25, v92, v26
  v_dot2c_f32_bf16 v25, v93, v26
  s_waitcnt lgkmcnt(4)
  v_dot2c_f32_bf16 v25, v94, v26
  v_dot2c_f32_bf16 v25, v95, v26
  s_waitcnt lgkmcnt(3)
  v_dot2c_f32_bf16 v25, v96, v26
  v_dot2c_f32_bf16 v25, v97, v26
  s_waitcnt lgkmcnt(2)
  v_dot2c_f32_bf16 v25, v98, v26
  v_dot2c_f32_bf16 v25, v99, v26
  s_waitcnt lgkmcnt(1)
  v_dot2c_f32_bf16 v25, v100, v26
  v_dot2c_f32_bf16 v25, v101, v26
  s_waitcnt lgkmcnt(0)
  v_dot2c_f32_bf16 v25, v102, v26
  v_dot2c_f32_bf16 v25, v103, v26
  s_waitcnt vmcnt(18)
  s_barrier
  v_mov_b32 v48, 162304
  ds_read_b32 v27, v48
  s_waitcnt lgkmcnt(0)
  v_readfirstlane_b32 s56, v27
  s_add_u32 s60, s71, 1179648
  s_add_u32 m0, s72, 69632
  s_nop 0
  buffer_load_dwordx4 v3, s[8:11], s60 offen offset:0 lds
  s_add_u32 s60, s71, 1179648
  s_add_u32 m0, s72, 70656
  s_nop 0
  buffer_load_dwordx4 v4, s[8:11], s60 offen offset:0 lds
  s_add_u32 s60, s71, 1179648
  s_add_u32 m0, s72, 71680
  s_nop 0
  buffer_load_dwordx4 v5, s[8:11], s60 offen offset:0 lds
  s_add_u32 s60, s71, 1228800
  s_add_u32 m0, s72, 72704
  s_nop 0
  buffer_load_dwordx4 v3, s[8:11], s60 offen offset:0 lds
  s_add_u32 s60, s71, 1228800
  s_add_u32 m0, s72, 73728
  s_nop 0
  buffer_load_dwordx4 v4, s[8:11], s60 offen offset:0 lds
  s_add_u32 s60, s71, 1228800
  s_add_u32 m0, s72, 74752
  s_nop 0
  buffer_load_dwordx4 v5, s[8:11], s60 offen offset:0 lds
  v_add_u32 v108, 34816, v21
  v_xor_b32 v110, 0, v108
  v_xor_b32 v111, 16, v108
  v_xor_b32 v112, 32, v108
  v_xor_b32 v113, 48, v108
  ds_read_b128 v[48:51], v110 offset:0
  ds_read_b128 v[52:55], v111 offset:0
  ds_read_b128 v[56:59], v112 offset:0
  ds_read_b128 v[60:63], v113 offset:0
  s_waitcnt lgkmcnt(3)
  v_dot2c_f32_bf16 v23, v48, v26
  v_dot2c_f32_bf16 v24, v48, v48
  v_dot2c_f32_bf16 v23, v49, v26
  v_dot2c_f32_bf16 v24, v49, v49
  v_dot2c_f32_bf16 v23, v50, v26
  v_dot2c_f32_bf16 v24, v50, v50
  v_dot2c_f32_bf16 v23, v51, v26
  v_dot2c_f32_bf16 v24, v51, v51
  s_waitcnt lgkmcnt(2)
  v_dot2c_f32_bf16 v23, v52, v26
  v_dot2c_f32_bf16 v24, v52, v52
  v_dot2c_f32_bf16 v23, v53, v26
  v_dot2c_f32_bf16 v24, v53, v53
  v_dot2c_f32_bf16 v23, v54, v26
  v_dot2c_f32_bf16 v24, v54, v54
  v_dot2c_f32_bf16 v23, v55, v26
  v_dot2c_f32_bf16 v24, v55, v55
  s_waitcnt lgkmcnt(1)
  v_dot2c_f32_bf16 v23, v56, v26
  v_dot2c_f32_bf16 v24, v56, v56
  v_dot2c_f32_bf16 v23, v57, v26
  v_dot2c_f32_bf16 v24, v57, v57
  v_dot2c_f32_bf16 v23, v58, v26
  v_dot2c_f32_bf16 v24, v58, v58
  v_dot2c_f32_bf16 v23, v59, v26
  v_dot2c_f32_bf16 v24, v59, v59
  s_waitcnt lgkmcnt(0)
  v_dot2c_f32_bf16 v23, v60, v26
  v_dot2c_f32_bf16 v24, v60, v60
  v_dot2c_f32_bf16 v23, v61, v26
  v_dot2c_f32_bf16 v24, v61, v61
  v_dot2c_f32_bf16 v23, v62, v26
  v_dot2c_f32_bf16 v24, v62, v62
  v_dot2c_f32_bf16 v23, v63, v26
  v_dot2c_f32_bf16 v24, v63, v63
  v_add_u32 v109, 86016, v29
  ds_read_b64_tr_b16 v[88:89], v109 offset:0
  ds_read_b64_tr_b16 v[90:91], v109 offset:768
  ds_read_b64_tr_b16 v[92:93], v109 offset:3072
  ds_read_b64_tr_b16 v[94:95], v109 offset:3840
  ds_read_b64_tr_b16 v[96:97], v109 offset:6144
  ds_read_b64_tr_b16 v[98:99], v109 offset:6912
  ds_read_b64_tr_b16 v[100:101], v109 offset:9216
  ds_read_b64_tr_b16 v[102:103], v109 offset:9984
  s_waitcnt lgkmcnt(7)
  v_dot2c_f32_bf16 v25, v88, v26
  v_dot2c_f32_bf16 v25, v89, v26
  s_waitcnt lgkmcnt(6)
  v_dot2c_f32_bf16 v25, v90, v26
  v_dot2c_f32_bf16 v25, v91, v26
  s_waitcnt lgkmcnt(5)
  v_dot2c_f32_bf16 v25, v92, v26
  v_dot2c_f32_bf16 v25, v93, v26
  s_waitcnt lgkmcnt(4)
  v_dot2c_f32_bf16 v25, v94, v26
  v_dot2c_f32_bf16 v25, v95, v26
  s_waitcnt lgkmcnt(3)
  v_dot2c_f32_bf16 v25, v96, v26
  v_dot2c_f32_bf16 v25, v97, v26
  s_waitcnt lgkmcnt(2)
  v_dot2c_f32_bf16 v25, v98, v26
  v_dot2c_f32_bf16 v25, v99, v26
  s_waitcnt lgkmcnt(1)
  v_dot2c_f32_bf16 v25, v100, v26
  v_dot2c_f32_bf16 v25, v101, v26
  s_waitcnt lgkmcnt(0)
  v_dot2c_f32_bf16 v25, v102, v26
  v_dot2c_f32_bf16 v25, v103, v26
  s_waitcnt vmcnt(18)
  s_barrier
  s_add_u32 s60, s71, 1376256
  s_add_u32 m0, s72, 86016
  s_nop 0
  buffer_load_dwordx4 v3, s[8:11], s60 offen offset:0 lds
  s_add_u32 s60, s71, 1376256
  s_add_u32 m0, s72, 87040
  s_nop 0
  buffer_load_dwordx4 v4, s[8:11], s60 offen offset:0 lds
  s_add_u32 s60, s71, 1376256
  s_add_u32 m0, s72, 88064
  s_nop 0
  buffer_load_dwordx4 v5, s[8:11], s60 offen offset:0 lds
  s_add_u32 s60, s71, 1425408
  s_add_u32 m0, s72, 89088
  s_nop 0
  buffer_load_dwordx4 v3, s[8:11], s60 offen offset:0 lds
  s_add_u32 s60, s71, 1425408
  s_add_u32 m0, s72, 90112
  s_nop 0
  buffer_load_dwordx4 v4, s[8:11], s60 offen offset:0 lds
  s_add_u32 s60, s71, 1425408
  s_add_u32 m0, s72, 91136
  s_nop 0
  buffer_load_dwordx4 v5, s[8:11], s60 offen offset:0 lds
  v_add_u32 v108, 52224, v21
  v_xor_b32 v110, 0, v108
  v_xor_b32 v111, 16, v108
  v_xor_b32 v112, 32, v108
  v_xor_b32 v113, 48, v108
  ds_read_b128 v[48:51], v110 offset:0
  ds_read_b128 v[52:55], v111 offset:0
  ds_read_b128 v[56:59], v112 offset:0
  ds_read_b128 v[60:63], v113 offset:0
  s_waitcnt lgkmcnt(3)
  v_dot2c_f32_bf16 v23, v48, v26
  v_dot2c_f32_bf16 v24, v48, v48
  v_dot2c_f32_bf16 v23, v49, v26
  v_dot2c_f32_bf16 v24, v49, v49
  v_dot2c_f32_bf16 v23, v50, v26
  v_dot2c_f32_bf16 v24, v50, v50
  v_dot2c_f32_bf16 v23, v51, v26
  v_dot2c_f32_bf16 v24, v51, v51
  s_waitcnt lgkmcnt(2)
  v_dot2c_f32_bf16 v23, v52, v26
  v_dot2c_f32_bf16 v24, v52, v52
  v_dot2c_f32_bf16 v23, v53, v26
  v_dot2c_f32_bf16 v24, v53, v53
  v_dot2c_f32_bf16 v23, v54, v26
  v_dot2c_f32_bf16 v24, v54, v54
  v_dot2c_f32_bf16 v23, v55, v26
  v_dot2c_f32_bf16 v24, v55, v55
  s_waitcnt lgkmcnt(1)
  v_dot2c_f32_bf16 v23, v56, v26
  v_dot2c_f32_bf16 v24, v56, v56
  v_dot2c_f32_bf16 v23, v57, v26
  v_dot2c_f32_bf16 v24, v57, v57
  v_dot2c_f32_bf16 v23, v58, v26
  v_dot2c_f32_bf16 v24, v58, v58
  v_dot2c_f32_bf16 v23, v59, v26
  v_dot2c_f32_bf16 v24, v59, v59
  s_waitcnt lgkmcnt(0)
  v_dot2c_f32_bf16 v23, v60, v26
  v_dot2c_f32_bf16 v24, v60, v60
  v_dot2c_f32_bf16 v23, v61, v26
  v_dot2c_f32_bf16 v24, v61, v61
  v_dot2c_f32_bf16 v23, v62, v26
  v_dot2c_f32_bf16 v24, v62, v62
  v_dot2c_f32_bf16 v23, v63, v26
  v_dot2c_f32_bf16 v24, v63, v63
  v_add_u32 v109, 102400, v29
  ds_read_b64_tr_b16 v[88:89], v109 offset:0
  ds_read_b64_tr_b16 v[90:91], v109 offset:768
  ds_read_b64_tr_b16 v[92:93], v109 offset:3072
  ds_read_b64_tr_b16 v[94:95], v109 offset:3840
  ds_read_b64_tr_b16 v[96:97], v109 offset:6144
  ds_read_b64_tr_b16 v[98:99], v109 offset:6912
  ds_read_b64_tr_b16 v[100:101], v109 offset:9216
  ds_read_b64_tr_b16 v[102:103], v109 offset:9984
  s_waitcnt lgkmcnt(7)
  v_dot2c_f32_bf16 v25, v88, v26
  v_dot2c_f32_bf16 v25, v89, v26
  s_waitcnt lgkmcnt(6)
  v_dot2c_f32_bf16 v25, v90, v26
  v_dot2c_f32_bf16 v25, v91, v26
  s_waitcnt lgkmcnt(5)
  v_dot2c_f32_bf16 v25, v92, v26
  v_dot2c_f32_bf16 v25, v93, v26
  s_waitcnt lgkmcnt(4)
  v_dot2c_f32_bf16 v25, v94, v26
  v_dot2c_f32_bf16 v25, v95, v26
  s_waitcnt lgkmcnt(3)
  v_dot2c_f32_bf16 v25, v96, v26
  v_dot2c_f32_bf16 v25, v97, v26
  s_waitcnt lgkmcnt(2)
  v_dot2c_f32_bf16 v25, v98, v26
  v_dot2c_f32_bf16 v25, v99, v26
  s_waitcnt lgkmcnt(1)
  v_dot2c_f32_bf16 v25, v100, v26
  v_dot2c_f32_bf16 v25, v101, v26
  s_waitcnt lgkmcnt(0)
  v_dot2c_f32_bf16 v25, v102, v26
  v_dot2c_f32_bf16 v25, v103, v26
  s_waitcnt vmcnt(18)
  s_barrier
  s_add_u32 s60, s70, 0
  s_add_u32 m0, s69, 102400
  s_nop 0
  buffer_load_dwordx4 v2, s[20:23], s60 offen offset:0 lds
  s_add_u32 s60, s70, 8192
  s_add_u32 m0, s69, 103424
  s_nop 0
  buffer_load_dwordx4 v2, s[20:23], s60 offen offset:0 lds
  s_add_u32 s60, s70, 16384
  s_add_u32 m0, s69, 104448
  s_nop 0
  buffer_load_dwordx4 v2, s[20:23], s60 offen offset:0 lds
  s_add_u32 s60, s70, 24576
  s_add_u32 m0, s69, 105472
  s_nop 0
  buffer_load_dwordx4 v2, s[20:23], s60 offen offset:0 lds
  s_add_u32 s60, s70, 32768
  s_add_u32 m0, s69, 106496
  s_nop 0
  buffer_load_dwordx4 v2, s[20:23], s60 offen offset:0 lds
  s_add_u32 s60, s70, 40960
  s_add_u32 m0, s69, 107520
  s_nop 0
  buffer_load_dwordx4 v2, s[20:23], s60 offen offset:0 lds
  s_add_u32 s60, s70, 49152
  s_add_u32 m0, s69, 108544
  s_nop 0
  buffer_load_dwordx4 v2, s[20:23], s60 offen offset:0 lds
  s_add_u32 s60, s70, 57344
  s_add_u32 m0, s69, 109568
  s_nop 0
  buffer_load_dwordx4 v2, s[20:23], s60 offen offset:0 lds
  v_add_u32 v108, 0, v21
  v_xor_b32 v110, 0, v108
  v_xor_b32 v111, 16, v108
  v_xor_b32 v112, 32, v108
  v_xor_b32 v113, 48, v108
  ds_read_b128 v[48:51], v110 offset:0
  ds_read_b128 v[52:55], v111 offset:0
  ds_read_b128 v[56:59], v112 offset:0
  ds_read_b128 v[60:63], v113 offset:0
  s_waitcnt lgkmcnt(3)
  v_dot2c_f32_bf16 v23, v48, v26
  v_dot2c_f32_bf16 v24, v48, v48
  v_dot2c_f32_bf16 v23, v49, v26
  v_dot2c_f32_bf16 v24, v49, v49
  v_dot2c_f32_bf16 v23, v50, v26
  v_dot2c_f32_bf16 v24, v50, v50
  v_dot2c_f32_bf16 v23, v51, v26
  v_dot2c_f32_bf16 v24, v51, v51
  s_waitcnt lgkmcnt(2)
  v_dot2c_f32_bf16 v23, v52, v26
  v_dot2c_f32_bf16 v24, v52, v52
  v_dot2c_f32_bf16 v23, v53, v26
  v_dot2c_f32_bf16 v24, v53, v53
  v_dot2c_f32_bf16 v23, v54, v26
  v_dot2c_f32_bf16 v24, v54, v54
  v_dot2c_f32_bf16 v23, v55, v26
  v_dot2c_f32_bf16 v24, v55, v55
  s_waitcnt lgkmcnt(1)
  v_dot2c_f32_bf16 v23, v56, v26
  v_dot2c_f32_bf16 v24, v56, v56
  v_dot2c_f32_bf16 v23, v57, v26
  v_dot2c_f32_bf16 v24, v57, v57
  v_dot2c_f32_bf16 v23, v58, v26
  v_dot2c_f32_bf16 v24, v58, v58
  v_dot2c_f32_bf16 v23, v59, v26
  v_dot2c_f32_bf16 v24, v59, v59
  s_waitcnt lgkmcnt(0)
  v_dot2c_f32_bf16 v23, v60, v26
  v_dot2c_f32_bf16 v24, v60, v60
  v_dot2c_f32_bf16 v23, v61, v26
  v_dot2c_f32_bf16 v24, v61, v61
  v_dot2c_f32_bf16 v23, v62, v26
  v_dot2c_f32_bf16 v24, v62, v62
  v_dot2c_f32_bf16 v23, v63, v26
  v_dot2c_f32_bf16 v24, v63, v63
  v_add_u32 v109, 118784, v29
  ds_read_b64_tr_b16 v[88:89], v109 offset:0
  ds_read_b64_tr_b16 v[90:91], v109 offset:768
  ds_read_b64_tr_b16 v[92:93], v109 offset:3072
  ds_read_b64_tr_b16 v[94:95], v109 offset:3840
  ds_read_b64_tr_b16 v[96:97], v109 offset:6144
  ds_read_b64_tr_b16 v[98:99], v109 offset:6912
  ds_read_b64_tr_b16 v[100:101], v109 offset:9216
  ds_read_b64_tr_b16 v[102:103], v109 offset:9984
  s_waitcnt lgkmcnt(7)
  v_dot2c_f32_bf16 v25, v88, v26
  v_dot2c_f32_bf16 v25, v89, v26
  s_waitcnt lgkmcnt(6)
  v_dot2c_f32_bf16 v25, v90, v26
  v_dot2c_f32_bf16 v25, v91, v26
  s_waitcnt lgkmcnt(5)
  v_dot2c_f32_bf16 v25, v92, v26
  v_dot2c_f32_bf16 v25, v93, v26
  s_waitcnt lgkmcnt(4)
  v_dot2c_f32_bf16 v25, v94, v26
  v_dot2c_f32_bf16 v25, v95, v26
  s_waitcnt lgkmcnt(3)
  v_dot2c_f32_bf16 v25, v96, v26
  v_dot2c_f32_bf16 v25, v97, v26
  s_waitcnt lgkmcnt(2)
  v_dot2c_f32_bf16 v25, v98, v26
  v_dot2c_f32_bf16 v25, v99, v26
  s_waitcnt lgkmcnt(1)
  v_dot2c_f32_bf16 v25, v100, v26
  v_dot2c_f32_bf16 v25, v101, v26
  s_waitcnt lgkmcnt(0)
  v_dot2c_f32_bf16 v25, v102, v26
  v_dot2c_f32_bf16 v25, v103, v26
  s_waitcnt vmcnt(20)
  s_barrier
  s_add_u32 s60, s70, 131072
  s_add_u32 m0, s69, 118784
  s_nop 0
  buffer_load_dwordx4 v2, s[20:23], s60 offen offset:0 lds
  s_add_u32 s60, s70, 139264
  s_add_u32 m0, s69, 119808
  s_nop 0
  buffer_load_dwordx4 v2, s[20:23], s60 offen offset:0 lds
  s_add_u32 s60, s70, 147456
  s_add_u32 m0, s69, 120832
  s_nop 0
  buffer_load_dwordx4 v2, s[20:23], s60 offen offset:0 lds
  s_add_u32 s60, s70, 155648
  s_add_u32 m0, s69, 121856
  s_nop 0
  buffer_load_dwordx4 v2, s[20:23], s60 offen offset:0 lds
  s_add_u32 s60, s70, 163840
  s_add_u32 m0, s69, 122880
  s_nop 0
  buffer_load_dwordx4 v2, s[20:23], s60 offen offset:0 lds
  s_add_u32 s60, s70, 172032
  s_add_u32 m0, s69, 123904
  s_nop 0
  buffer_load_dwordx4 v2, s[20:23], s60 offen offset:0 lds
  s_add_u32 s60, s70, 180224
  s_add_u32 m0, s69, 124928
  s_nop 0
  buffer_load_dwordx4 v2, s[20:23], s60 offen offset:0 lds
  s_add_u32 s60, s70, 188416
  s_add_u32 m0, s69, 125952
  s_nop 0
  buffer_load_dwordx4 v2, s[20:23], s60 offen offset:0 lds
  v_add_u32 v108, 17408, v21
  v_xor_b32 v110, 0, v108
  v_xor_b32 v111, 16, v108
  v_xor_b32 v112, 32, v108
  v_xor_b32 v113, 48, v108
  ds_read_b128 v[48:51], v110 offset:0
  ds_read_b128 v[52:55], v111 offset:0
  ds_read_b128 v[56:59], v112 offset:0
  ds_read_b128 v[60:63], v113 offset:0
  s_waitcnt lgkmcnt(3)
  v_dot2c_f32_bf16 v23, v48, v26
  v_dot2c_f32_bf16 v24, v48, v48
  v_dot2c_f32_bf16 v23, v49, v26
  v_dot2c_f32_bf16 v24, v49, v49
  v_dot2c_f32_bf16 v23, v50, v26
  v_dot2c_f32_bf16 v24, v50, v50
  v_dot2c_f32_bf16 v23, v51, v26
  v_dot2c_f32_bf16 v24, v51, v51
  s_waitcnt lgkmcnt(2)
  v_dot2c_f32_bf16 v23, v52, v26
  v_dot2c_f32_bf16 v24, v52, v52
  v_dot2c_f32_bf16 v23, v53, v26
  v_dot2c_f32_bf16 v24, v53, v53
  v_dot2c_f32_bf16 v23, v54, v26
  v_dot2c_f32_bf16 v24, v54, v54
  v_dot2c_f32_bf16 v23, v55, v26
  v_dot2c_f32_bf16 v24, v55, v55
  s_waitcnt lgkmcnt(1)
  v_dot2c_f32_bf16 v23, v56, v26
  v_dot2c_f32_bf16 v24, v56, v56
  v_dot2c_f32_bf16 v23, v57, v26
  v_dot2c_f32_bf16 v24, v57, v57
  v_dot2c_f32_bf16 v23, v58, v26
  v_dot2c_f32_bf16 v24, v58, v58
  v_dot2c_f32_bf16 v23, v59, v26
  v_dot2c_f32_bf16 v24, v59, v59
  s_waitcnt lgkmcnt(0)
  v_dot2c_f32_bf16 v23, v60, v26
  v_dot2c_f32_bf16 v24, v60, v60
  v_dot2c_f32_bf16 v23, v61, v26
  v_dot2c_f32_bf16 v24, v61, v61
  v_dot2c_f32_bf16 v23, v62, v26
  v_dot2c_f32_bf16 v24, v62, v62
  v_dot2c_f32_bf16 v23, v63, v26
  v_dot2c_f32_bf16 v24, v63, v63
  v_add_u32 v109, 135168, v29
  ds_read_b64_tr_b16 v[88:89], v109 offset:0
  ds_read_b64_tr_b16 v[90:91], v109 offset:768
  ds_read_b64_tr_b16 v[92:93], v109 offset:3072
  ds_read_b64_tr_b16 v[94:95], v109 offset:3840
  ds_read_b64_tr_b16 v[96:97], v109 offset:6144
  ds_read_b64_tr_b16 v[98:99], v109 offset:6912
  ds_read_b64_tr_b16 v[100:101], v109 offset:9216
  ds_read_b64_tr_b16 v[102:103], v109 offset:9984
  s_waitcnt lgkmcnt(7)
  v_dot2c_f32_bf16 v25, v88, v26
  v_dot2c_f32_bf16 v25, v89, v26
  s_waitcnt lgkmcnt(6)
  v_dot2c_f32_bf16 v25, v90, v26
  v_dot2c_f32_bf16 v25, v91, v26
  s_waitcnt lgkmcnt(5)
  v_dot2c_f32_bf16 v25, v92, v26
  v_dot2c_f32_bf16 v25, v93, v26
  s_waitcnt lgkmcnt(4)
  v_dot2c_f32_bf16 v25, v94, v26
  v_dot2c_f32_bf16 v25, v95, v26
  s_waitcnt lgkmcnt(3)
  v_dot2c_f32_bf16 v25, v96, v26
  v_dot2c_f32_bf16 v25, v97, v26
  s_waitcnt lgkmcnt(2)
  v_dot2c_f32_bf16 v25, v98, v26
  v_dot2c_f32_bf16 v25, v99, v26
  s_waitcnt lgkmcnt(1)
  v_dot2c_f32_bf16 v25, v100, v26
  v_dot2c_f32_bf16 v25, v101, v26
  s_waitcnt lgkmcnt(0)
  v_dot2c_f32_bf16 v25, v102, v26
  v_dot2c_f32_bf16 v25, v103, v26
  s_waitcnt vmcnt(22)
  s_barrier
  s_add_u32 s60, s70, 262144
  s_add_u32 m0, s69, 135168
  s_nop 0
  buffer_load_dwordx4 v2, s[20:23], s60 offen offset:0 lds
  s_add_u32 s60, s70, 270336
  s_add_u32 m0, s69, 136192
  s_nop 0
  buffer_load_dwordx4 v2, s[20:23], s60 offen offset:0 lds
  s_add_u32 s60, s70, 278528
  s_add_u32 m0, s69, 137216
  s_nop 0
  buffer_load_dwordx4 v2, s[20:23], s60 offen offset:0 lds
  s_add_u32 s60, s70, 286720
  s_add_u32 m0, s69, 138240
  s_nop 0
  buffer_load_dwordx4 v2, s[20:23], s60 offen offset:0 lds
  s_add_u32 s60, s70, 294912
  s_add_u32 m0, s69, 139264
  s_nop 0
  buffer_load_dwordx4 v2, s[20:23], s60 offen offset:0 lds
  s_add_u32 s60, s70, 303104
  s_add_u32 m0, s69, 140288
  s_nop 0
  buffer_load_dwordx4 v2, s[20:23], s60 offen offset:0 lds
  s_add_u32 s60, s70, 311296
  s_add_u32 m0, s69, 141312
  s_nop 0
  buffer_load_dwordx4 v2, s[20:23], s60 offen offset:0 lds
  s_add_u32 s60, s70, 319488
  s_add_u32 m0, s69, 142336
  s_nop 0
  buffer_load_dwordx4 v2, s[20:23], s60 offen offset:0 lds
  v_add_u32 v108, 34816, v21
  v_xor_b32 v110, 0, v108
  v_xor_b32 v111, 16, v108
  v_xor_b32 v112, 32, v108
  v_xor_b32 v113, 48, v108
  ds_read_b128 v[48:51], v110 offset:0
  ds_read_b128 v[52:55], v111 offset:0
  ds_read_b128 v[56:59], v112 offset:0
  ds_read_b128 v[60:63], v113 offset:0
  s_waitcnt lgkmcnt(3)
  v_dot2c_f32_bf16 v23, v48, v26
  v_dot2c_f32_bf16 v24, v48, v48
  v_dot2c_f32_bf16 v23, v49, v26
  v_dot2c_f32_bf16 v24, v49, v49
  v_dot2c_f32_bf16 v23, v50, v26
  v_dot2c_f32_bf16 v24, v50, v50
  v_dot2c_f32_bf16 v23, v51, v26
  v_dot2c_f32_bf16 v24, v51, v51
  s_waitcnt lgkmcnt(2)
  v_dot2c_f32_bf16 v23, v52, v26
  v_dot2c_f32_bf16 v24, v52, v52
  v_dot2c_f32_bf16 v23, v53, v26
  v_dot2c_f32_bf16 v24, v53, v53
  v_dot2c_f32_bf16 v23, v54, v26
  v_dot2c_f32_bf16 v24, v54, v54
  v_dot2c_f32_bf16 v23, v55, v26
  v_dot2c_f32_bf16 v24, v55, v55
  s_waitcnt lgkmcnt(1)
  v_dot2c_f32_bf16 v23, v56, v26
  v_dot2c_f32_bf16 v24, v56, v56
  v_dot2c_f32_bf16 v23, v57, v26
  v_dot2c_f32_bf16 v24, v57, v57
  v_dot2c_f32_bf16 v23, v58, v26
  v_dot2c_f32_bf16 v24, v58, v58
  v_dot2c_f32_bf16 v23, v59, v26
  v_dot2c_f32_bf16 v24, v59, v59
  s_waitcnt lgkmcnt(0)
  v_dot2c_f32_bf16 v23, v60, v26
  v_dot2c_f32_bf16 v24, v60, v60
  v_dot2c_f32_bf16 v23, v61, v26
  v_dot2c_f32_bf16 v24, v61, v61
  v_dot2c_f32_bf16 v23, v62, v26
  v_dot2c_f32_bf16 v24, v62, v62
  v_dot2c_f32_bf16 v23, v63, v26
  v_dot2c_f32_bf16 v24, v63, v63
  v_add_u32 v109, 69632, v29
  ds_read_b64_tr_b16 v[88:89], v109 offset:0
  ds_read_b64_tr_b16 v[90:91], v109 offset:768
  ds_read_b64_tr_b16 v[92:93], v109 offset:3072
  ds_read_b64_tr_b16 v[94:95], v109 offset:3840
  ds_read_b64_tr_b16 v[96:97], v109 offset:6144
  ds_read_b64_tr_b16 v[98:99], v109 offset:6912
  ds_read_b64_tr_b16 v[100:101], v109 offset:9216
  ds_read_b64_tr_b16 v[102:103], v109 offset:9984
  s_waitcnt lgkmcnt(7)
  v_dot2c_f32_bf16 v25, v88, v26
  v_dot2c_f32_bf16 v25, v89, v26
  s_waitcnt lgkmcnt(6)
  v_dot2c_f32_bf16 v25, v90, v26
  v_dot2c_f32_bf16 v25, v91, v26
  s_waitcnt lgkmcnt(5)
  v_dot2c_f32_bf16 v25, v92, v26
  v_dot2c_f32_bf16 v25, v93, v26
  s_waitcnt lgkmcnt(4)
  v_dot2c_f32_bf16 v25, v94, v26
  v_dot2c_f32_bf16 v25, v95, v26
  s_waitcnt lgkmcnt(3)
  v_dot2c_f32_bf16 v25, v96, v26
  v_dot2c_f32_bf16 v25, v97, v26
  s_waitcnt lgkmcnt(2)
  v_dot2c_f32_bf16 v25, v98, v26
  v_dot2c_f32_bf16 v25, v99, v26
  s_waitcnt lgkmcnt(1)
  v_dot2c_f32_bf16 v25, v100, v26
  v_dot2c_f32_bf16 v25, v101, v26
  s_waitcnt lgkmcnt(0)
  v_dot2c_f32_bf16 v25, v102, v26
  v_dot2c_f32_bf16 v25, v103, v26
  s_waitcnt vmcnt(24)
  s_barrier
  s_add_u32 s60, s70, 393216
  s_add_u32 m0, s69, 69632
  s_nop 0
  buffer_load_dwordx4 v2, s[20:23], s60 offen offset:0 lds
  s_add_u32 s60, s70, 401408
  s_add_u32 m0, s69, 70656
  s_nop 0
  buffer_load_dwordx4 v2, s[20:23], s60 offen offset:0 lds
  s_add_u32 s60, s70, 409600
  s_add_u32 m0, s69, 71680
  s_nop 0
  buffer_load_dwordx4 v2, s[20:23], s60 offen offset:0 lds
  s_add_u32 s60, s70, 417792
  s_add_u32 m0, s69, 72704
  s_nop 0
  buffer_load_dwordx4 v2, s[20:23], s60 offen offset:0 lds
  s_add_u32 s60, s70, 425984
  s_add_u32 m0, s69, 73728
  s_nop 0
  buffer_load_dwordx4 v2, s[20:23], s60 offen offset:0 lds
  s_add_u32 s60, s70, 434176
  s_add_u32 m0, s69, 74752
  s_nop 0
  buffer_load_dwordx4 v2, s[20:23], s60 offen offset:0 lds
  s_add_u32 s60, s70, 442368
  s_add_u32 m0, s69, 75776
  s_nop 0
  buffer_load_dwordx4 v2, s[20:23], s60 offen offset:0 lds
  s_add_u32 s60, s70, 450560
  s_add_u32 m0, s69, 76800
  s_nop 0
  buffer_load_dwordx4 v2, s[20:23], s60 offen offset:0 lds
  v_add_u32 v108, 52224, v21
  v_xor_b32 v110, 0, v108
  v_xor_b32 v111, 16, v108
  v_xor_b32 v112, 32, v108
  v_xor_b32 v113, 48, v108
  ds_read_b128 v[48:51], v110 offset:0
  ds_read_b128 v[52:55], v111 offset:0
  ds_read_b128 v[56:59], v112 offset:0
  ds_read_b128 v[60:63], v113 offset:0
  s_waitcnt lgkmcnt(3)
  v_dot2c_f32_bf16 v23, v48, v26
  v_dot2c_f32_bf16 v24, v48, v48
  v_dot2c_f32_bf16 v23, v49, v26
  v_dot2c_f32_bf16 v24, v49, v49
  v_dot2c_f32_bf16 v23, v50, v26
  v_dot2c_f32_bf16 v24, v50, v50
  v_dot2c_f32_bf16 v23, v51, v26
  v_dot2c_f32_bf16 v24, v51, v51
  s_waitcnt lgkmcnt(2)
  v_dot2c_f32_bf16 v23, v52, v26
  v_dot2c_f32_bf16 v24, v52, v52
  v_dot2c_f32_bf16 v23, v53, v26
  v_dot2c_f32_bf16 v24, v53, v53
  v_dot2c_f32_bf16 v23, v54, v26
  v_dot2c_f32_bf16 v24, v54, v54
  v_dot2c_f32_bf16 v23, v55, v26
  v_dot2c_f32_bf16 v24, v55, v55
  s_waitcnt lgkmcnt(1)
  v_dot2c_f32_bf16 v23, v56, v26
  v_dot2c_f32_bf16 v24, v56, v56
  v_dot2c_f32_bf16 v23, v57, v26
  v_dot2c_f32_bf16 v24, v57, v57
  v_dot2c_f32_bf16 v23, v58, v26
  v_dot2c_f32_bf16 v24, v58, v58
  v_dot2c_f32_bf16 v23, v59, v26
  v_dot2c_f32_bf16 v24, v59, v59
  s_waitcnt lgkmcnt(0)
  v_dot2c_f32_bf16 v23, v60, v26
  v_dot2c_f32_bf16 v24, v60, v60
  v_dot2c_f32_bf16 v23, v61, v26
  v_dot2c_f32_bf16 v24, v61, v61
  v_dot2c_f32_bf16 v23, v62, v26
  v_dot2c_f32_bf16 v24, v62, v62
  v_dot2c_f32_bf16 v23, v63, v26
  v_dot2c_f32_bf16 v24, v63, v63
  v_add_u32 v109, 86016, v29
  ds_read_b64_tr_b16 v[88:89], v109 offset:0
  ds_read_b64_tr_b16 v[90:91], v109 offset:768
  ds_read_b64_tr_b16 v[92:93], v109 offset:3072
  ds_read_b64_tr_b16 v[94:95], v109 offset:3840
  ds_read_b64_tr_b16 v[96:97], v109 offset:6144
  ds_read_b64_tr_b16 v[98:99], v109 offset:6912
  ds_read_b64_tr_b16 v[100:101], v109 offset:9216
  ds_read_b64_tr_b16 v[102:103], v109 offset:9984
  s_waitcnt lgkmcnt(7)
  v_dot2c_f32_bf16 v25, v88, v26
  v_dot2c_f32_bf16 v25, v89, v26
  s_waitcnt lgkmcnt(6)
  v_dot2c_f32_bf16 v25, v90, v26
  v_dot2c_f32_bf16 v25, v91, v26
  s_waitcnt lgkmcnt(5)
  v_dot2c_f32_bf16 v25, v92, v26
  v_dot2c_f32_bf16 v25, v93, v26
  s_waitcnt lgkmcnt(4)
  v_dot2c_f32_bf16 v25, v94, v26
  v_dot2c_f32_bf16 v25, v95, v26
  s_waitcnt lgkmcnt(3)
  v_dot2c_f32_bf16 v25, v96, v26
  v_dot2c_f32_bf16 v25, v97, v26
  s_waitcnt lgkmcnt(2)
  v_dot2c_f32_bf16 v25, v98, v26
  v_dot2c_f32_bf16 v25, v99, v26
  s_waitcnt lgkmcnt(1)
  v_dot2c_f32_bf16 v25, v100, v26
  v_dot2c_f32_bf16 v25, v101, v26
  s_waitcnt lgkmcnt(0)
  v_dot2c_f32_bf16 v25, v102, v26
  v_dot2c_f32_bf16 v25, v103, v26
  v_mov_b32 v48, v23
  s_nop 1
  v_permlane32_swap_b32 v23, v48
  v_add_f32 v23, v23, v48
  v_mov_b32 v49, v24
  s_nop 1
  v_permlane32_swap_b32 v24, v49
  v_add_f32 v24, v24, v49
  v_mul_f32 v23, 0x3b000000, v23
  v_mul_f32 v24, 0x3b000000, v24
  v_fma_f32 v48, -v23, v23, v24
  v_max_f32 v48, 0, v48
  v_add_f32 v49, 0x3727c5ac, v48
  v_rsq_f32 v50, v49
  s_nop 0
  v_mul_f32 v51, v23, v50
  ds_write_b32 v32, v50 offset:0
  ds_write_b32 v32, v51 offset:512
  s_cmp_eq_u32 s67, 3
  s_cbranch_scc1 L_a1cs_22
  v_mov_b32 v56, v25
  s_nop 1
  v_permlane32_swap_b32 v25, v56
  v_add_f32 v25, v25, v56
  ds_write_b32 v34, v25
L_a1cs_22:
  s_waitcnt lgkmcnt(0)
  s_waitcnt vmcnt(24)
  s_barrier
  s_waitcnt vmcnt(16)
  s_barrier
  s_add_u32 s60, s73, 0
  s_add_u32 m0, s69, 102400
  s_nop 0
  buffer_load_dwordx4 v6, s[24:27], s60 offen offset:0 lds
  s_add_u32 s60, s73, 14336
  s_add_u32 m0, s69, 103424
  s_nop 0
  buffer_load_dwordx4 v6, s[24:27], s60 offen offset:0 lds
  s_add_u32 s60, s73, 28672
  s_add_u32 m0, s69, 104448
  s_nop 0
  buffer_load_dwordx4 v6, s[24:27], s60 offen offset:0 lds
  s_add_u32 s60, s73, 43008
  s_add_u32 m0, s69, 105472
  s_nop 0
  buffer_load_dwordx4 v6, s[24:27], s60 offen offset:0 lds
  s_add_u32 s60, s73, 57344
  s_add_u32 m0, s69, 106496
  s_nop 0
  buffer_load_dwordx4 v6, s[24:27], s60 offen offset:0 lds
  s_add_u32 s60, s73, 71680
  s_add_u32 m0, s69, 107520
  s_nop 0
  buffer_load_dwordx4 v6, s[24:27], s60 offen offset:0 lds
  s_add_u32 s60, s73, 86016
  s_add_u32 m0, s69, 108544
  s_nop 0
  buffer_load_dwordx4 v6, s[24:27], s60 offen offset:0 lds
  s_add_u32 s60, s73, 100352
  s_add_u32 m0, s69, 109568
  s_nop 0
  buffer_load_dwordx4 v6, s[24:27], s60 offen offset:0 lds
  s_waitcnt vmcnt(16)
  s_barrier
  s_mov_b32 s65, 0x10000
L_poll_23:
  buffer_load_dword v48, v16, s[36:39], 0 offen sc1
  s_waitcnt vmcnt(0)
  v_cmp_ne_u32 vcc, s56, v48
  s_nop 1
  s_cbranch_vccz L_polld_24
  s_sub_u32 s65, s65, 1
  s_cmp_eq_u32 s65, 0
  s_cbranch_scc1 L_polld_24
  s_sleep 1
  s_branch L_poll_23
L_polld_24:
  s_add_u32 s60, s75, 0
  s_add_u32 m0, s69, 86016
  s_nop 0
  buffer_load_dwordx4 v14, s[36:39], s60 offen offset:0 sc1 lds
  buffer_load_dwordx4 v14, s[36:39], s60 offen offset:1024 sc1 lds
  buffer_load_dwordx4 v14, s[36:39], s60 offen offset:2048 sc1 lds
  buffer_load_dwordx4 v14, s[36:39], s60 offen offset:3072 sc1 lds
  s_add_u32 s60, s75, 4096
  s_add_u32 m0, s69, 90112
  s_nop 0
  buffer_load_dwordx4 v14, s[36:39], s60 offen offset:0 sc1 lds
  buffer_load_dwordx4 v14, s[36:39], s60 offen offset:1024 sc1 lds
  buffer_load_dwordx4 v14, s[36:39], s60 offen offset:2048 sc1 lds
  buffer_load_dwordx4 v14, s[36:39], s60 offen offset:3072 sc1 lds
  s_add_u32 s60, s73, 229376
  s_add_u32 m0, s69, 118784
  s_nop 0
  buffer_load_dwordx4 v6, s[24:27], s60 offen offset:0 lds
  s_add_u32 s60, s73, 243712
  s_add_u32 m0, s69, 119808
  s_nop 0
  buffer_load_dwordx4 v6, s[24:27], s60 offen offset:0 lds
  s_add_u32 s60, s73, 258048
  s_add_u32 m0, s69, 120832
  s_nop 0
  buffer_load_dwordx4 v6, s[24:27], s60 offen offset:0 lds
  s_add_u32 s60, s73, 272384
  s_add_u32 m0, s69, 121856
  s_nop 0
  buffer_load_dwordx4 v6, s[24:27], s60 offen offset:0 lds
  s_add_u32 s60, s73, 286720
  s_add_u32 m0, s69, 122880
  s_nop 0
  buffer_load_dwordx4 v6, s[24:27], s60 offen offset:0 lds
  s_add_u32 s60, s73, 301056
  s_add_u32 m0, s69, 123904
  s_nop 0
  buffer_load_dwordx4 v6, s[24:27], s60 offen offset:0 lds
  s_add_u32 s60, s73, 315392
  s_add_u32 m0, s69, 124928
  s_nop 0
  buffer_load_dwordx4 v6, s[24:27], s60 offen offset:0 lds
  s_add_u32 s60, s73, 329728
  s_add_u32 m0, s69, 125952
  s_nop 0
  buffer_load_dwordx4 v6, s[24:27], s60 offen offset:0 lds
  s_barrier
  s_add_u32 s60, s73, 458752
  s_add_u32 m0, s69, 135168
  s_nop 0
  buffer_load_dwordx4 v6, s[24:27], s60 offen offset:0 lds
  s_add_u32 s60, s73, 473088
  s_add_u32 m0, s69, 136192
  s_nop 0
  buffer_load_dwordx4 v6, s[24:27], s60 offen offset:0 lds
  s_add_u32 s60, s73, 487424
  s_add_u32 m0, s69, 137216
  s_nop 0
  buffer_load_dwordx4 v6, s[24:27], s60 offen offset:0 lds
  s_add_u32 s60, s73, 501760
  s_add_u32 m0, s69, 138240
  s_nop 0
  buffer_load_dwordx4 v6, s[24:27], s60 offen offset:0 lds
  s_add_u32 s60, s73, 516096
  s_add_u32 m0, s69, 139264
  s_nop 0
  buffer_load_dwordx4 v6, s[24:27], s60 offen offset:0 lds
  s_add_u32 s60, s73, 530432
  s_add_u32 m0, s69, 140288
  s_nop 0
  buffer_load_dwordx4 v6, s[24:27], s60 offen offset:0 lds
  s_add_u32 s60, s73, 544768
  s_add_u32 m0, s69, 141312
  s_nop 0
  buffer_load_dwordx4 v6, s[24:27], s60 offen offset:0 lds
  s_add_u32 s60, s73, 559104
  s_add_u32 m0, s69, 142336
  s_nop 0
  buffer_load_dwordx4 v6, s[24:27], s60 offen offset:0 lds
  s_waitcnt vmcnt(16)
  s_barrier
  s_add_u32 s60, s73, 688128
  s_add_u32 m0, s69, 69632
  s_nop 0
  buffer_load_dwordx4 v6, s[24:27], s60 offen offset:0 lds
  s_add_u32 s60, s73, 702464
  s_add_u32 m0, s69, 70656
  s_nop 0
  buffer_load_dwordx4 v6, s[24:27], s60 offen offset:0 lds
  s_add_u32 s60, s73, 716800
  s_add_u32 m0, s69, 71680
  s_nop 0
  buffer_load_dwordx4 v6, s[24:27], s60 offen offset:0 lds
  s_add_u32 s60, s73, 731136
  s_add_u32 m0, s69, 72704
  s_nop 0
  buffer_load_dwordx4 v6, s[24:27], s60 offen offset:0 lds
  s_add_u32 s60, s73, 745472
  s_add_u32 m0, s69, 73728
  s_nop 0
  buffer_load_dwordx4 v6, s[24:27], s60 offen offset:0 lds
  s_add_u32 s60, s73, 759808
  s_add_u32 m0, s69, 74752
  s_nop 0
  buffer_load_dwordx4 v6, s[24:27], s60 offen offset:0 lds
  s_add_u32 s60, s73, 774144
  s_add_u32 m0, s69, 75776
  s_nop 0
  buffer_load_dwordx4 v6, s[24:27], s60 offen offset:0 lds
  s_add_u32 s60, s73, 788480
  s_add_u32 m0, s69, 76800
  s_nop 0
  buffer_load_dwordx4 v6, s[24:27], s60 offen offset:0 lds
  s_branch L_ATT
L_ATT_RET_B:
  s_cmp_eq_u32 s57, 1
  s_cbranch_scc1 L_IDLE_B
  s_barrier
  s_add_u32 s60, s73, 917504
  s_add_u32 m0, s69, 86016
  s_nop 0
  buffer_load_dwordx4 v6, s[24:27], s60 offen offset:0 lds
  s_add_u32 s60, s73, 931840
  s_add_u32 m0, s69, 87040
  s_nop 0
  buffer_load_dwordx4 v6, s[24:27], s60 offen offset:0 lds
  s_add_u32 s60, s73, 946176
  s_add_u32 m0, s69, 88064
  s_nop 0
  buffer_load_dwordx4 v6, s[24:27], s60 offen offset:0 lds
  s_add_u32 s60, s73, 960512
  s_add_u32 m0, s69, 89088
  s_nop 0
  buffer_load_dwordx4 v6, s[24:27], s60 offen offset:0 lds
  s_add_u32 s60, s73, 974848
  s_add_u32 m0, s69, 90112
  s_nop 0
  buffer_load_dwordx4 v6, s[24:27], s60 offen offset:0 lds
  s_add_u32 s60, s73, 989184
  s_add_u32 m0, s69, 91136
  s_nop 0
  buffer_load_dwordx4 v6, s[24:27], s60 offen offset:0 lds
  s_add_u32 s60, s73, 1003520
  s_add_u32 m0, s69, 92160
  s_nop 0
  buffer_load_dwordx4 v6, s[24:27], s60 offen offset:0 lds
  s_add_u32 s60, s73, 1017856
  s_add_u32 m0, s69, 93184
  s_nop 0
  buffer_load_dwordx4 v6, s[24:27], s60 offen offset:0 lds
  v_mov_b32 v23, 0
  v_mov_b32 v24, 0
  v_mov_b32 v25, 0
  v_add_u32 v108, 17408, v22
  ds_read_b128 v[48:51], v108 offset:0
  ds_read_b128 v[52:55], v108 offset:1024
  ds_read_b128 v[56:59], v108 offset:2048
  ds_read_b128 v[60:63], v108 offset:3072
  s_waitcnt lgkmcnt(3)
  v_dot2c_f32_bf16 v23, v48, v26
  v_dot2c_f32_bf16 v24, v48, v48
  v_dot2c_f32_bf16 v23, v49, v26
  v_dot2c_f32_bf16 v24, v49, v49
  v_dot2c_f32_bf16 v23, v50, v26
  v_dot2c_f32_bf16 v24, v50, v50
  v_dot2c_f32_bf16 v23, v51, v26
  v_dot2c_f32_bf16 v24, v51, v51
  s_waitcnt lgkmcnt(2)
  v_dot2c_f32_bf16 v23, v52, v26
  v_dot2c_f32_bf16 v24, v52, v52
  v_dot2c_f32_bf16 v23, v53, v26
  v_dot2c_f32_bf16 v24, v53, v53
  v_dot2c_f32_bf16 v23, v54, v26
  v_dot2c_f32_bf16 v24, v54, v54
  v_dot2c_f32_bf16 v23, v55, v26
  v_dot2c_f32_bf16 v24, v55, v55
  s_waitcnt lgkmcnt(1)
  v_dot2c_f32_bf16 v23, v56, v26
  v_dot2c_f32_bf16 v24, v56, v56
  v_dot2c_f32_bf16 v23, v57, v26
  v_dot2c_f32_bf16 v24, v57, v57
  v_dot2c_f32_bf16 v23, v58, v26
  v_dot2c_f32_bf16 v24, v58, v58
  v_dot2c_f32_bf16 v23, v59, v26
  v_dot2c_f32_bf16 v24, v59, v59
  s_waitcnt lgkmcnt(0)
  v_dot2c_f32_bf16 v23, v60, v26
  v_dot2c_f32_bf16 v24, v60, v60
  v_dot2c_f32_bf16 v23, v61, v26
  v_dot2c_f32_bf16 v24, v61, v61
  v_dot2c_f32_bf16 v23, v62, v26
  v_dot2c_f32_bf16 v24, v62, v62
  v_dot2c_f32_bf16 v23, v63, v26
  v_dot2c_f32_bf16 v24, v63, v63
  v_add_u32 v109, 102400, v30
  ds_read_b64_tr_b16 v[88:89], v109 offset:0
  ds_read_b64_tr_b16 v[90:91], v109 offset:1024
  ds_read_b64_tr_b16 v[92:93], v109 offset:4096
  ds_read_b64_tr_b16 v[94:95], v109 offset:5120
  ds_read_b64_tr_b16 v[96:97], v109 offset:8192
  ds_read_b64_tr_b16 v[98:99], v109 offset:9216
  ds_read_b64_tr_b16 v[100:101], v109 offset:12288
  ds_read_b64_tr_b16 v[102:103], v109 offset:13312
  s_waitcnt lgkmcnt(7)
  v_dot2c_f32_bf16 v25, v88, v26
  v_dot2c_f32_bf16 v25, v89, v26
  s_waitcnt lgkmcnt(6)
  v_dot2c_f32_bf16 v25, v90, v26
  v_dot2c_f32_bf16 v25, v91, v26
  s_waitcnt lgkmcnt(5)
  v_dot2c_f32_bf16 v25, v92, v26
  v_dot2c_f32_bf16 v25, v93, v26
  s_waitcnt lgkmcnt(4)
  v_dot2c_f32_bf16 v25, v94, v26
  v_dot2c_f32_bf16 v25, v95, v26
  s_waitcnt lgkmcnt(3)
  v_dot2c_f32_bf16 v25, v96, v26
  v_dot2c_f32_bf16 v25, v97, v26
  s_waitcnt lgkmcnt(2)
  v_dot2c_f32_bf16 v25, v98, v26
  v_dot2c_f32_bf16 v25, v99, v26
  s_waitcnt lgkmcnt(1)
  v_dot2c_f32_bf16 v25, v100, v26
  v_dot2c_f32_bf16 v25, v101, v26
  s_waitcnt lgkmcnt(0)
  v_dot2c_f32_bf16 v25, v102, v26
  v_dot2c_f32_bf16 v25, v103, v26
  s_waitcnt vmcnt(8)
  s_lshl_b32 s64, s52, 3
  s_add_u32 s64, s64, s44
  s_lshl_b32 s64, s64, 5
  s_add_u32 s64, s64, s51
  s_lshl_b32 s64, s64, 2
  s_add_u32 s64, s64, 20996096
  s_mov_b64 exec, 1
  buffer_store_dword v27, off, s[36:39], s64 sc1
  s_mov_b64 exec, -1
  s_barrier
  s_add_u32 s60, s73, 1146880
  s_add_u32 m0, s69, 102400
  s_nop 0
  buffer_load_dwordx4 v6, s[24:27], s60 offen offset:0 lds
  s_add_u32 s60, s73, 1161216
  s_add_u32 m0, s69, 103424
  s_nop 0
  buffer_load_dwordx4 v6, s[24:27], s60 offen offset:0 lds
  s_add_u32 s60, s73, 1175552
  s_add_u32 m0, s69, 104448
  s_nop 0
  buffer_load_dwordx4 v6, s[24:27], s60 offen offset:0 lds
  s_add_u32 s60, s73, 1189888
  s_add_u32 m0, s69, 105472
  s_nop 0
  buffer_load_dwordx4 v6, s[24:27], s60 offen offset:0 lds
  s_add_u32 s60, s73, 1204224
  s_add_u32 m0, s69, 106496
  s_nop 0
  buffer_load_dwordx4 v6, s[24:27], s60 offen offset:0 lds
  s_add_u32 s60, s73, 1218560
  s_add_u32 m0, s69, 107520
  s_nop 0
  buffer_load_dwordx4 v6, s[24:27], s60 offen offset:0 lds
  s_add_u32 s60, s73, 1232896
  s_add_u32 m0, s69, 108544
  s_nop 0
  buffer_load_dwordx4 v6, s[24:27], s60 offen offset:0 lds
  s_add_u32 s60, s73, 1247232
  s_add_u32 m0, s69, 109568
  s_nop 0
  buffer_load_dwordx4 v6, s[24:27], s60 offen offset:0 lds
  v_add_u32 v108, 34816, v22
  ds_read_b128 v[48:51], v108 offset:0
  ds_read_b128 v[52:55], v108 offset:1024
  ds_read_b128 v[56:59], v108 offset:2048
  ds_read_b128 v[60:63], v108 offset:3072
  s_waitcnt lgkmcnt(3)
  v_dot2c_f32_bf16 v23, v48, v26
  v_dot2c_f32_bf16 v24, v48, v48
  v_dot2c_f32_bf16 v23, v49, v26
  v_dot2c_f32_bf16 v24, v49, v49
  v_dot2c_f32_bf16 v23, v50, v26
  v_dot2c_f32_bf16 v24, v50, v50
  v_dot2c_f32_bf16 v23, v51, v26
  v_dot2c_f32_bf16 v24, v51, v51
  s_waitcnt lgkmcnt(2)
  v_dot2c_f32_bf16 v23, v52, v26
  v_dot2c_f32_bf16 v24, v52, v52
  v_dot2c_f32_bf16 v23, v53, v26
  v_dot2c_f32_bf16 v24, v53, v53
  v_dot2c_f32_bf16 v23, v54, v26
  v_dot2c_f32_bf16 v24, v54, v54
  v_dot2c_f32_bf16 v23, v55, v26
  v_dot2c_f32_bf16 v24, v55, v55
  s_waitcnt lgkmcnt(1)
  v_dot2c_f32_bf16 v23, v56, v26
  v_dot2c_f32_bf16 v24, v56, v56
  v_dot2c_f32_bf16 v23, v57, v26
  v_dot2c_f32_bf16 v24, v57, v57
  v_dot2c_f32_bf16 v23, v58, v26
  v_dot2c_f32_bf16 v24, v58, v58
  v_dot2c_f32_bf16 v23, v59, v26
  v_dot2c_f32_bf16 v24, v59, v59
  s_waitcnt lgkmcnt(0)
  v_dot2c_f32_bf16 v23, v60, v26
  v_dot2c_f32_bf16 v24, v60, v60
  v_dot2c_f32_bf16 v23, v61, v26
  v_dot2c_f32_bf16 v24, v61, v61
  v_dot2c_f32_bf16 v23, v62, v26
  v_dot2c_f32_bf16 v24, v62, v62
  v_dot2c_f32_bf16 v23, v63, v26
  v_dot2c_f32_bf16 v24, v63, v63
  v_add_u32 v109, 118784, v30
  ds_read_b64_tr_b16 v[88:89], v109 offset:0
  ds_read_b64_tr_b16 v[90:91], v109 offset:1024
  ds_read_b64_tr_b16 v[92:93], v109 offset:4096
  ds_read_b64_tr_b16 v[94:95], v109 offset:5120
  ds_read_b64_tr_b16 v[96:97], v109 offset:8192
  ds_read_b64_tr_b16 v[98:99], v109 offset:9216
  ds_read_b64_tr_b16 v[100:101], v109 offset:12288
  ds_read_b64_tr_b16 v[102:103], v109 offset:13312
  s_waitcnt lgkmcnt(7)
  v_dot2c_f32_bf16 v25, v88, v26
  v_dot2c_f32_bf16 v25, v89, v26
  s_waitcnt lgkmcnt(6)
  v_dot2c_f32_bf16 v25, v90, v26
  v_dot2c_f32_bf16 v25, v91, v26
  s_waitcnt lgkmcnt(5)
  v_dot2c_f32_bf16 v25, v92, v26
  v_dot2c_f32_bf16 v25, v93, v26
  s_waitcnt lgkmcnt(4)
  v_dot2c_f32_bf16 v25, v94, v26
  v_dot2c_f32_bf16 v25, v95, v26
  s_waitcnt lgkmcnt(3)
  v_dot2c_f32_bf16 v25, v96, v26
  v_dot2c_f32_bf16 v25, v97, v26
  s_waitcnt lgkmcnt(2)
  v_dot2c_f32_bf16 v25, v98, v26
  v_dot2c_f32_bf16 v25, v99, v26
  s_waitcnt lgkmcnt(1)
  v_dot2c_f32_bf16 v25, v100, v26
  v_dot2c_f32_bf16 v25, v101, v26
  s_waitcnt lgkmcnt(0)
  v_dot2c_f32_bf16 v25, v102, v26
  v_dot2c_f32_bf16 v25, v103, v26
  s_barrier
  s_add_u32 s60, s73, 1376256
  s_add_u32 m0, s69, 118784
  s_nop 0
  buffer_load_dwordx4 v6, s[24:27], s60 offen offset:0 lds
  s_add_u32 s60, s73, 1390592
  s_add_u32 m0, s69, 119808
  s_nop 0
  buffer_load_dwordx4 v6, s[24:27], s60 offen offset:0 lds
  s_add_u32 s60, s73, 1404928
  s_add_u32 m0, s69, 120832
  s_nop 0
  buffer_load_dwordx4 v6, s[24:27], s60 offen offset:0 lds
  s_add_u32 s60, s73, 1419264
  s_add_u32 m0, s69, 121856
  s_nop 0
  buffer_load_dwordx4 v6, s[24:27], s60 offen offset:0 lds
  s_add_u32 s60, s73, 1433600
  s_add_u32 m0, s69, 122880
  s_nop 0
  buffer_load_dwordx4 v6, s[24:27], s60 offen offset:0 lds
  s_add_u32 s60, s73, 1447936
  s_add_u32 m0, s69, 123904
  s_nop 0
  buffer_load_dwordx4 v6, s[24:27], s60 offen offset:0 lds
  s_add_u32 s60, s73, 1462272
  s_add_u32 m0, s69, 124928
  s_nop 0
  buffer_load_dwordx4 v6, s[24:27], s60 offen offset:0 lds
  s_add_u32 s60, s73, 1476608
  s_add_u32 m0, s69, 125952
  s_nop 0
  buffer_load_dwordx4 v6, s[24:27], s60 offen offset:0 lds
  v_add_u32 v108, 52224, v22
  ds_read_b128 v[48:51], v108 offset:0
  ds_read_b128 v[52:55], v108 offset:1024
  ds_read_b128 v[56:59], v108 offset:2048
  ds_read_b128 v[60:63], v108 offset:3072
  s_waitcnt lgkmcnt(3)
  v_dot2c_f32_bf16 v23, v48, v26
  v_dot2c_f32_bf16 v24, v48, v48
  v_dot2c_f32_bf16 v23, v49, v26
  v_dot2c_f32_bf16 v24, v49, v49
  v_dot2c_f32_bf16 v23, v50, v26
  v_dot2c_f32_bf16 v24, v50, v50
  v_dot2c_f32_bf16 v23, v51, v26
  v_dot2c_f32_bf16 v24, v51, v51
  s_waitcnt lgkmcnt(2)
  v_dot2c_f32_bf16 v23, v52, v26
  v_dot2c_f32_bf16 v24, v52, v52
  v_dot2c_f32_bf16 v23, v53, v26
  v_dot2c_f32_bf16 v24, v53, v53
  v_dot2c_f32_bf16 v23, v54, v26
  v_dot2c_f32_bf16 v24, v54, v54
  v_dot2c_f32_bf16 v23, v55, v26
  v_dot2c_f32_bf16 v24, v55, v55
  s_waitcnt lgkmcnt(1)
  v_dot2c_f32_bf16 v23, v56, v26
  v_dot2c_f32_bf16 v24, v56, v56
  v_dot2c_f32_bf16 v23, v57, v26
  v_dot2c_f32_bf16 v24, v57, v57
  v_dot2c_f32_bf16 v23, v58, v26
  v_dot2c_f32_bf16 v24, v58, v58
  v_dot2c_f32_bf16 v23, v59, v26
  v_dot2c_f32_bf16 v24, v59, v59
  s_waitcnt lgkmcnt(0)
  v_dot2c_f32_bf16 v23, v60, v26
  v_dot2c_f32_bf16 v24, v60, v60
  v_dot2c_f32_bf16 v23, v61, v26
  v_dot2c_f32_bf16 v24, v61, v61
  v_dot2c_f32_bf16 v23, v62, v26
  v_dot2c_f32_bf16 v24, v62, v62
  v_dot2c_f32_bf16 v23, v63, v26
  v_dot2c_f32_bf16 v24, v63, v63
  v_add_u32 v109, 135168, v30
  ds_read_b64_tr_b16 v[88:89], v109 offset:0
  ds_read_b64_tr_b16 v[90:91], v109 offset:1024
  ds_read_b64_tr_b16 v[92:93], v109 offset:4096
  ds_read_b64_tr_b16 v[94:95], v109 offset:5120
  ds_read_b64_tr_b16 v[96:97], v109 offset:8192
  ds_read_b64_tr_b16 v[98:99], v109 offset:9216
  ds_read_b64_tr_b16 v[100:101], v109 offset:12288
  ds_read_b64_tr_b16 v[102:103], v109 offset:13312
  s_waitcnt lgkmcnt(7)
  v_dot2c_f32_bf16 v25, v88, v26
  v_dot2c_f32_bf16 v25, v89, v26
  s_waitcnt lgkmcnt(6)
  v_dot2c_f32_bf16 v25, v90, v26
  v_dot2c_f32_bf16 v25, v91, v26
  s_waitcnt lgkmcnt(5)
  v_dot2c_f32_bf16 v25, v92, v26
  v_dot2c_f32_bf16 v25, v93, v26
  s_waitcnt lgkmcnt(4)
  v_dot2c_f32_bf16 v25, v94, v26
  v_dot2c_f32_bf16 v25, v95, v26
  s_waitcnt lgkmcnt(3)
  v_dot2c_f32_bf16 v25, v96, v26
  v_dot2c_f32_bf16 v25, v97, v26
  s_waitcnt lgkmcnt(2)
  v_dot2c_f32_bf16 v25, v98, v26
  v_dot2c_f32_bf16 v25, v99, v26
  s_waitcnt lgkmcnt(1)
  v_dot2c_f32_bf16 v25, v100, v26
  v_dot2c_f32_bf16 v25, v101, v26
  s_waitcnt lgkmcnt(0)
  v_dot2c_f32_bf16 v25, v102, v26
  v_dot2c_f32_bf16 v25, v103, v26
  s_barrier
  s_add_u32 s60, s73, 1605632
  s_add_u32 m0, s69, 135168
  s_nop 0
  buffer_load_dwordx4 v6, s[24:27], s60 offen offset:0 lds
  s_add_u32 s60, s73, 1619968
  s_add_u32 m0, s69, 136192
  s_nop 0
  buffer_load_dwordx4 v6, s[24:27], s60 offen offset:0 lds
  s_add_u32 s60, s73, 1634304
  s_add_u32 m0, s69, 137216
  s_nop 0
  buffer_load_dwordx4 v6, s[24:27], s60 offen offset:0 lds
  s_add_u32 s60, s73, 1648640
  s_add_u32 m0, s69, 138240
  s_nop 0
  buffer_load_dwordx4 v6, s[24:27], s60 offen offset:0 lds
  s_add_u32 s60, s73, 1662976
  s_add_u32 m0, s69, 139264
  s_nop 0
  buffer_load_dwordx4 v6, s[24:27], s60 offen offset:0 lds
  s_add_u32 s60, s73, 1677312
  s_add_u32 m0, s69, 140288
  s_nop 0
  buffer_load_dwordx4 v6, s[24:27], s60 offen offset:0 lds
  s_add_u32 s60, s73, 1691648
  s_add_u32 m0, s69, 141312
  s_nop 0
  buffer_load_dwordx4 v6, s[24:27], s60 offen offset:0 lds
  s_add_u32 s60, s73, 1705984
  s_add_u32 m0, s69, 142336
  s_nop 0
  buffer_load_dwordx4 v6, s[24:27], s60 offen offset:0 lds
  v_add_u32 v108, 0, v22
  ds_read_b128 v[48:51], v108 offset:0
  ds_read_b128 v[52:55], v108 offset:1024
  ds_read_b128 v[56:59], v108 offset:2048
  ds_read_b128 v[60:63], v108 offset:3072
  s_waitcnt lgkmcnt(3)
  v_dot2c_f32_bf16 v23, v48, v26
  v_dot2c_f32_bf16 v24, v48, v48
  v_dot2c_f32_bf16 v23, v49, v26
  v_dot2c_f32_bf16 v24, v49, v49
  v_dot2c_f32_bf16 v23, v50, v26
  v_dot2c_f32_bf16 v24, v50, v50
  v_dot2c_f32_bf16 v23, v51, v26
  v_dot2c_f32_bf16 v24, v51, v51
  s_waitcnt lgkmcnt(2)
  v_dot2c_f32_bf16 v23, v52, v26
  v_dot2c_f32_bf16 v24, v52, v52
  v_dot2c_f32_bf16 v23, v53, v26
  v_dot2c_f32_bf16 v24, v53, v53
  v_dot2c_f32_bf16 v23, v54, v26
  v_dot2c_f32_bf16 v24, v54, v54
  v_dot2c_f32_bf16 v23, v55, v26
  v_dot2c_f32_bf16 v24, v55, v55
  s_waitcnt lgkmcnt(1)
  v_dot2c_f32_bf16 v23, v56, v26
  v_dot2c_f32_bf16 v24, v56, v56
  v_dot2c_f32_bf16 v23, v57, v26
  v_dot2c_f32_bf16 v24, v57, v57
  v_dot2c_f32_bf16 v23, v58, v26
  v_dot2c_f32_bf16 v24, v58, v58
  v_dot2c_f32_bf16 v23, v59, v26
  v_dot2c_f32_bf16 v24, v59, v59
  s_waitcnt lgkmcnt(0)
  v_dot2c_f32_bf16 v23, v60, v26
  v_dot2c_f32_bf16 v24, v60, v60
  v_dot2c_f32_bf16 v23, v61, v26
  v_dot2c_f32_bf16 v24, v61, v61
  v_dot2c_f32_bf16 v23, v62, v26
  v_dot2c_f32_bf16 v24, v62, v62
  v_dot2c_f32_bf16 v23, v63, v26
  v_dot2c_f32_bf16 v24, v63, v63
  v_add_u32 v109, 69632, v30
  ds_read_b64_tr_b16 v[88:89], v109 offset:0
  ds_read_b64_tr_b16 v[90:91], v109 offset:1024
  ds_read_b64_tr_b16 v[92:93], v109 offset:4096
  ds_read_b64_tr_b16 v[94:95], v109 offset:5120
  ds_read_b64_tr_b16 v[96:97], v109 offset:8192
  ds_read_b64_tr_b16 v[98:99], v109 offset:9216
  ds_read_b64_tr_b16 v[100:101], v109 offset:12288
  ds_read_b64_tr_b16 v[102:103], v109 offset:13312
  s_waitcnt lgkmcnt(7)
  v_dot2c_f32_bf16 v25, v88, v26
  v_dot2c_f32_bf16 v25, v89, v26
  s_waitcnt lgkmcnt(6)
  v_dot2c_f32_bf16 v25, v90, v26
  v_dot2c_f32_bf16 v25, v91, v26
  s_waitcnt lgkmcnt(5)
  v_dot2c_f32_bf16 v25, v92, v26
  v_dot2c_f32_bf16 v25, v93, v26
  s_waitcnt lgkmcnt(4)
  v_dot2c_f32_bf16 v25, v94, v26
  v_dot2c_f32_bf16 v25, v95, v26
  s_waitcnt lgkmcnt(3)
  v_dot2c_f32_bf16 v25, v96, v26
  v_dot2c_f32_bf16 v25, v97, v26
  s_waitcnt lgkmcnt(2)
  v_dot2c_f32_bf16 v25, v98, v26
  v_dot2c_f32_bf16 v25, v99, v26
  s_waitcnt lgkmcnt(1)
  v_dot2c_f32_bf16 v25, v100, v26
  v_dot2c_f32_bf16 v25, v101, v26
  s_waitcnt lgkmcnt(0)
  v_dot2c_f32_bf16 v25, v102, v26
  v_dot2c_f32_bf16 v25, v103, v26
  s_waitcnt vmcnt(24)
  s_barrier
  s_add_u32 s60, s70, 0
  s_add_u32 m0, s69, 69632
  s_nop 0
  buffer_load_dwordx4 v2, s[12:15], s60 offen offset:0 lds
  s_add_u32 s60, s70, 8192
  s_add_u32 m0, s69, 70656
  s_nop 0
  buffer_load_dwordx4 v2, s[12:15], s60 offen offset:0 lds
  s_add_u32 s60, s70, 16384
  s_add_u32 m0, s69, 71680
  s_nop 0
  buffer_load_dwordx4 v2, s[12:15], s60 offen offset:0 lds
  s_add_u32 s60, s70, 24576
  s_add_u32 m0, s69, 72704
  s_nop 0
  buffer_load_dwordx4 v2, s[12:15], s60 offen offset:0 lds
  s_add_u32 s60, s70, 32768
  s_add_u32 m0, s69, 73728
  s_nop 0
  buffer_load_dwordx4 v2, s[12:15], s60 offen offset:0 lds
  s_add_u32 s60, s70, 40960
  s_add_u32 m0, s69, 74752
  s_nop 0
  buffer_load_dwordx4 v2, s[12:15], s60 offen offset:0 lds
  s_add_u32 s60, s70, 49152
  s_add_u32 m0, s69, 75776
  s_nop 0
  buffer_load_dwordx4 v2, s[12:15], s60 offen offset:0 lds
  s_add_u32 s60, s70, 57344
  s_add_u32 m0, s69, 76800
  s_nop 0
  buffer_load_dwordx4 v2, s[12:15], s60 offen offset:0 lds
  v_add_u32 v108, 17408, v22
  ds_read_b128 v[48:51], v108 offset:0
  ds_read_b128 v[52:55], v108 offset:1024
  ds_read_b128 v[56:59], v108 offset:2048
  ds_read_b128 v[60:63], v108 offset:3072
  s_waitcnt lgkmcnt(3)
  v_dot2c_f32_bf16 v23, v48, v26
  v_dot2c_f32_bf16 v24, v48, v48
  v_dot2c_f32_bf16 v23, v49, v26
  v_dot2c_f32_bf16 v24, v49, v49
  v_dot2c_f32_bf16 v23, v50, v26
  v_dot2c_f32_bf16 v24, v50, v50
  v_dot2c_f32_bf16 v23, v51, v26
  v_dot2c_f32_bf16 v24, v51, v51
  s_waitcnt lgkmcnt(2)
  v_dot2c_f32_bf16 v23, v52, v26
  v_dot2c_f32_bf16 v24, v52, v52
  v_dot2c_f32_bf16 v23, v53, v26
  v_dot2c_f32_bf16 v24, v53, v53
  v_dot2c_f32_bf16 v23, v54, v26
  v_dot2c_f32_bf16 v24, v54, v54
  v_dot2c_f32_bf16 v23, v55, v26
  v_dot2c_f32_bf16 v24, v55, v55
  s_waitcnt lgkmcnt(1)
  v_dot2c_f32_bf16 v23, v56, v26
  v_dot2c_f32_bf16 v24, v56, v56
  v_dot2c_f32_bf16 v23, v57, v26
  v_dot2c_f32_bf16 v24, v57, v57
  v_dot2c_f32_bf16 v23, v58, v26
  v_dot2c_f32_bf16 v24, v58, v58
  v_dot2c_f32_bf16 v23, v59, v26
  v_dot2c_f32_bf16 v24, v59, v59
  s_waitcnt lgkmcnt(0)
  v_dot2c_f32_bf16 v23, v60, v26
  v_dot2c_f32_bf16 v24, v60, v60
  v_dot2c_f32_bf16 v23, v61, v26
  v_dot2c_f32_bf16 v24, v61, v61
  v_dot2c_f32_bf16 v23, v62, v26
  v_dot2c_f32_bf16 v24, v62, v62
  v_dot2c_f32_bf16 v23, v63, v26
  v_dot2c_f32_bf16 v24, v63, v63
  v_add_u32 v109, 86016, v30
  ds_read_b64_tr_b16 v[88:89], v109 offset:0
  ds_read_b64_tr_b16 v[90:91], v109 offset:1024
  ds_read_b64_tr_b16 v[92:93], v109 offset:4096
  ds_read_b64_tr_b16 v[94:95], v109 offset:5120
  ds_read_b64_tr_b16 v[96:97], v109 offset:8192
  ds_read_b64_tr_b16 v[98:99], v109 offset:9216
  ds_read_b64_tr_b16 v[100:101], v109 offset:12288
  ds_read_b64_tr_b16 v[102:103], v109 offset:13312
  s_waitcnt lgkmcnt(7)
  v_dot2c_f32_bf16 v25, v88, v26
  v_dot2c_f32_bf16 v25, v89, v26
  s_waitcnt lgkmcnt(6)
  v_dot2c_f32_bf16 v25, v90, v26
  v_dot2c_f32_bf16 v25, v91, v26
  s_waitcnt lgkmcnt(5)
  v_dot2c_f32_bf16 v25, v92, v26
  v_dot2c_f32_bf16 v25, v93, v26
  s_waitcnt lgkmcnt(4)
  v_dot2c_f32_bf16 v25, v94, v26
  v_dot2c_f32_bf16 v25, v95, v26
  s_waitcnt lgkmcnt(3)
  v_dot2c_f32_bf16 v25, v96, v26
  v_dot2c_f32_bf16 v25, v97, v26
  s_waitcnt lgkmcnt(2)
  v_dot2c_f32_bf16 v25, v98, v26
  v_dot2c_f32_bf16 v25, v99, v26
  s_waitcnt lgkmcnt(1)
  v_dot2c_f32_bf16 v25, v100, v26
  v_dot2c_f32_bf16 v25, v101, v26
  s_waitcnt lgkmcnt(0)
  v_dot2c_f32_bf16 v25, v102, v26
  v_dot2c_f32_bf16 v25, v103, v26
  s_waitcnt vmcnt(24)
  s_barrier
  s_add_u32 s60, s70, 131072
  s_add_u32 m0, s69, 86016
  s_nop 0
  buffer_load_dwordx4 v2, s[12:15], s60 offen offset:0 lds
  s_add_u32 s60, s70, 139264
  s_add_u32 m0, s69, 87040
  s_nop 0
  buffer_load_dwordx4 v2, s[12:15], s60 offen offset:0 lds
  s_add_u32 s60, s70, 147456
  s_add_u32 m0, s69, 88064
  s_nop 0
  buffer_load_dwordx4 v2, s[12:15], s60 offen offset:0 lds
  s_add_u32 s60, s70, 155648
  s_add_u32 m0, s69, 89088
  s_nop 0
  buffer_load_dwordx4 v2, s[12:15], s60 offen offset:0 lds
  s_add_u32 s60, s70, 163840
  s_add_u32 m0, s69, 90112
  s_nop 0
  buffer_load_dwordx4 v2, s[12:15], s60 offen offset:0 lds
  s_add_u32 s60, s70, 172032
  s_add_u32 m0, s69, 91136
  s_nop 0
  buffer_load_dwordx4 v2, s[12:15], s60 offen offset:0 lds
  s_add_u32 s60, s70, 180224
  s_add_u32 m0, s69, 92160
  s_nop 0
  buffer_load_dwordx4 v2, s[12:15], s60 offen offset:0 lds
  s_add_u32 s60, s70, 188416
  s_add_u32 m0, s69, 93184
  s_nop 0
  buffer_load_dwordx4 v2, s[12:15], s60 offen offset:0 lds
  v_add_u32 v108, 34816, v22
  ds_read_b128 v[48:51], v108 offset:0
  ds_read_b128 v[52:55], v108 offset:1024
  ds_read_b128 v[56:59], v108 offset:2048
  ds_read_b128 v[60:63], v108 offset:3072
  s_waitcnt lgkmcnt(3)
  v_dot2c_f32_bf16 v23, v48, v26
  v_dot2c_f32_bf16 v24, v48, v48
  v_dot2c_f32_bf16 v23, v49, v26
  v_dot2c_f32_bf16 v24, v49, v49
  v_dot2c_f32_bf16 v23, v50, v26
  v_dot2c_f32_bf16 v24, v50, v50
  v_dot2c_f32_bf16 v23, v51, v26
  v_dot2c_f32_bf16 v24, v51, v51
  s_waitcnt lgkmcnt(2)
  v_dot2c_f32_bf16 v23, v52, v26
  v_dot2c_f32_bf16 v24, v52, v52
  v_dot2c_f32_bf16 v23, v53, v26
  v_dot2c_f32_bf16 v24, v53, v53
  v_dot2c_f32_bf16 v23, v54, v26
  v_dot2c_f32_bf16 v24, v54, v54
  v_dot2c_f32_bf16 v23, v55, v26
  v_dot2c_f32_bf16 v24, v55, v55
  s_waitcnt lgkmcnt(1)
  v_dot2c_f32_bf16 v23, v56, v26
  v_dot2c_f32_bf16 v24, v56, v56
  v_dot2c_f32_bf16 v23, v57, v26
  v_dot2c_f32_bf16 v24, v57, v57
  v_dot2c_f32_bf16 v23, v58, v26
  v_dot2c_f32_bf16 v24, v58, v58
  v_dot2c_f32_bf16 v23, v59, v26
  v_dot2c_f32_bf16 v24, v59, v59
  s_waitcnt lgkmcnt(0)
  v_dot2c_f32_bf16 v23, v60, v26
  v_dot2c_f32_bf16 v24, v60, v60
  v_dot2c_f32_bf16 v23, v61, v26
  v_dot2c_f32_bf16 v24, v61, v61
  v_dot2c_f32_bf16 v23, v62, v26
  v_dot2c_f32_bf16 v24, v62, v62
  v_dot2c_f32_bf16 v23, v63, v26
  v_dot2c_f32_bf16 v24, v63, v63
  v_add_u32 v109, 102400, v30
  ds_read_b64_tr_b16 v[88:89], v109 offset:0
  ds_read_b64_tr_b16 v[90:91], v109 offset:1024
  ds_read_b64_tr_b16 v[92:93], v109 offset:4096
  ds_read_b64_tr_b16 v[94:95], v109 offset:5120
  ds_read_b64_tr_b16 v[96:97], v109 offset:8192
  ds_read_b64_tr_b16 v[98:99], v109 offset:9216
  ds_read_b64_tr_b16 v[100:101], v109 offset:12288
  ds_read_b64_tr_b16 v[102:103], v109 offset:13312
  s_waitcnt lgkmcnt(7)
  v_dot2c_f32_bf16 v25, v88, v26
  v_dot2c_f32_bf16 v25, v89, v26
  s_waitcnt lgkmcnt(6)
  v_dot2c_f32_bf16 v25, v90, v26
  v_dot2c_f32_bf16 v25, v91, v26
  s_waitcnt lgkmcnt(5)
  v_dot2c_f32_bf16 v25, v92, v26
  v_dot2c_f32_bf16 v25, v93, v26
  s_waitcnt lgkmcnt(4)
  v_dot2c_f32_bf16 v25, v94, v26
  v_dot2c_f32_bf16 v25, v95, v26
  s_waitcnt lgkmcnt(3)
  v_dot2c_f32_bf16 v25, v96, v26
  v_dot2c_f32_bf16 v25, v97, v26
  s_waitcnt lgkmcnt(2)
  v_dot2c_f32_bf16 v25, v98, v26
  v_dot2c_f32_bf16 v25, v99, v26
  s_waitcnt lgkmcnt(1)
  v_dot2c_f32_bf16 v25, v100, v26
  v_dot2c_f32_bf16 v25, v101, v26
  s_waitcnt lgkmcnt(0)
  v_dot2c_f32_bf16 v25, v102, v26
  v_dot2c_f32_bf16 v25, v103, v26
  s_waitcnt vmcnt(24)
  s_barrier
  s_add_u32 s60, s70, 262144
  s_add_u32 m0, s69, 102400
  s_nop 0
  buffer_load_dwordx4 v2, s[12:15], s60 offen offset:0 lds
  s_add_u32 s60, s70, 270336
  s_add_u32 m0, s69, 103424
  s_nop 0
  buffer_load_dwordx4 v2, s[12:15], s60 offen offset:0 lds
  s_add_u32 s60, s70, 278528
  s_add_u32 m0, s69, 104448
  s_nop 0
  buffer_load_dwordx4 v2, s[12:15], s60 offen offset:0 lds
  s_add_u32 s60, s70, 286720
  s_add_u32 m0, s69, 105472
  s_nop 0
  buffer_load_dwordx4 v2, s[12:15], s60 offen offset:0 lds
  s_add_u32 s60, s70, 294912
  s_add_u32 m0, s69, 106496
  s_nop 0
  buffer_load_dwordx4 v2, s[12:15], s60 offen offset:0 lds
  s_add_u32 s60, s70, 303104
  s_add_u32 m0, s69, 107520
  s_nop 0
  buffer_load_dwordx4 v2, s[12:15], s60 offen offset:0 lds
  s_add_u32 s60, s70, 311296
  s_add_u32 m0, s69, 108544
  s_nop 0
  buffer_load_dwordx4 v2, s[12:15], s60 offen offset:0 lds
  s_add_u32 s60, s70, 319488
  s_add_u32 m0, s69, 109568
  s_nop 0
  buffer_load_dwordx4 v2, s[12:15], s60 offen offset:0 lds
  v_add_u32 v108, 52224, v22
  ds_read_b128 v[48:51], v108 offset:0
  ds_read_b128 v[52:55], v108 offset:1024
  ds_read_b128 v[56:59], v108 offset:2048
  ds_read_b128 v[60:63], v108 offset:3072
  s_waitcnt lgkmcnt(3)
  v_dot2c_f32_bf16 v23, v48, v26
  v_dot2c_f32_bf16 v24, v48, v48
  v_dot2c_f32_bf16 v23, v49, v26
  v_dot2c_f32_bf16 v24, v49, v49
  v_dot2c_f32_bf16 v23, v50, v26
  v_dot2c_f32_bf16 v24, v50, v50
  v_dot2c_f32_bf16 v23, v51, v26
  v_dot2c_f32_bf16 v24, v51, v51
  s_waitcnt lgkmcnt(2)
  v_dot2c_f32_bf16 v23, v52, v26
  v_dot2c_f32_bf16 v24, v52, v52
  v_dot2c_f32_bf16 v23, v53, v26
  v_dot2c_f32_bf16 v24, v53, v53
  v_dot2c_f32_bf16 v23, v54, v26
  v_dot2c_f32_bf16 v24, v54, v54
  v_dot2c_f32_bf16 v23, v55, v26
  v_dot2c_f32_bf16 v24, v55, v55
  s_waitcnt lgkmcnt(1)
  v_dot2c_f32_bf16 v23, v56, v26
  v_dot2c_f32_bf16 v24, v56, v56
  v_dot2c_f32_bf16 v23, v57, v26
  v_dot2c_f32_bf16 v24, v57, v57
  v_dot2c_f32_bf16 v23, v58, v26
  v_dot2c_f32_bf16 v24, v58, v58
  v_dot2c_f32_bf16 v23, v59, v26
  v_dot2c_f32_bf16 v24, v59, v59
  s_waitcnt lgkmcnt(0)
  v_dot2c_f32_bf16 v23, v60, v26
  v_dot2c_f32_bf16 v24, v60, v60
  v_dot2c_f32_bf16 v23, v61, v26
  v_dot2c_f32_bf16 v24, v61, v61
  v_dot2c_f32_bf16 v23, v62, v26
  v_dot2c_f32_bf16 v24, v62, v62
  v_dot2c_f32_bf16 v23, v63, v26
  v_dot2c_f32_bf16 v24, v63, v63
  v_add_u32 v109, 118784, v30
  ds_read_b64_tr_b16 v[88:89], v109 offset:0
  ds_read_b64_tr_b16 v[90:91], v109 offset:1024
  ds_read_b64_tr_b16 v[92:93], v109 offset:4096
  ds_read_b64_tr_b16 v[94:95], v109 offset:5120
  ds_read_b64_tr_b16 v[96:97], v109 offset:8192
  ds_read_b64_tr_b16 v[98:99], v109 offset:9216
  ds_read_b64_tr_b16 v[100:101], v109 offset:12288
  ds_read_b64_tr_b16 v[102:103], v109 offset:13312
  s_waitcnt lgkmcnt(7)
  v_dot2c_f32_bf16 v25, v88, v26
  v_dot2c_f32_bf16 v25, v89, v26
  s_waitcnt lgkmcnt(6)
  v_dot2c_f32_bf16 v25, v90, v26
  v_dot2c_f32_bf16 v25, v91, v26
  s_waitcnt lgkmcnt(5)
  v_dot2c_f32_bf16 v25, v92, v26
  v_dot2c_f32_bf16 v25, v93, v26
  s_waitcnt lgkmcnt(4)
  v_dot2c_f32_bf16 v25, v94, v26
  v_dot2c_f32_bf16 v25, v95, v26
  s_waitcnt lgkmcnt(3)
  v_dot2c_f32_bf16 v25, v96, v26
  v_dot2c_f32_bf16 v25, v97, v26
  s_waitcnt lgkmcnt(2)
  v_dot2c_f32_bf16 v25, v98, v26
  v_dot2c_f32_bf16 v25, v99, v26
  s_waitcnt lgkmcnt(1)
  v_dot2c_f32_bf16 v25, v100, v26
  v_dot2c_f32_bf16 v25, v101, v26
  s_waitcnt lgkmcnt(0)
  v_dot2c_f32_bf16 v25, v102, v26
  v_dot2c_f32_bf16 v25, v103, v26
  s_waitcnt vmcnt(24)
  s_barrier
  s_add_u32 s60, s70, 393216
  s_add_u32 m0, s69, 118784
  s_nop 0
  buffer_load_dwordx4 v2, s[12:15], s60 offen offset:0 lds
  s_add_u32 s60, s70, 401408
  s_add_u32 m0, s69, 119808
  s_nop 0
  buffer_load_dwordx4 v2, s[12:15], s60 offen offset:0 lds
  s_add_u32 s60, s70, 409600
  s_add_u32 m0, s69, 120832
  s_nop 0
  buffer_load_dwordx4 v2, s[12:15], s60 offen offset:0 lds
  s_add_u32 s60, s70, 417792
  s_add_u32 m0, s69, 121856
  s_nop 0
  buffer_load_dwordx4 v2, s[12:15], s60 offen offset:0 lds
  s_add_u32 s60, s70, 425984
  s_add_u32 m0, s69, 122880
  s_nop 0
  buffer_load_dwordx4 v2, s[12:15], s60 offen offset:0 lds
  s_add_u32 s60, s70, 434176
  s_add_u32 m0, s69, 123904
  s_nop 0
  buffer_load_dwordx4 v2, s[12:15], s60 offen offset:0 lds
  s_add_u32 s60, s70, 442368
  s_add_u32 m0, s69, 124928
  s_nop 0
  buffer_load_dwordx4 v2, s[12:15], s60 offen offset:0 lds
  s_add_u32 s60, s70, 450560
  s_add_u32 m0, s69, 125952
  s_nop 0
  buffer_load_dwordx4 v2, s[12:15], s60 offen offset:0 lds
  v_add_u32 v108, 0, v22
  ds_read_b128 v[48:51], v108 offset:0
  ds_read_b128 v[52:55], v108 offset:1024
  ds_read_b128 v[56:59], v108 offset:2048
  ds_read_b128 v[60:63], v108 offset:3072
  s_waitcnt lgkmcnt(3)
  v_dot2c_f32_bf16 v23, v48, v26
  v_dot2c_f32_bf16 v24, v48, v48
  v_dot2c_f32_bf16 v23, v49, v26
  v_dot2c_f32_bf16 v24, v49, v49
  v_dot2c_f32_bf16 v23, v50, v26
  v_dot2c_f32_bf16 v24, v50, v50
  v_dot2c_f32_bf16 v23, v51, v26
  v_dot2c_f32_bf16 v24, v51, v51
  s_waitcnt lgkmcnt(2)
  v_dot2c_f32_bf16 v23, v52, v26
  v_dot2c_f32_bf16 v24, v52, v52
  v_dot2c_f32_bf16 v23, v53, v26
  v_dot2c_f32_bf16 v24, v53, v53
  v_dot2c_f32_bf16 v23, v54, v26
  v_dot2c_f32_bf16 v24, v54, v54
  v_dot2c_f32_bf16 v23, v55, v26
  v_dot2c_f32_bf16 v24, v55, v55
  s_waitcnt lgkmcnt(1)
  v_dot2c_f32_bf16 v23, v56, v26
  v_dot2c_f32_bf16 v24, v56, v56
  v_dot2c_f32_bf16 v23, v57, v26
  v_dot2c_f32_bf16 v24, v57, v57
  v_dot2c_f32_bf16 v23, v58, v26
  v_dot2c_f32_bf16 v24, v58, v58
  v_dot2c_f32_bf16 v23, v59, v26
  v_dot2c_f32_bf16 v24, v59, v59
  s_waitcnt lgkmcnt(0)
  v_dot2c_f32_bf16 v23, v60, v26
  v_dot2c_f32_bf16 v24, v60, v60
  v_dot2c_f32_bf16 v23, v61, v26
  v_dot2c_f32_bf16 v24, v61, v61
  v_dot2c_f32_bf16 v23, v62, v26
  v_dot2c_f32_bf16 v24, v62, v62
  v_dot2c_f32_bf16 v23, v63, v26
  v_dot2c_f32_bf16 v24, v63, v63
  v_add_u32 v109, 135168, v30
  ds_read_b64_tr_b16 v[88:89], v109 offset:0
  ds_read_b64_tr_b16 v[90:91], v109 offset:1024
  ds_read_b64_tr_b16 v[92:93], v109 offset:4096
  ds_read_b64_tr_b16 v[94:95], v109 offset:5120
  ds_read_b64_tr_b16 v[96:97], v109 offset:8192
  ds_read_b64_tr_b16 v[98:99], v109 offset:9216
  ds_read_b64_tr_b16 v[100:101], v109 offset:12288
  ds_read_b64_tr_b16 v[102:103], v109 offset:13312
  s_waitcnt lgkmcnt(7)
  v_dot2c_f32_bf16 v25, v88, v26
  v_dot2c_f32_bf16 v25, v89, v26
  s_waitcnt lgkmcnt(6)
  v_dot2c_f32_bf16 v25, v90, v26
  v_dot2c_f32_bf16 v25, v91, v26
  s_waitcnt lgkmcnt(5)
  v_dot2c_f32_bf16 v25, v92, v26
  v_dot2c_f32_bf16 v25, v93, v26
  s_waitcnt lgkmcnt(4)
  v_dot2c_f32_bf16 v25, v94, v26
  v_dot2c_f32_bf16 v25, v95, v26
  s_waitcnt lgkmcnt(3)
  v_dot2c_f32_bf16 v25, v96, v26
  v_dot2c_f32_bf16 v25, v97, v26
  s_waitcnt lgkmcnt(2)
  v_dot2c_f32_bf16 v25, v98, v26
  v_dot2c_f32_bf16 v25, v99, v26
  s_waitcnt lgkmcnt(1)
  v_dot2c_f32_bf16 v25, v100, v26
  v_dot2c_f32_bf16 v25, v101, v26
  s_waitcnt lgkmcnt(0)
  v_dot2c_f32_bf16 v25, v102, v26
  v_dot2c_f32_bf16 v25, v103, v26
  v_mov_b32 v48, v23
  s_nop 1
  v_permlane32_swap_b32 v23, v48
  v_add_f32 v23, v23, v48
  v_mov_b32 v49, v24
  s_nop 1
  v_permlane32_swap_b32 v24, v49
  v_add_f32 v24, v24, v49
  v_mul_f32 v23, 0x3b000000, v23
  v_mul_f32 v24, 0x3b000000, v24
  v_fma_f32 v48, -v23, v23, v24
  v_max_f32 v48, 0, v48
  v_add_f32 v49, 0x3727c5ac, v48
  v_rsq_f32 v50, v49
  s_nop 0
  v_mul_f32 v51, v23, v50
  ds_write_b32 v32, v50 offset:0
  ds_write_b32 v32, v51 offset:512
  v_mov_b32 v56, v25
  s_nop 1
  v_permlane32_swap_b32 v25, v56
  v_add_f32 v25, v25, v56
  ds_write_b32 v34, v25
  s_waitcnt lgkmcnt(0)
  s_waitcnt vmcnt(24)
  s_barrier
L_A3_ENTRY_B:
  s_add_u32 s60, s70, 0
  s_add_u32 m0, s69, 135168
  s_nop 0
  buffer_load_dwordx4 v2, s[28:31], s60 offen offset:0 lds
  s_add_u32 s60, s70, 8192
  s_add_u32 m0, s69, 136192
  s_nop 0
  buffer_load_dwordx4 v2, s[28:31], s60 offen offset:0 lds
  s_add_u32 s60, s70, 16384
  s_add_u32 m0, s69, 137216
  s_nop 0
  buffer_load_dwordx4 v2, s[28:31], s60 offen offset:0 lds
  s_add_u32 s60, s70, 24576
  s_add_u32 m0, s69, 138240
  s_nop 0
  buffer_load_dwordx4 v2, s[28:31], s60 offen offset:0 lds
  s_add_u32 s60, s70, 32768
  s_add_u32 m0, s69, 139264
  s_nop 0
  buffer_load_dwordx4 v2, s[28:31], s60 offen offset:0 lds
  s_add_u32 s60, s70, 40960
  s_add_u32 m0, s69, 140288
  s_nop 0
  buffer_load_dwordx4 v2, s[28:31], s60 offen offset:0 lds
  s_add_u32 s60, s70, 49152
  s_add_u32 m0, s69, 141312
  s_nop 0
  buffer_load_dwordx4 v2, s[28:31], s60 offen offset:0 lds
  s_add_u32 s60, s70, 57344
  s_add_u32 m0, s69, 142336
  s_nop 0
  buffer_load_dwordx4 v2, s[28:31], s60 offen offset:0 lds
  s_waitcnt vmcnt(24)
  s_barrier
  s_add_u32 s60, s70, 131072
  s_add_u32 m0, s69, 69632
  s_nop 0
  buffer_load_dwordx4 v2, s[28:31], s60 offen offset:0 lds
  s_add_u32 s60, s70, 139264
  s_add_u32 m0, s69, 70656
  s_nop 0
  buffer_load_dwordx4 v2, s[28:31], s60 offen offset:0 lds
  s_add_u32 s60, s70, 147456
  s_add_u32 m0, s69, 71680
  s_nop 0
  buffer_load_dwordx4 v2, s[28:31], s60 offen offset:0 lds
  s_add_u32 s60, s70, 155648
  s_add_u32 m0, s69, 72704
  s_nop 0
  buffer_load_dwordx4 v2, s[28:31], s60 offen offset:0 lds
  s_add_u32 s60, s70, 163840
  s_add_u32 m0, s69, 73728
  s_nop 0
  buffer_load_dwordx4 v2, s[28:31], s60 offen offset:0 lds
  s_add_u32 s60, s70, 172032
  s_add_u32 m0, s69, 74752
  s_nop 0
  buffer_load_dwordx4 v2, s[28:31], s60 offen offset:0 lds
  s_add_u32 s60, s70, 180224
  s_add_u32 m0, s69, 75776
  s_nop 0
  buffer_load_dwordx4 v2, s[28:31], s60 offen offset:0 lds
  s_add_u32 s60, s70, 188416
  s_add_u32 m0, s69, 76800
  s_nop 0
  buffer_load_dwordx4 v2, s[28:31], s60 offen offset:0 lds
  s_waitcnt vmcnt(24)
  s_barrier
  s_add_u32 s60, s70, 262144
  s_add_u32 m0, s69, 86016
  s_nop 0
  buffer_load_dwordx4 v2, s[28:31], s60 offen offset:0 lds
  s_add_u32 s60, s70, 270336
  s_add_u32 m0, s69, 87040
  s_nop 0
  buffer_load_dwordx4 v2, s[28:31], s60 offen offset:0 lds
  s_add_u32 s60, s70, 278528
  s_add_u32 m0, s69, 88064
  s_nop 0
  buffer_load_dwordx4 v2, s[28:31], s60 offen offset:0 lds
  s_add_u32 s60, s70, 286720
  s_add_u32 m0, s69, 89088
  s_nop 0
  buffer_load_dwordx4 v2, s[28:31], s60 offen offset:0 lds
  s_add_u32 s60, s70, 294912
  s_add_u32 m0, s69, 90112
  s_nop 0
  buffer_load_dwordx4 v2, s[28:31], s60 offen offset:0 lds
  s_add_u32 s60, s70, 303104
  s_add_u32 m0, s69, 91136
  s_nop 0
  buffer_load_dwordx4 v2, s[28:31], s60 offen offset:0 lds
  s_add_u32 s60, s70, 311296
  s_add_u32 m0, s69, 92160
  s_nop 0
  buffer_load_dwordx4 v2, s[28:31], s60 offen offset:0 lds
  s_add_u32 s60, s70, 319488
  s_add_u32 m0, s69, 93184
  s_nop 0
  buffer_load_dwordx4 v2, s[28:31], s60 offen offset:0 lds
  s_waitcnt vmcnt(24)
  s_barrier
  s_add_u32 s60, s70, 393216
  s_add_u32 m0, s69, 102400
  s_nop 0
  buffer_load_dwordx4 v2, s[28:31], s60 offen offset:0 lds
  s_add_u32 s60, s70, 401408
  s_add_u32 m0, s69, 103424
  s_nop 0
  buffer_load_dwordx4 v2, s[28:31], s60 offen offset:0 lds
  s_add_u32 s60, s70, 409600
  s_add_u32 m0, s69, 104448
  s_nop 0
  buffer_load_dwordx4 v2, s[28:31], s60 offen offset:0 lds
  s_add_u32 s60, s70, 417792
  s_add_u32 m0, s69, 105472
  s_nop 0
  buffer_load_dwordx4 v2, s[28:31], s60 offen offset:0 lds
  s_add_u32 s60, s70, 425984
  s_add_u32 m0, s69, 106496
  s_nop 0
  buffer_load_dwordx4 v2, s[28:31], s60 offen offset:0 lds
  s_add_u32 s60, s70, 434176
  s_add_u32 m0, s69, 107520
  s_nop 0
  buffer_load_dwordx4 v2, s[28:31], s60 offen offset:0 lds
  s_add_u32 s60, s70, 442368
  s_add_u32 m0, s69, 108544
  s_nop 0
  buffer_load_dwordx4 v2, s[28:31], s60 offen offset:0 lds
  s_add_u32 s60, s70, 450560
  s_add_u32 m0, s69, 109568
  s_nop 0
  buffer_load_dwordx4 v2, s[28:31], s60 offen offset:0 lds
  s_waitcnt vmcnt(24)
  s_barrier
  s_add_u32 s60, s70, 524288
  s_add_u32 m0, s69, 118784
  s_nop 0
  buffer_load_dwordx4 v2, s[28:31], s60 offen offset:0 lds
  s_add_u32 s60, s70, 532480
  s_add_u32 m0, s69, 119808
  s_nop 0
  buffer_load_dwordx4 v2, s[28:31], s60 offen offset:0 lds
  s_add_u32 s60, s70, 540672
  s_add_u32 m0, s69, 120832
  s_nop 0
  buffer_load_dwordx4 v2, s[28:31], s60 offen offset:0 lds
  s_add_u32 s60, s70, 548864
  s_add_u32 m0, s69, 121856
  s_nop 0
  buffer_load_dwordx4 v2, s[28:31], s60 offen offset:0 lds
  s_add_u32 s60, s70, 557056
  s_add_u32 m0, s69, 122880
  s_nop 0
  buffer_load_dwordx4 v2, s[28:31], s60 offen offset:0 lds
  s_add_u32 s60, s70, 565248
  s_add_u32 m0, s69, 123904
  s_nop 0
  buffer_load_dwordx4 v2, s[28:31], s60 offen offset:0 lds
  s_add_u32 s60, s70, 573440
  s_add_u32 m0, s69, 124928
  s_nop 0
  buffer_load_dwordx4 v2, s[28:31], s60 offen offset:0 lds
  s_add_u32 s60, s70, 581632
  s_add_u32 m0, s69, 125952
  s_nop 0
  buffer_load_dwordx4 v2, s[28:31], s60 offen offset:0 lds
  s_waitcnt vmcnt(24)
  s_barrier
  s_add_u32 s60, s70, 655360
  s_add_u32 m0, s69, 135168
  s_nop 0
  buffer_load_dwordx4 v2, s[28:31], s60 offen offset:0 lds
  s_add_u32 s60, s70, 663552
  s_add_u32 m0, s69, 136192
  s_nop 0
  buffer_load_dwordx4 v2, s[28:31], s60 offen offset:0 lds
  s_add_u32 s60, s70, 671744
  s_add_u32 m0, s69, 137216
  s_nop 0
  buffer_load_dwordx4 v2, s[28:31], s60 offen offset:0 lds
  s_add_u32 s60, s70, 679936
  s_add_u32 m0, s69, 138240
  s_nop 0
  buffer_load_dwordx4 v2, s[28:31], s60 offen offset:0 lds
  s_add_u32 s60, s70, 688128
  s_add_u32 m0, s69, 139264
  s_nop 0
  buffer_load_dwordx4 v2, s[28:31], s60 offen offset:0 lds
  s_add_u32 s60, s70, 696320
  s_add_u32 m0, s69, 140288
  s_nop 0
  buffer_load_dwordx4 v2, s[28:31], s60 offen offset:0 lds
  s_add_u32 s60, s70, 704512
  s_add_u32 m0, s69, 141312
  s_nop 0
  buffer_load_dwordx4 v2, s[28:31], s60 offen offset:0 lds
  s_add_u32 s60, s70, 712704
  s_add_u32 m0, s69, 142336
  s_nop 0
  buffer_load_dwordx4 v2, s[28:31], s60 offen offset:0 lds
  s_waitcnt vmcnt(24)
  s_barrier
  s_add_u32 s60, s70, 786432
  s_add_u32 m0, s69, 69632
  s_nop 0
  buffer_load_dwordx4 v2, s[28:31], s60 offen offset:0 lds
  s_add_u32 s60, s70, 794624
  s_add_u32 m0, s69, 70656
  s_nop 0
  buffer_load_dwordx4 v2, s[28:31], s60 offen offset:0 lds
  s_add_u32 s60, s70, 802816
  s_add_u32 m0, s69, 71680
  s_nop 0
  buffer_load_dwordx4 v2, s[28:31], s60 offen offset:0 lds
  s_add_u32 s60, s70, 811008
  s_add_u32 m0, s69, 72704
  s_nop 0
  buffer_load_dwordx4 v2, s[28:31], s60 offen offset:0 lds
  s_add_u32 s60, s70, 819200
  s_add_u32 m0, s69, 73728
  s_nop 0
  buffer_load_dwordx4 v2, s[28:31], s60 offen offset:0 lds
  s_add_u32 s60, s70, 827392
  s_add_u32 m0, s69, 74752
  s_nop 0
  buffer_load_dwordx4 v2, s[28:31], s60 offen offset:0 lds
  s_add_u32 s60, s70, 835584
  s_add_u32 m0, s69, 75776
  s_nop 0
  buffer_load_dwordx4 v2, s[28:31], s60 offen offset:0 lds
  s_add_u32 s60, s70, 843776
  s_add_u32 m0, s69, 76800
  s_nop 0
  buffer_load_dwordx4 v2, s[28:31], s60 offen offset:0 lds
  s_waitcnt vmcnt(24)
  s_barrier
  s_add_u32 s60, s70, 917504
  s_add_u32 m0, s69, 86016
  s_nop 0
  buffer_load_dwordx4 v2, s[28:31], s60 offen offset:0 lds
  s_add_u32 s60, s70, 925696
  s_add_u32 m0, s69, 87040
  s_nop 0
  buffer_load_dwordx4 v2, s[28:31], s60 offen offset:0 lds
  s_add_u32 s60, s70, 933888
  s_add_u32 m0, s69, 88064
  s_nop 0
  buffer_load_dwordx4 v2, s[28:31], s60 offen offset:0 lds
  s_add_u32 s60, s70, 942080
  s_add_u32 m0, s69, 89088
  s_nop 0
  buffer_load_dwordx4 v2, s[28:31], s60 offen offset:0 lds
  s_add_u32 s60, s70, 950272
  s_add_u32 m0, s69, 90112
  s_nop 0
  buffer_load_dwordx4 v2, s[28:31], s60 offen offset:0 lds
  s_add_u32 s60, s70, 958464
  s_add_u32 m0, s69, 91136
  s_nop 0
  buffer_load_dwordx4 v2, s[28:31], s60 offen offset:0 lds
  s_add_u32 s60, s70, 966656
  s_add_u32 m0, s69, 92160
  s_nop 0
  buffer_load_dwordx4 v2, s[28:31], s60 offen offset:0 lds
  s_add_u32 s60, s70, 974848
  s_add_u32 m0, s69, 93184
  s_nop 0
  buffer_load_dwordx4 v2, s[28:31], s60 offen offset:0 lds
  s_waitcnt vmcnt(24)
  s_barrier
  s_add_u32 s60, s70, 1048576
  s_add_u32 m0, s69, 102400
  s_nop 0
  buffer_load_dwordx4 v2, s[28:31], s60 offen offset:0 lds
  s_add_u32 s60, s70, 1056768
  s_add_u32 m0, s69, 103424
  s_nop 0
  buffer_load_dwordx4 v2, s[28:31], s60 offen offset:0 lds
  s_add_u32 s60, s70, 1064960
  s_add_u32 m0, s69, 104448
  s_nop 0
  buffer_load_dwordx4 v2, s[28:31], s60 offen offset:0 lds
  s_add_u32 s60, s70, 1073152
  s_add_u32 m0, s69, 105472
  s_nop 0
  buffer_load_dwordx4 v2, s[28:31], s60 offen offset:0 lds
  s_add_u32 s60, s70, 1081344
  s_add_u32 m0, s69, 106496
  s_nop 0
  buffer_load_dwordx4 v2, s[28:31], s60 offen offset:0 lds
  s_add_u32 s60, s70, 1089536
  s_add_u32 m0, s69, 107520
  s_nop 0
  buffer_load_dwordx4 v2, s[28:31], s60 offen offset:0 lds
  s_add_u32 s60, s70, 1097728
  s_add_u32 m0, s69, 108544
  s_nop 0
  buffer_load_dwordx4 v2, s[28:31], s60 offen offset:0 lds
  s_add_u32 s60, s70, 1105920
  s_add_u32 m0, s69, 109568
  s_nop 0
  buffer_load_dwordx4 v2, s[28:31], s60 offen offset:0 lds
  s_waitcnt vmcnt(24)
  s_barrier
  s_add_u32 s60, s70, 1179648
  s_add_u32 m0, s69, 118784
  s_nop 0
  buffer_load_dwordx4 v2, s[28:31], s60 offen offset:0 lds
  s_add_u32 s60, s70, 1187840
  s_add_u32 m0, s69, 119808
  s_nop 0
  buffer_load_dwordx4 v2, s[28:31], s60 offen offset:0 lds
  s_add_u32 s60, s70, 1196032
  s_add_u32 m0, s69, 120832
  s_nop 0
  buffer_load_dwordx4 v2, s[28:31], s60 offen offset:0 lds
  s_add_u32 s60, s70, 1204224
  s_add_u32 m0, s69, 121856
  s_nop 0
  buffer_load_dwordx4 v2, s[28:31], s60 offen offset:0 lds
  s_add_u32 s60, s70, 1212416
  s_add_u32 m0, s69, 122880
  s_nop 0
  buffer_load_dwordx4 v2, s[28:31], s60 offen offset:0 lds
  s_add_u32 s60, s70, 1220608
  s_add_u32 m0, s69, 123904
  s_nop 0
  buffer_load_dwordx4 v2, s[28:31], s60 offen offset:0 lds
  s_add_u32 s60, s70, 1228800
  s_add_u32 m0, s69, 124928
  s_nop 0
  buffer_load_dwordx4 v2, s[28:31], s60 offen offset:0 lds
  s_add_u32 s60, s70, 1236992
  s_add_u32 m0, s69, 125952
  s_nop 0
  buffer_load_dwordx4 v2, s[28:31], s60 offen offset:0 lds
  s_waitcnt vmcnt(24)
  s_barrier
  s_add_u32 s60, s70, 1310720
  s_add_u32 m0, s69, 135168
  s_nop 0
  buffer_load_dwordx4 v2, s[28:31], s60 offen offset:0 lds
  s_add_u32 s60, s70, 1318912
  s_add_u32 m0, s69, 136192
  s_nop 0
  buffer_load_dwordx4 v2, s[28:31], s60 offen offset:0 lds
  s_add_u32 s60, s70, 1327104
  s_add_u32 m0, s69, 137216
  s_nop 0
  buffer_load_dwordx4 v2, s[28:31], s60 offen offset:0 lds
  s_add_u32 s60, s70, 1335296
  s_add_u32 m0, s69, 138240
  s_nop 0
  buffer_load_dwordx4 v2, s[28:31], s60 offen offset:0 lds
  s_add_u32 s60, s70, 1343488
  s_add_u32 m0, s69, 139264
  s_nop 0
  buffer_load_dwordx4 v2, s[28:31], s60 offen offset:0 lds
  s_add_u32 s60, s70, 1351680
  s_add_u32 m0, s69, 140288
  s_nop 0
  buffer_load_dwordx4 v2, s[28:31], s60 offen offset:0 lds
  s_add_u32 s60, s70, 1359872
  s_add_u32 m0, s69, 141312
  s_nop 0
  buffer_load_dwordx4 v2, s[28:31], s60 offen offset:0 lds
  s_add_u32 s60, s70, 1368064
  s_add_u32 m0, s69, 142336
  s_nop 0
  buffer_load_dwordx4 v2, s[28:31], s60 offen offset:0 lds
  s_waitcnt vmcnt(24)
  s_barrier
  s_add_u32 s60, s70, 1441792
  s_add_u32 m0, s69, 69632
  s_nop 0
  buffer_load_dwordx4 v2, s[28:31], s60 offen offset:0 lds
  s_add_u32 s60, s70, 1449984
  s_add_u32 m0, s69, 70656
  s_nop 0
  buffer_load_dwordx4 v2, s[28:31], s60 offen offset:0 lds
  s_add_u32 s60, s70, 1458176
  s_add_u32 m0, s69, 71680
  s_nop 0
  buffer_load_dwordx4 v2, s[28:31], s60 offen offset:0 lds
  s_add_u32 s60, s70, 1466368
  s_add_u32 m0, s69, 72704
  s_nop 0
  buffer_load_dwordx4 v2, s[28:31], s60 offen offset:0 lds
  s_add_u32 s60, s70, 1474560
  s_add_u32 m0, s69, 73728
  s_nop 0
  buffer_load_dwordx4 v2, s[28:31], s60 offen offset:0 lds
  s_add_u32 s60, s70, 1482752
  s_add_u32 m0, s69, 74752
  s_nop 0
  buffer_load_dwordx4 v2, s[28:31], s60 offen offset:0 lds
  s_add_u32 s60, s70, 1490944
  s_add_u32 m0, s69, 75776
  s_nop 0
  buffer_load_dwordx4 v2, s[28:31], s60 offen offset:0 lds
  s_add_u32 s60, s70, 1499136
  s_add_u32 m0, s69, 76800
  s_nop 0
  buffer_load_dwordx4 v2, s[28:31], s60 offen offset:0 lds
  s_waitcnt vmcnt(24)
  s_barrier
  s_add_u32 s60, s70, 1572864
  s_add_u32 m0, s69, 86016
  s_nop 0
  buffer_load_dwordx4 v2, s[28:31], s60 offen offset:0 lds
  s_add_u32 s60, s70, 1581056
  s_add_u32 m0, s69, 87040
  s_nop 0
  buffer_load_dwordx4 v2, s[28:31], s60 offen offset:0 lds
  s_add_u32 s60, s70, 1589248
  s_add_u32 m0, s69, 88064
  s_nop 0
  buffer_load_dwordx4 v2, s[28:31], s60 offen offset:0 lds
  s_add_u32 s60, s70, 1597440
  s_add_u32 m0, s69, 89088
  s_nop 0
  buffer_load_dwordx4 v2, s[28:31], s60 offen offset:0 lds
  s_add_u32 s60, s70, 1605632
  s_add_u32 m0, s69, 90112
  s_nop 0
  buffer_load_dwordx4 v2, s[28:31], s60 offen offset:0 lds
  s_add_u32 s60, s70, 1613824
  s_add_u32 m0, s69, 91136
  s_nop 0
  buffer_load_dwordx4 v2, s[28:31], s60 offen offset:0 lds
  s_add_u32 s60, s70, 1622016
  s_add_u32 m0, s69, 92160
  s_nop 0
  buffer_load_dwordx4 v2, s[28:31], s60 offen offset:0 lds
  s_add_u32 s60, s70, 1630208
  s_add_u32 m0, s69, 93184
  s_nop 0
  buffer_load_dwordx4 v2, s[28:31], s60 offen offset:0 lds
  s_waitcnt vmcnt(24)
  s_barrier
  s_add_u32 s60, s70, 1703936
  s_add_u32 m0, s69, 102400
  s_nop 0
  buffer_load_dwordx4 v2, s[28:31], s60 offen offset:0 lds
  s_add_u32 s60, s70, 1712128
  s_add_u32 m0, s69, 103424
  s_nop 0
  buffer_load_dwordx4 v2, s[28:31], s60 offen offset:0 lds
  s_add_u32 s60, s70, 1720320
  s_add_u32 m0, s69, 104448
  s_nop 0
  buffer_load_dwordx4 v2, s[28:31], s60 offen offset:0 lds
  s_add_u32 s60, s70, 1728512
  s_add_u32 m0, s69, 105472
  s_nop 0
  buffer_load_dwordx4 v2, s[28:31], s60 offen offset:0 lds
  s_add_u32 s60, s70, 1736704
  s_add_u32 m0, s69, 106496
  s_nop 0
  buffer_load_dwordx4 v2, s[28:31], s60 offen offset:0 lds
  s_add_u32 s60, s70, 1744896
  s_add_u32 m0, s69, 107520
  s_nop 0
  buffer_load_dwordx4 v2, s[28:31], s60 offen offset:0 lds
  s_add_u32 s60, s70, 1753088
  s_add_u32 m0, s69, 108544
  s_nop 0
  buffer_load_dwordx4 v2, s[28:31], s60 offen offset:0 lds
  s_add_u32 s60, s70, 1761280
  s_add_u32 m0, s69, 109568
  s_nop 0
  buffer_load_dwordx4 v2, s[28:31], s60 offen offset:0 lds
  s_waitcnt vmcnt(24)
  s_barrier
  s_waitcnt vmcnt(16)
  s_barrier
  s_waitcnt vmcnt(8)
  s_barrier
  s_waitcnt vmcnt(0)
  s_barrier
  s_barrier
  s_branch L_END
L_IDLE_B:
  s_waitcnt vmcnt(0)
  s_lshl_b32 s64, s52, 3
  s_add_u32 s64, s64, s44
  s_lshl_b32 s64, s64, 5
  s_add_u32 s64, s64, s51
  s_lshl_b32 s64, s64, 2
  s_add_u32 s64, s64, 20996096
  s_mov_b64 exec, 1
  buffer_store_dword v27, off, s[36:39], s64 sc1
  s_mov_b64 exec, -1
  s_barrier
  s_add_u32 s60, s70, 0
  s_add_u32 m0, s69, 69632
  s_nop 0
  buffer_load_dwordx4 v2, s[12:15], s60 offen offset:0 lds
  s_add_u32 s60, s70, 8192
  s_add_u32 m0, s69, 70656
  s_nop 0
  buffer_load_dwordx4 v2, s[12:15], s60 offen offset:0 lds
  s_add_u32 s60, s70, 16384
  s_add_u32 m0, s69, 71680
  s_nop 0
  buffer_load_dwordx4 v2, s[12:15], s60 offen offset:0 lds
  s_add_u32 s60, s70, 24576
  s_add_u32 m0, s69, 72704
  s_nop 0
  buffer_load_dwordx4 v2, s[12:15], s60 offen offset:0 lds
  s_add_u32 s60, s70, 32768
  s_add_u32 m0, s69, 73728
  s_nop 0
  buffer_load_dwordx4 v2, s[12:15], s60 offen offset:0 lds
  s_add_u32 s60, s70, 40960
  s_add_u32 m0, s69, 74752
  s_nop 0
  buffer_load_dwordx4 v2, s[12:15], s60 offen offset:0 lds
  s_add_u32 s60, s70, 49152
  s_add_u32 m0, s69, 75776
  s_nop 0
  buffer_load_dwordx4 v2, s[12:15], s60 offen offset:0 lds
  s_add_u32 s60, s70, 57344
  s_add_u32 m0, s69, 76800
  s_nop 0
  buffer_load_dwordx4 v2, s[12:15], s60 offen offset:0 lds
  s_add_u32 s60, s70, 131072
  s_add_u32 m0, s69, 86016
  s_nop 0
  buffer_load_dwordx4 v2, s[12:15], s60 offen offset:0 lds
  s_add_u32 s60, s70, 139264
  s_add_u32 m0, s69, 87040
  s_nop 0
  buffer_load_dwordx4 v2, s[12:15], s60 offen offset:0 lds
  s_add_u32 s60, s70, 147456
  s_add_u32 m0, s69, 88064
  s_nop 0
  buffer_load_dwordx4 v2, s[12:15], s60 offen offset:0 lds
  s_add_u32 s60, s70, 155648
  s_add_u32 m0, s69, 89088
  s_nop 0
  buffer_load_dwordx4 v2, s[12:15], s60 offen offset:0 lds
  s_add_u32 s60, s70, 163840
  s_add_u32 m0, s69, 90112
  s_nop 0
  buffer_load_dwordx4 v2, s[12:15], s60 offen offset:0 lds
  s_add_u32 s60, s70, 172032
  s_add_u32 m0, s69, 91136
  s_nop 0
  buffer_load_dwordx4 v2, s[12:15], s60 offen offset:0 lds
  s_add_u32 s60, s70, 180224
  s_add_u32 m0, s69, 92160
  s_nop 0
  buffer_load_dwordx4 v2, s[12:15], s60 offen offset:0 lds
  s_add_u32 s60, s70, 188416
  s_add_u32 m0, s69, 93184
  s_nop 0
  buffer_load_dwordx4 v2, s[12:15], s60 offen offset:0 lds
  s_add_u32 s60, s70, 262144
  s_add_u32 m0, s69, 102400
  s_nop 0
  buffer_load_dwordx4 v2, s[12:15], s60 offen offset:0 lds
  s_add_u32 s60, s70, 270336
  s_add_u32 m0, s69, 103424
  s_nop 0
  buffer_load_dwordx4 v2, s[12:15], s60 offen offset:0 lds
  s_add_u32 s60, s70, 278528
  s_add_u32 m0, s69, 104448
  s_nop 0
  buffer_load_dwordx4 v2, s[12:15], s60 offen offset:0 lds
  s_add_u32 s60, s70, 286720
  s_add_u32 m0, s69, 105472
  s_nop 0
  buffer_load_dwordx4 v2, s[12:15], s60 offen offset:0 lds
  s_add_u32 s60, s70, 294912
  s_add_u32 m0, s69, 106496
  s_nop 0
  buffer_load_dwordx4 v2, s[12:15], s60 offen offset:0 lds
  s_add_u32 s60, s70, 303104
  s_add_u32 m0, s69, 107520
  s_nop 0
  buffer_load_dwordx4 v2, s[12:15], s60 offen offset:0 lds
  s_add_u32 s60, s70, 311296
  s_add_u32 m0, s69, 108544
  s_nop 0
  buffer_load_dwordx4 v2, s[12:15], s60 offen offset:0 lds
  s_add_u32 s60, s70, 319488
  s_add_u32 m0, s69, 109568
  s_nop 0
  buffer_load_dwordx4 v2, s[12:15], s60 offen offset:0 lds
  s_add_u32 s60, s70, 393216
  s_add_u32 m0, s69, 118784
  s_nop 0
  buffer_load_dwordx4 v2, s[12:15], s60 offen offset:0 lds
  s_add_u32 s60, s70, 401408
  s_add_u32 m0, s69, 119808
  s_nop 0
  buffer_load_dwordx4 v2, s[12:15], s60 offen offset:0 lds
  s_add_u32 s60, s70, 409600
  s_add_u32 m0, s69, 120832
  s_nop 0
  buffer_load_dwordx4 v2, s[12:15], s60 offen offset:0 lds
  s_add_u32 s60, s70, 417792
  s_add_u32 m0, s69, 121856
  s_nop 0
  buffer_load_dwordx4 v2, s[12:15], s60 offen offset:0 lds
  s_add_u32 s60, s70, 425984
  s_add_u32 m0, s69, 122880
  s_nop 0
  buffer_load_dwordx4 v2, s[12:15], s60 offen offset:0 lds
  s_add_u32 s60, s70, 434176
  s_add_u32 m0, s69, 123904
  s_nop 0
  buffer_load_dwordx4 v2, s[12:15], s60 offen offset:0 lds
  s_add_u32 s60, s70, 442368
  s_add_u32 m0, s69, 124928
  s_nop 0
  buffer_load_dwordx4 v2, s[12:15], s60 offen offset:0 lds
  s_add_u32 s60, s70, 450560
  s_add_u32 m0, s69, 125952
  s_nop 0
  buffer_load_dwordx4 v2, s[12:15], s60 offen offset:0 lds
  s_waitcnt vmcnt(24)
  s_barrier
  s_branch L_A3_ENTRY_B
L_ATT:
  v_lshlrev_b32 v208, 4, v1
  s_lshl_b32 s60, s44, 10
  v_add_u32 v209, s60, v208
  v_add_u32 v210, 151552, v209
  v_add_u32 v209, 0, v209
  ds_read_b128 v[48:51], v210
  ds_read_b128 v[52:55], v209 offset:0
  ds_read_b128 v[56:59], v209 offset:1024
  ds_read_b128 v[60:63], v209 offset:2048
  ds_read_b128 v[64:67], v209 offset:3072
  ds_read_b128 v[68:71], v209 offset:4096
  ds_read_b128 v[72:75], v209 offset:5120
  ds_read_b128 v[76:79], v209 offset:6144
  ds_read_b128 v[80:83], v209 offset:7168
  ds_read_b128 v[84:87], v209 offset:8192
  v_and_b32 v211, 15, v1
  v_lshrrev_b32 v212, 5, v1
  v_lshl_add_u32 v211, v212, 4, v211
  v_lshlrev_b32 v211, 4, v211
  v_add_u32 v211, s60, v211
  v_add_u32 v211, 86016, v211
  s_sub_u32 s66, 8, s44
  s_cmp_eq_u32 s52, 0
  s_cselect_b32 s66, s66, 0
  v_and_b32 v213, 31, v1
  v_lshlrev_b32 v212, 2, v212
  v_sub_u32 v213, v213, v212
  v_mov_b32 v214, 0xf149f2ca
  v_mov_b32 v215, 0
  v_mov_b32 v88, 0x3f803f80
  v_mov_b32 v89, 0x3f803f80
  v_mov_b32 v90, 0x3f803f80
  v_mov_b32 v91, 0x3f803f80
  v_mov_b32 v92, 0x3f803f80
  v_mov_b32 v93, 0x3f803f80
  v_mov_b32 v94, 0x3f803f80
  v_mov_b32 v95, 0x3f803f80
  v_mov_b32 v96, 0x3f803f80
  v_mov_b32 v97, 0x3f803f80
  v_mov_b32 v98, 0x3f803f80
  v_mov_b32 v99, 0x3f803f80
  v_mov_b32 v100, 0x3f803f80
  v_mov_b32 v101, 0x3f803f80
  v_mov_b32 v102, 0x3f803f80
  v_mov_b32 v103, 0x3f803f80
  v_cmp_le_i32 s[80:81], 0, v213
  v_cmp_le_i32 s[82:83], 1, v213
  v_cmp_le_i32 s[84:85], 2, v213
  v_cmp_le_i32 s[86:87], 3, v213
  v_cmp_le_i32 s[88:89], 8, v213
  v_cmp_le_i32 s[90:91], 9, v213
  v_cmp_le_i32 s[92:93], 10, v213
  v_cmp_le_i32 s[94:95], 11, v213
  v_cndmask_b32 v152, v214, v215, s[80:81]
  v_cndmask_b32 v168, v215, v214, s[80:81]
  v_cndmask_b32 v153, v214, v215, s[82:83]
  v_cndmask_b32 v169, v215, v214, s[82:83]
  v_cndmask_b32 v154, v214, v215, s[84:85]
  v_cndmask_b32 v170, v215, v214, s[84:85]
  v_cndmask_b32 v155, v214, v215, s[86:87]
  v_cndmask_b32 v171, v215, v214, s[86:87]
  v_cndmask_b32 v156, v214, v215, s[88:89]
  v_cndmask_b32 v172, v215, v214, s[88:89]
  v_cndmask_b32 v157, v214, v215, s[90:91]
  v_cndmask_b32 v173, v215, v214, s[90:91]
  v_cndmask_b32 v158, v214, v215, s[92:93]
  v_cndmask_b32 v174, v215, v214, s[92:93]
  v_cndmask_b32 v159, v214, v215, s[94:95]
  v_cndmask_b32 v175, v215, v214, s[94:95]
  v_cmp_le_i32 s[80:81], 16, v213
  v_cmp_le_i32 s[82:83], 17, v213
  v_cmp_le_i32 s[84:85], 18, v213
  v_cmp_le_i32 s[86:87], 19, v213
  v_cmp_le_i32 s[88:89], 24, v213
  v_cmp_le_i32 s[90:91], 25, v213
  v_cmp_le_i32 s[92:93], 26, v213
  v_cmp_le_i32 s[94:95], 27, v213
  v_cndmask_b32 v160, v214, v215, s[80:81]
  v_cndmask_b32 v176, v215, v214, s[80:81]
  v_cndmask_b32 v161, v214, v215, s[82:83]
  v_cndmask_b32 v177, v215, v214, s[82:83]
  v_cndmask_b32 v162, v214, v215, s[84:85]
  v_cndmask_b32 v178, v215, v214, s[84:85]
  v_cndmask_b32 v163, v214, v215, s[86:87]
  v_cndmask_b32 v179, v215, v214, s[86:87]
  v_cndmask_b32 v164, v214, v215, s[88:89]
  v_cndmask_b32 v180, v215, v214, s[88:89]
  v_cndmask_b32 v165, v214, v215, s[90:91]
  v_cndmask_b32 v181, v215, v214, s[90:91]
  v_cndmask_b32 v166, v214, v215, s[92:93]
  v_cndmask_b32 v182, v215, v214, s[92:93]
  v_cndmask_b32 v167, v214, v215, s[94:95]
  v_cndmask_b32 v183, v215, v214, s[94:95]
  s_cmp_eq_u32 s66, 0
  s_cbranch_scc1 L_inits_25
  v_mov_b32 v104, v214
  v_mov_b32 v105, v214
  v_mov_b32 v106, v214
  v_mov_b32 v107, v214
  v_mov_b32 v108, v214
  v_mov_b32 v109, v214
  v_mov_b32 v110, v214
  v_mov_b32 v111, v214
  v_mov_b32 v112, v214
  v_mov_b32 v113, v214
  v_mov_b32 v114, v214
  v_mov_b32 v115, v214
  v_mov_b32 v116, v214
  v_mov_b32 v117, v214
  v_mov_b32 v118, v214
  v_mov_b32 v119, v214
  v_mov_b32 v120, v214
  v_mov_b32 v121, v214
  v_mov_b32 v122, v214
  v_mov_b32 v123, v214
  v_mov_b32 v124, v214
  v_mov_b32 v125, v214
  v_mov_b32 v126, v214
  v_mov_b32 v127, v214
  v_mov_b32 v128, v214
  v_mov_b32 v129, v214
  v_mov_b32 v130, v214
  v_mov_b32 v131, v214
  v_mov_b32 v132, v214
  v_mov_b32 v133, v214
  v_mov_b32 v134, v214
  v_mov_b32 v135, v214
L_inits_25:
  v_mov_b32 v216, v214
  s_waitcnt lgkmcnt(0)
  s_cmp_gt_u32 s66, 0
  s_cbranch_scc1 L_qk_26
  v_mfma_f32_32x32x16_bf16 v[104:119], v[52:55], v[48:51], v[168:183]
L_qk_26:
  s_cmp_gt_u32 s66, 1
  s_cbranch_scc1 L_qk_27
  v_mfma_f32_32x32x16_bf16 v[120:135], v[56:59], v[48:51], 0
L_qk_27:
  s_nop 7
  s_nop 3
  v_max3_f32 v216, v216, v104, v105
  v_max3_f32 v216, v216, v106, v107
  v_max3_f32 v216, v216, v108, v109
  v_max3_f32 v216, v216, v110, v111
  v_max3_f32 v216, v216, v112, v113
  v_max3_f32 v216, v216, v114, v115
  v_max3_f32 v216, v216, v116, v117
  v_max3_f32 v216, v216, v118, v119
  s_cmp_gt_u32 s66, 2
  s_cbranch_scc1 L_qk_28
  v_mfma_f32_32x32x16_bf16 v[104:119], v[60:63], v[48:51], 0
L_qk_28:
  s_nop 1
  v_max3_f32 v216, v216, v120, v121
  v_max3_f32 v216, v216, v122, v123
  v_max3_f32 v216, v216, v124, v125
  v_max3_f32 v216, v216, v126, v127
  v_max3_f32 v216, v216, v128, v129
  v_max3_f32 v216, v216, v130, v131
  v_max3_f32 v216, v216, v132, v133
  v_max3_f32 v216, v216, v134, v135
  s_cmp_gt_u32 s66, 3
  s_cbranch_scc1 L_qk_29
  v_mfma_f32_32x32x16_bf16 v[120:135], v[64:67], v[48:51], 0
L_qk_29:
  s_nop 1
  v_max3_f32 v216, v216, v104, v105
  v_max3_f32 v216, v216, v106, v107
  v_max3_f32 v216, v216, v108, v109
  v_max3_f32 v216, v216, v110, v111
  v_max3_f32 v216, v216, v112, v113
  v_max3_f32 v216, v216, v114, v115
  v_max3_f32 v216, v216, v116, v117
  v_max3_f32 v216, v216, v118, v119
  s_cmp_gt_u32 s66, 4
  s_cbranch_scc1 L_qk_30
  v_mfma_f32_32x32x16_bf16 v[104:119], v[68:71], v[48:51], 0
L_qk_30:
  s_nop 1
  v_max3_f32 v216, v216, v120, v121
  v_max3_f32 v216, v216, v122, v123
  v_max3_f32 v216, v216, v124, v125
  v_max3_f32 v216, v216, v126, v127
  v_max3_f32 v216, v216, v128, v129
  v_max3_f32 v216, v216, v130, v131
  v_max3_f32 v216, v216, v132, v133
  v_max3_f32 v216, v216, v134, v135
  s_cmp_gt_u32 s66, 5
  s_cbranch_scc1 L_qk_31
  v_mfma_f32_32x32x16_bf16 v[120:135], v[72:75], v[48:51], 0
L_qk_31:
  s_nop 1
  v_max3_f32 v216, v216, v104, v105
  v_max3_f32 v216, v216, v106, v107
  v_max3_f32 v216, v216, v108, v109
  v_max3_f32 v216, v216, v110, v111
  v_max3_f32 v216, v216, v112, v113
  v_max3_f32 v216, v216, v114, v115
  v_max3_f32 v216, v216, v116, v117
  v_max3_f32 v216, v216, v118, v119
  s_cmp_gt_u32 s66, 6
  s_cbranch_scc1 L_qk_32
  v_mfma_f32_32x32x16_bf16 v[104:119], v[76:79], v[48:51], 0
L_qk_32:
  s_nop 1
  v_max3_f32 v216, v216, v120, v121
  v_max3_f32 v216, v216, v122, v123
  v_max3_f32 v216, v216, v124, v125
  v_max3_f32 v216, v216, v126, v127
  v_max3_f32 v216, v216, v128, v129
  v_max3_f32 v216, v216, v130, v131
  v_max3_f32 v216, v216, v132, v133
  v_max3_f32 v216, v216, v134, v135
  s_cmp_gt_u32 s66, 7
  s_cbranch_scc1 L_qk_33
  v_mfma_f32_32x32x16_bf16 v[120:135], v[80:83], v[48:51], 0
L_qk_33:
  s_nop 1
  v_max3_f32 v216, v216, v104, v105
  v_max3_f32 v216, v216, v106, v107
  v_max3_f32 v216, v216, v108, v109
  v_max3_f32 v216, v216, v110, v111
  v_max3_f32 v216, v216, v112, v113
  v_max3_f32 v216, v216, v114, v115
  v_max3_f32 v216, v216, v116, v117
  v_max3_f32 v216, v216, v118, v119
  s_cmp_gt_u32 s66, 8
  s_cbranch_scc1 L_qk_34
  v_mfma_f32_32x32x16_bf16 v[104:119], v[84:87], v[48:51], v[152:167]
L_qk_34:
  s_nop 1
  v_max3_f32 v216, v216, v120, v121
  v_max3_f32 v216, v216, v122, v123
  v_max3_f32 v216, v216, v124, v125
  v_max3_f32 v216, v216, v126, v127
  v_max3_f32 v216, v216, v128, v129
  v_max3_f32 v216, v216, v130, v131
  v_max3_f32 v216, v216, v132, v133
  v_max3_f32 v216, v216, v134, v135
  s_nop 7
  s_nop 3
  v_max3_f32 v216, v216, v104, v105
  v_max3_f32 v216, v216, v106, v107
  v_max3_f32 v216, v216, v108, v109
  v_max3_f32 v216, v216, v110, v111
  v_max3_f32 v216, v216, v112, v113
  v_max3_f32 v216, v216, v114, v115
  v_max3_f32 v216, v216, v116, v117
  v_max3_f32 v216, v216, v118, v119
  v_mov_b32 v217, v216
  s_nop 1
  v_permlane32_swap_b32 v216, v217
  v_max_f32 v216, v216, v217
  v_sub_f32 v216, 0, v216
  s_cmp_lg_u32 s59, 0
  s_cbranch_scc1 L_fx_35
  s_waitcnt vmcnt(0)
  s_lshl_b32 s64, s47, 3
  s_add_u32 s64, s64, s48
  s_lshl_b32 s64, s64, 2
  s_add_u32 s64, s64, s44
  s_lshl_b32 s64, s64, 2
  s_add_u32 s64, s64, 20987904
  s_mov_b64 exec, 1
  buffer_store_dword v13, off, s[36:39], s64 sc1
  s_mov_b64 exec, -1
L_fx_35:
  v_mov_b32 v136, v216
  v_mov_b32 v137, v216
  v_mov_b32 v138, v216
  v_mov_b32 v139, v216
  v_mov_b32 v140, v216
  v_mov_b32 v141, v216
  v_mov_b32 v142, v216
  v_mov_b32 v143, v216
  v_mov_b32 v144, v216
  v_mov_b32 v145, v216
  v_mov_b32 v146, v216
  v_mov_b32 v147, v216
  v_mov_b32 v148, v216
  v_mov_b32 v149, v216
  v_mov_b32 v150, v216
  v_mov_b32 v151, v216
  v_pk_add_f32 v[152:153], v[152:153], v[136:137]
  v_pk_add_f32 v[168:169], v[168:169], v[136:137]
  v_pk_add_f32 v[154:155], v[154:155], v[136:137]
  v_pk_add_f32 v[170:171], v[170:171], v[136:137]
  v_pk_add_f32 v[156:157], v[156:157], v[136:137]
  v_pk_add_f32 v[172:173], v[172:173], v[136:137]
  v_pk_add_f32 v[158:159], v[158:159], v[136:137]
  v_pk_add_f32 v[174:175], v[174:175], v[136:137]
  v_pk_add_f32 v[160:161], v[160:161], v[136:137]
  v_pk_add_f32 v[176:177], v[176:177], v[136:137]
  v_pk_add_f32 v[162:163], v[162:163], v[136:137]
  v_pk_add_f32 v[178:179], v[178:179], v[136:137]
  v_pk_add_f32 v[164:165], v[164:165], v[136:137]
  v_pk_add_f32 v[180:181], v[180:181], v[136:137]
  v_pk_add_f32 v[166:167], v[166:167], v[136:137]
  v_pk_add_f32 v[182:183], v[182:183], v[136:137]
  s_cmp_eq_u32 s66, 0
  s_cbranch_scc1 L_inits_36
  v_mov_b32 v104, v214
  v_mov_b32 v105, v214
  v_mov_b32 v106, v214
  v_mov_b32 v107, v214
  v_mov_b32 v108, v214
  v_mov_b32 v109, v214
  v_mov_b32 v110, v214
  v_mov_b32 v111, v214
  v_mov_b32 v112, v214
  v_mov_b32 v113, v214
  v_mov_b32 v114, v214
  v_mov_b32 v115, v214
  v_mov_b32 v116, v214
  v_mov_b32 v117, v214
  v_mov_b32 v118, v214
  v_mov_b32 v119, v214
  v_mov_b32 v120, v214
  v_mov_b32 v121, v214
  v_mov_b32 v122, v214
  v_mov_b32 v123, v214
  v_mov_b32 v124, v214
  v_mov_b32 v125, v214
  v_mov_b32 v126, v214
  v_mov_b32 v127, v214
  v_mov_b32 v128, v214
  v_mov_b32 v129, v214
  v_mov_b32 v130, v214
  v_mov_b32 v131, v214
  v_mov_b32 v132, v214
  v_mov_b32 v133, v214
  v_mov_b32 v134, v214
  v_mov_b32 v135, v214
L_inits_36:
  s_cmp_gt_u32 s66, 0
  s_cbranch_scc1 L_qk_37
  v_mfma_f32_32x32x16_bf16 v[104:119], v[52:55], v[48:51], v[168:183]
L_qk_37:
  s_mov_b32 exec_lo, 0xffff
  s_mov_b32 exec_hi, 0xffff
  ds_read_b128 v[88:91], v211 offset:0
  ds_read_b128 v[92:95], v211 offset:512
  s_mov_b64 exec, -1
  s_cmp_gt_u32 s66, 1
  s_cbranch_scc1 L_qk_38
  s_nop 1
  v_mfma_f32_32x32x16_bf16 v[120:135], v[56:59], v[48:51], v[136:151]
L_qk_38:
  s_nop 7
  s_nop 3
  v_exp_f32 v224, v104
  v_exp_f32 v225, v105
  v_exp_f32 v226, v106
  v_exp_f32 v227, v107
  v_exp_f32 v228, v108
  v_exp_f32 v229, v109
  v_exp_f32 v230, v110
  v_exp_f32 v231, v111
  v_exp_f32 v232, v112
  v_exp_f32 v233, v113
  v_exp_f32 v234, v114
  v_exp_f32 v235, v115
  v_exp_f32 v236, v116
  v_exp_f32 v237, v117
  v_exp_f32 v238, v118
  v_exp_f32 v239, v119
  v_cvt_pk_bf16_f32 v184, v224, v225
  v_cvt_pk_bf16_f32 v185, v226, v227
  v_cvt_pk_bf16_f32 v186, v228, v229
  v_cvt_pk_bf16_f32 v187, v230, v231
  v_cvt_pk_bf16_f32 v188, v232, v233
  v_cvt_pk_bf16_f32 v189, v234, v235
  v_cvt_pk_bf16_f32 v190, v236, v237
  v_cvt_pk_bf16_f32 v191, v238, v239
  s_waitcnt lgkmcnt(0)
  v_mfma_f32_32x32x16_bf16 v[192:207], v[88:91], v[184:187], 0
  v_mfma_f32_32x32x16_bf16 v[192:207], v[92:95], v[188:191], v[192:207]
  s_mov_b32 exec_lo, 0xffff
  s_mov_b32 exec_hi, 0xffff
  ds_read_b128 v[96:99], v211 offset:1024
  ds_read_b128 v[100:103], v211 offset:1536
  s_mov_b64 exec, -1
  s_cmp_gt_u32 s66, 2
  s_cbranch_scc1 L_qk_39
  s_nop 1
  v_mfma_f32_32x32x16_bf16 v[104:119], v[60:63], v[48:51], v[136:151]
L_qk_39:
  v_exp_f32 v224, v120
  v_exp_f32 v225, v121
  v_exp_f32 v226, v122
  v_exp_f32 v227, v123
  v_exp_f32 v228, v124
  v_exp_f32 v229, v125
  v_exp_f32 v230, v126
  v_exp_f32 v231, v127
  v_exp_f32 v232, v128
  v_exp_f32 v233, v129
  v_exp_f32 v234, v130
  v_exp_f32 v235, v131
  v_exp_f32 v236, v132
  v_exp_f32 v237, v133
  v_exp_f32 v238, v134
  v_exp_f32 v239, v135
  v_cvt_pk_bf16_f32 v184, v224, v225
  v_cvt_pk_bf16_f32 v185, v226, v227
  v_cvt_pk_bf16_f32 v186, v228, v229
  v_cvt_pk_bf16_f32 v187, v230, v231
  v_cvt_pk_bf16_f32 v188, v232, v233
  v_cvt_pk_bf16_f32 v189, v234, v235
  v_cvt_pk_bf16_f32 v190, v236, v237
  v_cvt_pk_bf16_f32 v191, v238, v239
  s_waitcnt lgkmcnt(0)
  v_mfma_f32_32x32x16_bf16 v[192:207], v[96:99], v[184:187], v[192:207]
  v_mfma_f32_32x32x16_bf16 v[192:207], v[100:103], v[188:191], v[192:207]
  s_mov_b32 exec_lo, 0xffff
  s_mov_b32 exec_hi, 0xffff
  ds_read_b128 v[88:91], v211 offset:2048
  ds_read_b128 v[92:95], v211 offset:2560
  s_mov_b64 exec, -1
  s_cmp_gt_u32 s66, 3
  s_cbranch_scc1 L_qk_40
  s_nop 1
  v_mfma_f32_32x32x16_bf16 v[120:135], v[64:67], v[48:51], v[136:151]
L_qk_40:
  v_exp_f32 v224, v104
  v_exp_f32 v225, v105
  v_exp_f32 v226, v106
  v_exp_f32 v227, v107
  v_exp_f32 v228, v108
  v_exp_f32 v229, v109
  v_exp_f32 v230, v110
  v_exp_f32 v231, v111
  v_exp_f32 v232, v112
  v_exp_f32 v233, v113
  v_exp_f32 v234, v114
  v_exp_f32 v235, v115
  v_exp_f32 v236, v116
  v_exp_f32 v237, v117
  v_exp_f32 v238, v118
  v_exp_f32 v239, v119
  v_cvt_pk_bf16_f32 v184, v224, v225
  v_cvt_pk_bf16_f32 v185, v226, v227
  v_cvt_pk_bf16_f32 v186, v228, v229
  v_cvt_pk_bf16_f32 v187, v230, v231
  v_cvt_pk_bf16_f32 v188, v232, v233
  v_cvt_pk_bf16_f32 v189, v234, v235
  v_cvt_pk_bf16_f32 v190, v236, v237
  v_cvt_pk_bf16_f32 v191, v238, v239
  s_waitcnt lgkmcnt(0)
  v_mfma_f32_32x32x16_bf16 v[192:207], v[88:91], v[184:187], v[192:207]
  v_mfma_f32_32x32x16_bf16 v[192:207], v[92:95], v[188:191], v[192:207]
  s_mov_b32 exec_lo, 0xffff
  s_mov_b32 exec_hi, 0xffff
  ds_read_b128 v[96:99], v211 offset:3072
  ds_read_b128 v[100:103], v211 offset:3584
  s_mov_b64 exec, -1
  s_cmp_gt_u32 s66, 4
  s_cbranch_scc1 L_qk_41
  s_nop 1
  v_mfma_f32_32x32x16_bf16 v[104:119], v[68:71], v[48:51], v[136:151]
L_qk_41:
  v_exp_f32 v224, v120
  v_exp_f32 v225, v121
  v_exp_f32 v226, v122
  v_exp_f32 v227, v123
  v_exp_f32 v228, v124
  v_exp_f32 v229, v125
  v_exp_f32 v230, v126
  v_exp_f32 v231, v127
  v_exp_f32 v232, v128
  v_exp_f32 v233, v129
  v_exp_f32 v234, v130
  v_exp_f32 v235, v131
  v_exp_f32 v236, v132
  v_exp_f32 v237, v133
  v_exp_f32 v238, v134
  v_exp_f32 v239, v135
  v_cvt_pk_bf16_f32 v184, v224, v225
  v_cvt_pk_bf16_f32 v185, v226, v227
  v_cvt_pk_bf16_f32 v186, v228, v229
  v_cvt_pk_bf16_f32 v187, v230, v231
  v_cvt_pk_bf16_f32 v188, v232, v233
  v_cvt_pk_bf16_f32 v189, v234, v235
  v_cvt_pk_bf16_f32 v190, v236, v237
  v_cvt_pk_bf16_f32 v191, v238, v239
  s_waitcnt lgkmcnt(0)
  v_mfma_f32_32x32x16_bf16 v[192:207], v[96:99], v[184:187], v[192:207]
  v_mfma_f32_32x32x16_bf16 v[192:207], v[100:103], v[188:191], v[192:207]
  s_mov_b32 exec_lo, 0xffff
  s_mov_b32 exec_hi, 0xffff
  ds_read_b128 v[88:91], v211 offset:4096
  ds_read_b128 v[92:95], v211 offset:4608
  s_mov_b64 exec, -1
  s_cmp_gt_u32 s66, 5
  s_cbranch_scc1 L_qk_42
  s_nop 1
  v_mfma_f32_32x32x16_bf16 v[120:135], v[72:75], v[48:51], v[136:151]
L_qk_42:
  v_exp_f32 v224, v104
  v_exp_f32 v225, v105
  v_exp_f32 v226, v106
  v_exp_f32 v227, v107
  v_exp_f32 v228, v108
  v_exp_f32 v229, v109
  v_exp_f32 v230, v110
  v_exp_f32 v231, v111
  v_exp_f32 v232, v112
  v_exp_f32 v233, v113
  v_exp_f32 v234, v114
  v_exp_f32 v235, v115
  v_exp_f32 v236, v116
  v_exp_f32 v237, v117
  v_exp_f32 v238, v118
  v_exp_f32 v239, v119
  v_cvt_pk_bf16_f32 v184, v224, v225
  v_cvt_pk_bf16_f32 v185, v226, v227
  v_cvt_pk_bf16_f32 v186, v228, v229
  v_cvt_pk_bf16_f32 v187, v230, v231
  v_cvt_pk_bf16_f32 v188, v232, v233
  v_cvt_pk_bf16_f32 v189, v234, v235
  v_cvt_pk_bf16_f32 v190, v236, v237
  v_cvt_pk_bf16_f32 v191, v238, v239
  s_waitcnt lgkmcnt(0)
  v_mfma_f32_32x32x16_bf16 v[192:207], v[88:91], v[184:187], v[192:207]
  v_mfma_f32_32x32x16_bf16 v[192:207], v[92:95], v[188:191], v[192:207]
  s_mov_b32 exec_lo, 0xffff
  s_mov_b32 exec_hi, 0xffff
  ds_read_b128 v[96:99], v211 offset:5120
  ds_read_b128 v[100:103], v211 offset:5632
  s_mov_b64 exec, -1
  s_cmp_gt_u32 s66, 6
  s_cbranch_scc1 L_qk_43
  s_nop 1
  v_mfma_f32_32x32x16_bf16 v[104:119], v[76:79], v[48:51], v[136:151]
L_qk_43:
  v_exp_f32 v224, v120
  v_exp_f32 v225, v121
  v_exp_f32 v226, v122
  v_exp_f32 v227, v123
  v_exp_f32 v228, v124
  v_exp_f32 v229, v125
  v_exp_f32 v230, v126
  v_exp_f32 v231, v127
  v_exp_f32 v232, v128
  v_exp_f32 v233, v129
  v_exp_f32 v234, v130
  v_exp_f32 v235, v131
  v_exp_f32 v236, v132
  v_exp_f32 v237, v133
  v_exp_f32 v238, v134
  v_exp_f32 v239, v135
  v_cvt_pk_bf16_f32 v184, v224, v225
  v_cvt_pk_bf16_f32 v185, v226, v227
  v_cvt_pk_bf16_f32 v186, v228, v229
  v_cvt_pk_bf16_f32 v187, v230, v231
  v_cvt_pk_bf16_f32 v188, v232, v233
  v_cvt_pk_bf16_f32 v189, v234, v235
  v_cvt_pk_bf16_f32 v190, v236, v237
  v_cvt_pk_bf16_f32 v191, v238, v239
  s_waitcnt lgkmcnt(0)
  v_mfma_f32_32x32x16_bf16 v[192:207], v[96:99], v[184:187], v[192:207]
  v_mfma_f32_32x32x16_bf16 v[192:207], v[100:103], v[188:191], v[192:207]
  s_mov_b32 exec_lo, 0xffff
  s_mov_b32 exec_hi, 0xffff
  ds_read_b128 v[88:91], v211 offset:6144
  ds_read_b128 v[92:95], v211 offset:6656
  s_mov_b64 exec, -1
  s_cmp_gt_u32 s66, 7
  s_cbranch_scc1 L_qk_44
  s_nop 1
  v_mfma_f32_32x32x16_bf16 v[120:135], v[80:83], v[48:51], v[136:151]
L_qk_44:
  v_exp_f32 v224, v104
  v_exp_f32 v225, v105
  v_exp_f32 v226, v106
  v_exp_f32 v227, v107
  v_exp_f32 v228, v108
  v_exp_f32 v229, v109
  v_exp_f32 v230, v110
  v_exp_f32 v231, v111
  v_exp_f32 v232, v112
  v_exp_f32 v233, v113
  v_exp_f32 v234, v114
  v_exp_f32 v235, v115
  v_exp_f32 v236, v116
  v_exp_f32 v237, v117
  v_exp_f32 v238, v118
  v_exp_f32 v239, v119
  v_cvt_pk_bf16_f32 v184, v224, v225
  v_cvt_pk_bf16_f32 v185, v226, v227
  v_cvt_pk_bf16_f32 v186, v228, v229
  v_cvt_pk_bf16_f32 v187, v230, v231
  v_cvt_pk_bf16_f32 v188, v232, v233
  v_cvt_pk_bf16_f32 v189, v234, v235
  v_cvt_pk_bf16_f32 v190, v236, v237
  v_cvt_pk_bf16_f32 v191, v238, v239
  s_waitcnt lgkmcnt(0)
  v_mfma_f32_32x32x16_bf16 v[192:207], v[88:91], v[184:187], v[192:207]
  v_mfma_f32_32x32x16_bf16 v[192:207], v[92:95], v[188:191], v[192:207]
  s_mov_b32 exec_lo, 0xffff
  s_mov_b32 exec_hi, 0xffff
  ds_read_b128 v[96:99], v211 offset:7168
  ds_read_b128 v[100:103], v211 offset:7680
  s_mov_b64 exec, -1
  s_cmp_gt_u32 s66, 8
  s_cbranch_scc1 L_qk_45
  s_nop 1
  v_mfma_f32_32x32x16_bf16 v[104:119], v[84:87], v[48:51], v[152:167]
L_qk_45:
  v_exp_f32 v224, v120
  v_exp_f32 v225, v121
  v_exp_f32 v226, v122
  v_exp_f32 v227, v123
  v_exp_f32 v228, v124
  v_exp_f32 v229, v125
  v_exp_f32 v230, v126
  v_exp_f32 v231, v127
  v_exp_f32 v232, v128
  v_exp_f32 v233, v129
  v_exp_f32 v234, v130
  v_exp_f32 v235, v131
  v_exp_f32 v236, v132
  v_exp_f32 v237, v133
  v_exp_f32 v238, v134
  v_exp_f32 v239, v135
  v_cvt_pk_bf16_f32 v184, v224, v225
  v_cvt_pk_bf16_f32 v185, v226, v227
  v_cvt_pk_bf16_f32 v186, v228, v229
  v_cvt_pk_bf16_f32 v187, v230, v231
  v_cvt_pk_bf16_f32 v188, v232, v233
  v_cvt_pk_bf16_f32 v189, v234, v235
  v_cvt_pk_bf16_f32 v190, v236, v237
  v_cvt_pk_bf16_f32 v191, v238, v239
  s_waitcnt lgkmcnt(0)
  v_mfma_f32_32x32x16_bf16 v[192:207], v[96:99], v[184:187], v[192:207]
  v_mfma_f32_32x32x16_bf16 v[192:207], v[100:103], v[188:191], v[192:207]
  s_mov_b32 exec_lo, 0xffff
  s_mov_b32 exec_hi, 0xffff
  ds_read_b128 v[88:91], v211 offset:8192
  ds_read_b128 v[92:95], v211 offset:8704
  s_mov_b64 exec, -1
  v_exp_f32 v224, v104
  v_exp_f32 v225, v105
  v_exp_f32 v226, v106
  v_exp_f32 v227, v107
  v_exp_f32 v228, v108
  v_exp_f32 v229, v109
  v_exp_f32 v230, v110
  v_exp_f32 v231, v111
  v_exp_f32 v232, v112
  v_exp_f32 v233, v113
  v_exp_f32 v234, v114
  v_exp_f32 v235, v115
  v_exp_f32 v236, v116
  v_exp_f32 v237, v117
  v_exp_f32 v238, v118
  v_exp_f32 v239, v119
  v_cvt_pk_bf16_f32 v184, v224, v225
  v_cvt_pk_bf16_f32 v185, v226, v227
  v_cvt_pk_bf16_f32 v186, v228, v229
  v_cvt_pk_bf16_f32 v187, v230, v231
  v_cvt_pk_bf16_f32 v188, v232, v233
  v_cvt_pk_bf16_f32 v189, v234, v235
  v_cvt_pk_bf16_f32 v190, v236, v237
  v_cvt_pk_bf16_f32 v191, v238, v239
  s_waitcnt lgkmcnt(0)
  v_mfma_f32_32x32x16_bf16 v[192:207], v[88:91], v[184:187], v[192:207]
  v_mfma_f32_32x32x16_bf16 v[192:207], v[92:95], v[188:191], v[192:207]
  s_nop 7
  s_nop 7
  v_rcp_f32 v217, v200
  s_nop 0
  v_pk_mul_f32 v[192:193], v[192:193], v[216:217] op_sel:[0,1] op_sel_hi:[1,1]
  v_pk_mul_f32 v[194:195], v[194:195], v[216:217] op_sel:[0,1] op_sel_hi:[1,1]
  v_pk_mul_f32 v[196:197], v[196:197], v[216:217] op_sel:[0,1] op_sel_hi:[1,1]
  v_pk_mul_f32 v[198:199], v[198:199], v[216:217] op_sel:[0,1] op_sel_hi:[1,1]
  v_cvt_pk_bf16_f32 v184, v192, v193
  v_cvt_pk_bf16_f32 v185, v194, v195
  v_cvt_pk_bf16_f32 v186, v196, v197
  v_cvt_pk_bf16_f32 v187, v198, v199
  s_lshl_b32 s60, s52, 3
  s_add_u32 s60, s60, s44
  s_lshl_b32 s60, s60, 5
  s_add_u32 s60, s60, s51
  s_lshl_b32 s60, s60, 10
  s_add_u32 s60, s60, 10485760
  buffer_store_dwordx4 v[184:187], v208, s[36:39], s60 offen sc1
  s_cmp_eq_u32 s59, 0
  s_cbranch_scc1 L_ATT_RET_C
  s_cmp_eq_u32 s59, 1
  s_cbranch_scc1 L_ATT_RET_A
  s_branch L_ATT_RET_B
L_END:
  s_endpgm
.section .rodata,"a"
.p2align 6
.amdhsa_kernel recurrent_scan__sliding_block__mixer_s_mlp__prompt_kernel
  .amdhsa_next_free_vgpr 256
  .amdhsa_next_free_sgpr 102
  .amdhsa_accum_offset 256
  .amdhsa_group_segment_fixed_size 0
  .amdhsa_kernarg_size 88
  .amdhsa_user_sgpr_count 2
  .amdhsa_user_sgpr_kernarg_segment_ptr 1
  .amdhsa_system_sgpr_workgroup_id_x 1
.end_amdhsa_kernel
```
